```python
import torch

def _softmax(x, axis=-1):
    return torch.softmax(x, dim=axis)
def _gelu(x):
    return torch.nn.functional.gelu(x, approximate="tanh")
def _silu(x):
    return torch.nn.functional.silu(x)
def _sigmoid(x):
    return torch.sigmoid(x)
def _layernorm(x, axis=-1, eps=1e-5):
    m = x.mean(dim=axis, keepdim=True)
    v = x.var(dim=axis, keepdim=True, unbiased=False)
    return (x - m) / torch.sqrt(v + eps)
def _scatter_add(tgt, idx, src, axis=0):
    return tgt.clone().index_add_(axis, idx, src)
def _segment_sum(src, seg, n):
    out = torch.zeros((n,) + src.shape[1:], dtype=src.dtype)
    return out.index_add_(0, seg, src)
def _pad(x, pw):
    flat = tuple(v for pair in reversed(pw) for v in pair)
    return torch.nn.functional.pad(x, flat)

kernel_name = 'recurrent_scan__gqa_block_cached__geglu_ffn__prompt'

def setup_inputs():

    _w = (lambda a: (lambda t: t.to(torch.bfloat16) if t.is_floating_point() else t)(torch.as_tensor(a)))
    def _A_setup():
        B, Sq, D = 1, 2048, 512
        Hq, Hkv, Sk, Dh = 32, 8, 2048, 128
        assert Hq % Hkv == 0, (Hq, Hkv)
        return {
            "x": _w((lambda *s: torch.randn(*s, dtype=torch.bfloat16) * 0.05)(B, Sq, D)),
            "k_cache": _w((lambda *s: torch.randn(*s, dtype=torch.bfloat16) * 0.8)(B, Hkv, Sk, Dh)),
            "v_cache": _w((lambda *s: torch.randn(*s, dtype=torch.bfloat16) * 0.2)(B, Hkv, Sk, Dh)),
            "wq": _w((lambda *s: torch.randn(*s, dtype=torch.bfloat16) * 0.8)(D, Hq * Dh) * (D ** -0.5)),
            "wo": _w((lambda *s: torch.randn(*s, dtype=torch.bfloat16) * 0.2)(Hq * Dh, D) * ((Hq * Dh) ** -0.5)),
        }
    _A_in = _A_setup()

    def _B_setup():
        B, S, D, F = 1, 2048, 512, 1792
        return {
            "x": _w((lambda *s: torch.randn(*s, dtype=torch.bfloat16) * 0.05)(B, S, D)),
            "w_gate": _w((lambda *s: torch.randn(*s, dtype=torch.bfloat16) * 0.1)(D, F)),
            "w_up": _w((lambda *s: torch.randn(*s, dtype=torch.bfloat16) * 0.1)(D, F)),
            "w_down": _w((lambda *s: torch.randn(*s, dtype=torch.bfloat16) * 0.1)(F, D)),
        }
    _B_in = _B_setup()

    return {
        "A_x": _A_in["x"],
        "A_k_cache": _A_in["k_cache"],
        "A_v_cache": _A_in["v_cache"],
        "A_wq": _A_in["wq"],
        "A_wo": _A_in["wo"],
        "B_x": _B_in["x"],
        "B_w_gate": _B_in["w_gate"],
        "B_w_up": _B_in["w_up"],
        "B_w_down": _B_in["w_down"],
    }

def reference(A_x, A_k_cache, A_v_cache, A_wq, A_wo, B_x, B_w_gate, B_w_up, B_w_down):
    def _A_ref(x, k_cache, v_cache, wq, wo):
        B, Sq, D = x.shape
        Hq, Dh = 32, 128
        Hkv = k_cache.shape[1]
        rep = Hq // Hkv
        q = (lambda x, *d: x.permute(*d))((x @ wq).reshape(B, Sq, Hq, Dh), 0, 2, 1, 3)
        k = (lambda x, n, axis: torch.repeat_interleave(x, n, dim=axis))(k_cache, rep, axis=1)
        v = (lambda x, n, axis: torch.repeat_interleave(x, n, dim=axis))(v_cache, rep, axis=1)
        scores = torch.einsum("bhqd,bhkd->bhqk", q, k) * (Dh ** -0.5)
        p = _softmax(scores, axis=-1)
        o = torch.einsum("bhqk,bhkd->bhqd", p, v)
        return (lambda x, *d: x.permute(*d))(o, 0, 2, 1, 3).reshape(B, Sq, Hq * Dh) @ wo

    def _B_ref(x, w_gate, w_up, w_down):
        return (_gelu(x @ w_gate) * (x @ w_up)) @ w_down

    x = A_x
    xn = _layernorm(x, axis=-1)
    s = _A_ref(xn, A_k_cache, A_v_cache, A_wq, A_wo)
    g = _silu(_B_ref(xn, B_w_gate, B_w_up, B_w_down))
    return x + s * g
```

```asm
; @launch grid=(256,1,1) block=(256,1,1) lds=163840
.amdgcn_target "amdgcn-amd-amdhsa--gfx950"
.text
.globl recurrent_scan__gqa_block_cached__geglu_ffn__prompt_kernel
.p2align 8
.type recurrent_scan__gqa_block_cached__geglu_ffn__prompt_kernel,@function
recurrent_scan__gqa_block_cached__geglu_ffn__prompt_kernel:
    s_cmp_ge_u32 s2, 256
    s_cbranch_scc1 L_end
    s_mov_b32 s64, 0
L_restart:
    s_load_dwordx16 s[68:83], s[0:1], 0
    s_load_dwordx8 s[84:91], s[0:1], 64
    s_getpc_b64 s[94:95]
L_pc0:
    v_sub_u32 v55, 255, v0
    v_cmp_gt_u32 vcc, 64, v55
    v_lshlrev_b32 v55, 7, v55
    s_nop 0
    s_and_saveexec_b64 s[4:5], vcc
    s_cbranch_execz L_ct0
    global_load_dword v55, v55, s[94:95]
L_ct0:
    s_mov_b64 exec, -1
    s_and_b32 s52, s2, 7
    s_lshr_b32 s53, s2, 3
    v_and_b32 v1, 63, v0
    v_lshrrev_b32 v3, 6, v0
    v_lshlrev_b32 v2, 4, v1
    v_readfirstlane_b32 s54, v3
    v_and_b32 v40, 15, v1
    v_lshrrev_b32 v41, 4, v1
    v_lshrrev_b32 v44, 3, v1
    v_lshl_add_u32 v44, v3, 4, v44
    v_lshlrev_b32 v44, 10, v44
    v_and_b32 v45, 7, v1
    v_xor_b32 v45, v45, v41
    v_lshl_add_u32 v47, v45, 4, v44
    v_xor_b32 v50, 64, v47
    v_add_u32 v50, 8192, v50
    s_lshl_b32 s56, s52, 7
    s_and_b32 s57, s54, 1
    s_lshr_b32 s58, s2, 3
    s_lshl_b32 s58, s58, 1
    s_add_u32 s57, s57, s58
    s_mul_i32 s57, s57, 28672
    s_add_u32 s56, s56, s57
    v_lshrrev_b32 v44, 2, v1
    v_mul_u32_u24 v44, 3584, v44
    v_and_b32 v46, 3, v1
    v_lshl_add_u32 v44, v46, 10, v44
    v_add_u32 v52, s56, v44
    s_add_u32 s58, s52, 1
    s_lshr_b32 s58, s58, 1
    s_lshl_b32 s58, s58, 7
    v_cmp_eq_u32 vcc, 3, v46
    v_subrev_u32 v44, s58, v52
    s_nop 0
    v_cndmask_b32 v52, v52, v44, vcc
    s_lshr_b32 s57, s2, 3
    s_lshl_b32 s57, s57, 2
    s_add_u32 s57, s57, s54
    s_mul_i32 s58, s57, 384
    v_lshlrev_b32 v54, 7, v1
    v_add_u32 v54, s58, v54
    s_lshl_b32 s55, s53, 16
    s_waitcnt lgkmcnt(0)
    s_add_u32 s4, s68, s55
    s_addc_u32 s5, s69, 0
    s_mov_b32 s6, 0x10000
    s_mov_b32 s7, 0x20000
    s_lshl_b32 s60, s54, 14
    s_add_u32 m0, s60, 0
    s_nop 0
    buffer_load_dwordx4 v47, s[4:7], 0 offen offset:0 lds
    s_add_u32 m0, s60, 1024
    s_nop 0
    buffer_load_dwordx4 v50, s[4:7], 0 offen offset:0 lds
    s_add_u32 m0, s60, 1920
    s_nop 0
    buffer_load_dwordx4 v47, s[4:7], 0 offen offset:128 lds
    s_add_u32 m0, s60, 2944
    s_nop 0
    buffer_load_dwordx4 v50, s[4:7], 0 offen offset:128 lds
    s_add_u32 m0, s60, 3840
    s_nop 0
    buffer_load_dwordx4 v47, s[4:7], 0 offen offset:256 lds
    s_add_u32 m0, s60, 4864
    s_nop 0
    buffer_load_dwordx4 v50, s[4:7], 0 offen offset:256 lds
    s_add_u32 m0, s60, 5760
    s_nop 0
    buffer_load_dwordx4 v47, s[4:7], 0 offen offset:384 lds
    s_add_u32 m0, s60, 6784
    s_nop 0
    buffer_load_dwordx4 v50, s[4:7], 0 offen offset:384 lds
    s_add_u32 m0, s60, 7680
    s_nop 0
    buffer_load_dwordx4 v47, s[4:7], 0 offen offset:512 lds
    s_add_u32 m0, s60, 8704
    s_nop 0
    buffer_load_dwordx4 v50, s[4:7], 0 offen offset:512 lds
    s_add_u32 m0, s60, 9600
    s_nop 0
    buffer_load_dwordx4 v47, s[4:7], 0 offen offset:640 lds
    s_add_u32 m0, s60, 10624
    s_nop 0
    buffer_load_dwordx4 v50, s[4:7], 0 offen offset:640 lds
    s_cmp_lt_u32 s54, 2
    s_cselect_b64 s[92:93], s[80:81], s[82:83]
    s_mov_b64 s[100:101], s[92:93]
    s_lshr_b32 s57, s2, 3
    s_lshl_b32 s57, s57, 2
    s_add_u32 s57, s57, s54
    s_lshl_b32 s57, s57, 15
    s_lshl_b32 s58, s52, 10
    s_add_u32 s57, s57, s58
    v_lshrrev_b32 v44, 3, v1
    v_lshlrev_b32 v44, 13, v44
    v_and_b32 v46, 7, v1
    v_lshl_add_u32 v44, v46, 7, v44
    v_add_u32 v53, s57, v44
    s_mov_b64 exec, 0xffffffff
    global_load_dword v48, v53, s[74:75]
    s_mov_b64 exec, 7
    global_load_dword v49, v54, s[94:95]
    s_mov_b64 exec, -1
    s_lshr_b32 s57, s2, 6
    s_and_b32 s58, s2, 7
    s_lshl_b32 s58, s58, 2
    s_add_u32 s57, s57, s58
    s_lshl_b32 s55, s57, 16
    s_add_u32 s36, s86, s55
    s_addc_u32 s37, s87, 0
    s_mov_b32 s38, 0x10000
    s_mov_b32 s39, 0x20000
    s_lshl_b32 s56, s52, 19
    s_add_u32 s8, s70, s56
    s_addc_u32 s9, s71, 0
    s_mov_b32 s10, 0x80000
    s_mov_b32 s11, 0x20000
    s_add_u32 s12, s72, s56
    s_addc_u32 s13, s73, 0
    s_mov_b32 s14, 0x80000
    s_mov_b32 s15, 0x20000
    s_add_u32 s20, s76, s56
    s_addc_u32 s21, s77, 0
    s_mov_b32 s22, 0x80000
    s_mov_b32 s23, 0x20000
    s_mov_b32 s16, s74
    s_mov_b32 s17, s75
    s_mov_b32 s18, 0x400000
    s_mov_b32 s19, 0x20000
    s_mov_b32 s24, s80
    s_mov_b32 s25, s81
    s_mov_b32 s26, 0x1c0000
    s_mov_b32 s27, 0x20000
    s_mov_b32 s28, s82
    s_mov_b32 s29, s83
    s_mov_b32 s30, 0x1c0000
    s_mov_b32 s31, 0x20000
    s_mov_b32 s32, s84
    s_mov_b32 s33, s85
    s_mov_b32 s34, 0x1c0000
    s_mov_b32 s35, 0x20000
    s_mov_b32 s40, s88
    s_mov_b32 s41, s89
    s_mov_b32 s42, 0x100
    s_mov_b32 s43, 0x20000
    s_mul_i32 s56, s53, 229376
    s_add_u32 s44, s90, s56
    s_addc_u32 s45, s91, 0
    s_mov_b32 s46, 0x38000
    s_mov_b32 s47, 0x20000
    s_lshl_b32 s56, s53, 19
    s_add_u32 s56, s56, 0x800000
    s_add_u32 s48, s90, s56
    s_addc_u32 s49, s91, 0
    s_mov_b32 s50, 0x80000
    s_mov_b32 s51, 0x20000
    s_mov_b64 s[92:93], s[90:91]
    s_lshl_b32 s55, s57, 16
    s_add_u32 s88, s68, s55
    s_addc_u32 s89, s69, 0
    s_mov_b32 s90, 0x10000
    s_mov_b32 s91, 0x20000
    s_mul_i32 s56, s57, 229376
    s_add_u32 s80, s92, s56
    s_addc_u32 s81, s93, 0
    s_mov_b32 s82, 0x38000
    s_mov_b32 s83, 0x20000
    s_lshl_b32 s56, s57, 19
    s_add_u32 s56, s56, 0x800000
    s_add_u32 s84, s92, s56
    s_addc_u32 s85, s93, 0
    s_mov_b32 s86, 0x80000
    s_mov_b32 s87, 0x20000
    s_mov_b32 s76, s57
    s_bfe_u32 s77, s2, 0x30003
    s_lshl_b32 s79, s53, 2
    s_add_u32 s79, s79, s54
    s_lshl_b32 s79, s79, 8
    s_lshl_b32 s56, s52, 2
    s_add_u32 s79, s79, s56
    s_lshl_b32 s59, s54, 12
    s_add_u32 s59, s59, 65536
    s_lshl_b32 s56, s54, 3
    s_add_u32 s56, s56, s52
    s_lshr_b32 s57, s52, 1
    s_add_u32 s57, s57, 24
    s_cmp_eq_u32 s54, 3
    s_cselect_b32 s56, s57, s56
    s_lshl_b32 s65, s56, 13
    s_add_u32 s66, s65, 4096
    s_lshl_b32 s56, s56, 7
    s_lshl_b32 s57, s52, 2
    s_add_u32 s57, s57, s54
    s_lshl_b32 s57, s57, 8
    v_bfe_u32 v44, v1, 1, 2
    v_bfe_u32 v45, v1, 4, 1
    v_xor_b32 v44, v44, v45
    v_and_b32 v45, 1, v1
    v_lshlrev_b32 v45, 4, v45
    v_lshl_add_u32 v44, v44, 5, v45
    v_lshrrev_b32 v45, 3, v1
    v_mul_u32_u24 v45, 3584, v45
    v_add3_u32 v44, v44, v45, s56
    v_add_u32 v12, 0, v44
    v_bfe_u32 v44, v1, 1, 2
    v_bfe_u32 v45, v1, 4, 1
    v_xor_b32 v44, v44, v45
    v_xor_b32 v44, 2, v44
    v_and_b32 v45, 1, v1
    v_lshlrev_b32 v45, 4, v45
    v_lshl_add_u32 v44, v44, 5, v45
    v_lshrrev_b32 v45, 3, v1
    v_mul_u32_u24 v45, 3584, v45
    v_add3_u32 v44, v44, v45, s56
    v_add_u32 v13, 27648, v44
    v_bfe_u32 v44, v1, 1, 2
    v_bfe_u32 v45, v1, 4, 1
    v_xor_b32 v44, v44, v45
    v_and_b32 v45, 1, v1
    v_lshlrev_b32 v45, 4, v45
    v_lshl_add_u32 v44, v44, 5, v45
    v_lshrrev_b32 v45, 3, v1
    v_mul_u32_u24 v45, 3584, v45
    v_add3_u32 v44, v44, v45, s56
    v_add_u32 v14, 55296, v44
    v_bfe_u32 v44, v1, 1, 2
    v_bfe_u32 v45, v1, 4, 1
    v_xor_b32 v44, v44, v45
    v_xor_b32 v44, 2, v44
    v_and_b32 v45, 1, v1
    v_lshlrev_b32 v45, 4, v45
    v_lshl_add_u32 v44, v44, 5, v45
    v_lshrrev_b32 v45, 3, v1
    v_mul_u32_u24 v45, 3584, v45
    v_add3_u32 v44, v44, v45, s56
    v_add_u32 v15, 82944, v44
    v_bfe_u32 v44, v1, 1, 2
    v_bfe_u32 v45, v1, 4, 1
    v_xor_b32 v44, v44, v45
    v_and_b32 v45, 1, v1
    v_lshlrev_b32 v45, 4, v45
    v_lshl_add_u32 v44, v44, 5, v45
    v_lshrrev_b32 v45, 3, v1
    v_mul_u32_u24 v45, 8192, v45
    v_add3_u32 v44, v44, v45, s57
    v_add_u32 v16, 0, v44
    v_bfe_u32 v44, v1, 1, 2
    v_bfe_u32 v45, v1, 4, 1
    v_xor_b32 v44, v44, v45
    v_xor_b32 v44, 2, v44
    v_and_b32 v45, 1, v1
    v_lshlrev_b32 v45, 4, v45
    v_lshl_add_u32 v44, v44, 5, v45
    v_lshrrev_b32 v45, 3, v1
    v_mul_u32_u24 v45, 8192, v45
    v_add3_u32 v44, v44, v45, s57
    v_add_u32 v17, 64512, v44
    v_bfe_u32 v44, v1, 1, 2
    v_bfe_u32 v45, v1, 4, 1
    v_xor_b32 v44, v44, v45
    v_and_b32 v45, 1, v1
    v_lshlrev_b32 v45, 4, v45
    v_lshl_add_u32 v44, v44, 5, v45
    v_lshrrev_b32 v45, 3, v1
    v_mul_u32_u24 v45, 8192, v45
    v_add3_u32 v44, v44, v45, s57
    v_add_u32 v18, 129024, v44
    v_bfe_u32 v44, v1, 1, 2
    v_bfe_u32 v45, v1, 4, 1
    v_xor_b32 v44, v44, v45
    v_xor_b32 v44, 2, v44
    v_and_b32 v45, 1, v1
    v_lshlrev_b32 v45, 4, v45
    v_lshl_add_u32 v44, v44, 5, v45
    v_lshrrev_b32 v45, 3, v1
    v_mul_u32_u24 v45, 8192, v45
    v_add3_u32 v44, v44, v45, s57
    v_add_u32 v19, 193536, v44
    s_lshl_b32 s58, s2, 1
    s_and_b32 s56, s54, 1
    s_add_u32 s58, s58, s56
    s_mul_i32 s58, s58, 3584
    v_lshlrev_b32 v54, 7, v1
    v_add_u32 v54, s58, v54
    v_bfe_u32 v42, v1, 2, 2
    v_and_b32 v43, 3, v1
    v_lshlrev_b32 v44, 10, v41
    v_lshl_add_u32 v44, v42, 7, v44
    v_lshl_add_u32 v44, v43, 3, v44
    v_add_u32 v44, s59, v44
    v_lshrrev_b32 v45, 1, v42
    v_and_b32 v46, 1, v41
    v_lshl_add_u32 v45, v46, 1, v45
    v_xor_b32 v46, 0, v45
    v_lshl_add_u32 v4, v46, 5, v44
    v_add_u32 v8, 49152, v4
    v_xor_b32 v46, 1, v45
    v_lshl_add_u32 v5, v46, 5, v44
    v_add_u32 v9, 49152, v5
    v_xor_b32 v46, 2, v45
    v_lshl_add_u32 v6, v46, 5, v44
    v_add_u32 v10, 49152, v6
    v_xor_b32 v46, 3, v45
    v_lshl_add_u32 v7, v46, 5, v44
    v_add_u32 v11, 49152, v7
    v_xor_b32 v45, v41, v40
    v_xor_b32 v46, 0, v45
    v_lshlrev_b32 v46, 4, v46
    v_lshl_add_u32 v46, v40, 8, v46
    v_add_u32 v20, 131072, v46
    v_xor_b32 v46, 4, v45
    v_lshlrev_b32 v46, 4, v46
    v_lshl_add_u32 v46, v40, 8, v46
    v_add_u32 v21, 131072, v46
    v_xor_b32 v46, 8, v45
    v_lshlrev_b32 v46, 4, v46
    v_lshl_add_u32 v46, v40, 8, v46
    v_add_u32 v22, 131072, v46
    v_xor_b32 v46, 12, v45
    v_lshlrev_b32 v46, 4, v46
    v_lshl_add_u32 v46, v40, 8, v46
    v_add_u32 v23, 131072, v46
    v_lshl_add_u32 v44, v41, 2, v42
    v_and_b32 v45, 7, v44
    v_lshlrev_b32 v44, 8, v44
    v_lshl_add_u32 v44, v43, 3, v44
    v_add_u32 v44, 65536, v44
    v_xor_b32 v46, 0, v45
    v_lshl_add_u32 v24, v46, 5, v44
    v_xor_b32 v46, 1, v45
    v_lshl_add_u32 v25, v46, 5, v44
    v_xor_b32 v46, 2, v45
    v_lshl_add_u32 v26, v46, 5, v44
    v_xor_b32 v46, 3, v45
    v_lshl_add_u32 v27, v46, 5, v44
    v_xor_b32 v46, 4, v45
    v_lshl_add_u32 v28, v46, 5, v44
    v_xor_b32 v46, 5, v45
    v_lshl_add_u32 v29, v46, 5, v44
    v_xor_b32 v46, 6, v45
    v_lshl_add_u32 v30, v46, 5, v44
    v_xor_b32 v46, 7, v45
    v_lshl_add_u32 v31, v46, 5, v44
    s_lshl_b32 s56, s54, 12
    v_lshlrev_b32 v44, 8, v41
    v_add_u32 v44, s56, v44
    v_add_u32 v45, 0, v41
    v_xor_b32 v45, v45, v40
    v_lshl_add_u32 v32, v45, 4, v44
    v_add_u32 v45, 4, v41
    v_xor_b32 v45, v45, v40
    v_lshl_add_u32 v33, v45, 4, v44
    v_add_u32 v45, 8, v41
    v_xor_b32 v45, v45, v40
    v_lshl_add_u32 v34, v45, 4, v44
    v_add_u32 v45, 12, v41
    v_xor_b32 v45, v45, v40
    v_lshl_add_u32 v35, v45, 4, v44
    v_and_b32 v46, 1, v1
    v_lshl_add_u32 v44, v46, 4, v44
    v_add_u32 v45, 0, v41
    v_lshrrev_b32 v46, 1, v40
    v_xor_b32 v45, v45, v46
    v_lshl_add_u32 v36, v45, 5, v44
    v_add_u32 v45, 4, v41
    v_lshrrev_b32 v46, 1, v40
    v_xor_b32 v45, v45, v46
    v_lshl_add_u32 v37, v45, 5, v44
    s_lshl_b32 s56, s54, 14
    v_add_u32 v38, s56, v2
    s_add_u32 m0, s60, 11520
    s_nop 0
    buffer_load_dwordx4 v47, s[4:7], 0 offen offset:768 lds
    s_add_u32 m0, s60, 12544
    s_nop 0
    buffer_load_dwordx4 v50, s[4:7], 0 offen offset:768 lds
    s_add_u32 m0, s60, 13440
    s_nop 0
    buffer_load_dwordx4 v47, s[4:7], 0 offen offset:896 lds
    s_add_u32 m0, s60, 14464
    s_nop 0
    buffer_load_dwordx4 v50, s[4:7], 0 offen offset:896 lds
    v_lshrrev_b32 v44, 1, v40
    v_xor_b32 v44, v44, v41
    v_lshlrev_b32 v44, 4, v44
    v_lshl_add_u32 v44, v40, 7, v44
    v_add_u32 v47, s60, v44
    v_xor_b32 v50, 64, v47
    s_mov_b32 s56, 0x780000
    s_add_u32 s4, s92, s56
    s_addc_u32 s5, s93, 0
    s_mov_b32 s6, 0x8000
    s_mov_b32 s7, 0x20000
    v_mov_b32 v41, 0x3f803f80
    v_accvgpr_write_b32 a240, v41
    v_accvgpr_write_b32 a241, v41
    v_accvgpr_write_b32 a242, v41
    v_accvgpr_write_b32 a243, v41
    v_and_b32 v41, 3, v1
    v_cmp_eq_u32 s[70:71], 1, v41
    v_cmp_eq_u32 s[72:73], 2, v41
    v_cmp_eq_u32 s[74:75], 3, v41
    v_bfe_u32 v41, v1, 2, 2
    v_lshrrev_b32 v42, 4, v1
    v_cmp_eq_u32 s[68:69], v41, v42
    s_waitcnt vmcnt(16)
    ds_read_b128 v[64:67], v47 offset:0
    ds_read_b128 v[68:71], v50 offset:0
    s_waitcnt vmcnt(14)
    ds_read_b128 v[72:75], v47 offset:2048
    ds_read_b128 v[76:79], v50 offset:2048
    s_waitcnt lgkmcnt(3)
    v_mfma_f32_16x16x32_bf16 v[56:59], a[240:243], v[64:67], 0
    v_lshlrev_b32 v128, 16, v64
    v_and_b32 v129, 0xffff0000, v64
    v_lshlrev_b32 v130, 16, v65
    v_and_b32 v131, 0xffff0000, v65
    v_mfma_f32_16x16x32_bf16 v[60:63], v[64:67], v[64:67], 0
    v_lshlrev_b32 v132, 16, v66
    v_and_b32 v133, 0xffff0000, v66
    v_lshlrev_b32 v134, 16, v67
    v_and_b32 v135, 0xffff0000, v67
    s_waitcnt lgkmcnt(2)
    v_mfma_f32_16x16x32_bf16 v[56:59], a[240:243], v[68:71], v[56:59]
    v_lshlrev_b32 v136, 16, v68
    v_and_b32 v137, 0xffff0000, v68
    v_lshlrev_b32 v138, 16, v69
    v_and_b32 v139, 0xffff0000, v69
    v_mfma_f32_16x16x32_bf16 v[60:63], v[68:71], v[68:71], v[60:63]
    v_lshlrev_b32 v140, 16, v70
    v_and_b32 v141, 0xffff0000, v70
    v_lshlrev_b32 v142, 16, v71
    v_and_b32 v143, 0xffff0000, v71
    s_waitcnt vmcnt(12)
    ds_read_b128 v[80:83], v47 offset:4096
    ds_read_b128 v[84:87], v50 offset:4096
    s_waitcnt lgkmcnt(3)
    v_mfma_f32_16x16x32_bf16 v[56:59], a[240:243], v[72:75], v[56:59]
    v_lshlrev_b32 v144, 16, v72
    v_and_b32 v145, 0xffff0000, v72
    v_lshlrev_b32 v146, 16, v73
    v_and_b32 v147, 0xffff0000, v73
    v_mfma_f32_16x16x32_bf16 v[60:63], v[72:75], v[72:75], v[60:63]
    v_lshlrev_b32 v148, 16, v74
    v_and_b32 v149, 0xffff0000, v74
    v_lshlrev_b32 v150, 16, v75
    v_and_b32 v151, 0xffff0000, v75
    s_waitcnt lgkmcnt(2)
    v_mfma_f32_16x16x32_bf16 v[56:59], a[240:243], v[76:79], v[56:59]
    v_lshlrev_b32 v152, 16, v76
    v_and_b32 v153, 0xffff0000, v76
    v_lshlrev_b32 v154, 16, v77
    v_and_b32 v155, 0xffff0000, v77
    v_mfma_f32_16x16x32_bf16 v[60:63], v[76:79], v[76:79], v[60:63]
    v_lshlrev_b32 v156, 16, v78
    v_and_b32 v157, 0xffff0000, v78
    v_lshlrev_b32 v158, 16, v79
    v_and_b32 v159, 0xffff0000, v79
    s_waitcnt vmcnt(10)
    ds_read_b128 v[88:91], v47 offset:6144
    ds_read_b128 v[92:95], v50 offset:6144
    s_waitcnt lgkmcnt(3)
    v_mfma_f32_16x16x32_bf16 v[56:59], a[240:243], v[80:83], v[56:59]
    s_add_u32 m0, s59, 0
    s_mov_b32 s60, 0
    buffer_load_dwordx4 v16, s[16:19], s60 offen offset:0 lds
    v_lshlrev_b32 v160, 16, v80
    v_and_b32 v161, 0xffff0000, v80
    v_lshlrev_b32 v162, 16, v81
    v_and_b32 v163, 0xffff0000, v81
    v_mfma_f32_16x16x32_bf16 v[60:63], v[80:83], v[80:83], v[60:63]
    v_lshlrev_b32 v164, 16, v82
    v_and_b32 v165, 0xffff0000, v82
    v_lshlrev_b32 v166, 16, v83
    v_and_b32 v167, 0xffff0000, v83
    s_waitcnt lgkmcnt(2)
    v_mfma_f32_16x16x32_bf16 v[56:59], a[240:243], v[84:87], v[56:59]
    buffer_load_dwordx4 v17, s[16:19], s60 offen offset:1024 lds
    v_lshlrev_b32 v168, 16, v84
    v_and_b32 v169, 0xffff0000, v84
    v_lshlrev_b32 v170, 16, v85
    v_and_b32 v171, 0xffff0000, v85
    v_mfma_f32_16x16x32_bf16 v[60:63], v[84:87], v[84:87], v[60:63]
    v_lshlrev_b32 v172, 16, v86
    v_and_b32 v173, 0xffff0000, v86
    v_lshlrev_b32 v174, 16, v87
    v_and_b32 v175, 0xffff0000, v87
    s_waitcnt vmcnt(10)
    ds_read_b128 v[96:99], v47 offset:8192
    ds_read_b128 v[100:103], v50 offset:8192
    s_waitcnt lgkmcnt(3)
    v_mfma_f32_16x16x32_bf16 v[56:59], a[240:243], v[88:91], v[56:59]
    buffer_load_dwordx4 v18, s[16:19], s60 offen offset:2048 lds
    v_lshlrev_b32 v176, 16, v88
    v_and_b32 v177, 0xffff0000, v88
    v_lshlrev_b32 v178, 16, v89
    v_and_b32 v179, 0xffff0000, v89
    v_mfma_f32_16x16x32_bf16 v[60:63], v[88:91], v[88:91], v[60:63]
    v_lshlrev_b32 v180, 16, v90
    v_and_b32 v181, 0xffff0000, v90
    v_lshlrev_b32 v182, 16, v91
    v_and_b32 v183, 0xffff0000, v91
    s_waitcnt lgkmcnt(2)
    v_mfma_f32_16x16x32_bf16 v[56:59], a[240:243], v[92:95], v[56:59]
    buffer_load_dwordx4 v19, s[16:19], s60 offen offset:3072 lds
    v_lshlrev_b32 v184, 16, v92
    v_and_b32 v185, 0xffff0000, v92
    v_lshlrev_b32 v186, 16, v93
    v_and_b32 v187, 0xffff0000, v93
    v_mfma_f32_16x16x32_bf16 v[60:63], v[92:95], v[92:95], v[60:63]
    v_lshlrev_b32 v188, 16, v94
    v_and_b32 v189, 0xffff0000, v94
    v_lshlrev_b32 v190, 16, v95
    v_and_b32 v191, 0xffff0000, v95
    s_waitcnt vmcnt(10)
    ds_read_b128 v[104:107], v47 offset:10240
    ds_read_b128 v[108:111], v50 offset:10240
    s_waitcnt lgkmcnt(3)
    v_mfma_f32_16x16x32_bf16 v[56:59], a[240:243], v[96:99], v[56:59]
    s_add_u32 m0, s59, 16384
    s_mov_b32 s60, 128
    buffer_load_dwordx4 v16, s[16:19], s60 offen offset:0 lds
    v_lshlrev_b32 v192, 16, v96
    v_and_b32 v193, 0xffff0000, v96
    v_lshlrev_b32 v194, 16, v97
    v_and_b32 v195, 0xffff0000, v97
    v_mfma_f32_16x16x32_bf16 v[60:63], v[96:99], v[96:99], v[60:63]
    v_lshlrev_b32 v196, 16, v98
    v_and_b32 v197, 0xffff0000, v98
    v_lshlrev_b32 v198, 16, v99
    v_and_b32 v199, 0xffff0000, v99
    s_waitcnt lgkmcnt(2)
    v_mfma_f32_16x16x32_bf16 v[56:59], a[240:243], v[100:103], v[56:59]
    buffer_load_dwordx4 v17, s[16:19], s60 offen offset:1024 lds
    v_lshlrev_b32 v200, 16, v100
    v_and_b32 v201, 0xffff0000, v100
    v_lshlrev_b32 v202, 16, v101
    v_and_b32 v203, 0xffff0000, v101
    v_mfma_f32_16x16x32_bf16 v[60:63], v[100:103], v[100:103], v[60:63]
    v_lshlrev_b32 v204, 16, v102
    v_and_b32 v205, 0xffff0000, v102
    v_lshlrev_b32 v206, 16, v103
    v_and_b32 v207, 0xffff0000, v103
    s_waitcnt vmcnt(8)
    ds_read_b128 v[112:115], v47 offset:12288
    ds_read_b128 v[116:119], v50 offset:12288
    s_waitcnt lgkmcnt(3)
    v_mfma_f32_16x16x32_bf16 v[56:59], a[240:243], v[104:107], v[56:59]
    buffer_load_dwordx4 v18, s[16:19], s60 offen offset:2048 lds
    v_lshlrev_b32 v208, 16, v104
    v_and_b32 v209, 0xffff0000, v104
    v_lshlrev_b32 v210, 16, v105
    v_and_b32 v211, 0xffff0000, v105
    v_mfma_f32_16x16x32_bf16 v[60:63], v[104:107], v[104:107], v[60:63]
    v_lshlrev_b32 v212, 16, v106
    v_and_b32 v213, 0xffff0000, v106
    v_lshlrev_b32 v214, 16, v107
    v_and_b32 v215, 0xffff0000, v107
    s_waitcnt lgkmcnt(2)
    v_mfma_f32_16x16x32_bf16 v[56:59], a[240:243], v[108:111], v[56:59]
    buffer_load_dwordx4 v19, s[16:19], s60 offen offset:3072 lds
    v_lshlrev_b32 v216, 16, v108
    v_and_b32 v217, 0xffff0000, v108
    v_lshlrev_b32 v218, 16, v109
    v_and_b32 v219, 0xffff0000, v109
    v_mfma_f32_16x16x32_bf16 v[60:63], v[108:111], v[108:111], v[60:63]
    v_lshlrev_b32 v220, 16, v110
    v_and_b32 v221, 0xffff0000, v110
    v_lshlrev_b32 v222, 16, v111
    v_and_b32 v223, 0xffff0000, v111
    s_waitcnt vmcnt(8)
    ds_read_b128 v[120:123], v47 offset:14336
    ds_read_b128 v[124:127], v50 offset:14336
    s_waitcnt lgkmcnt(3)
    v_mfma_f32_16x16x32_bf16 v[56:59], a[240:243], v[112:115], v[56:59]
    s_add_u32 m0, s59, 32768
    s_mov_b32 s60, 262144
    buffer_load_dwordx4 v16, s[16:19], s60 offen offset:0 lds
    v_lshlrev_b32 v224, 16, v112
    v_and_b32 v225, 0xffff0000, v112
    v_lshlrev_b32 v226, 16, v113
    v_and_b32 v227, 0xffff0000, v113
    v_mfma_f32_16x16x32_bf16 v[60:63], v[112:115], v[112:115], v[60:63]
    v_lshlrev_b32 v228, 16, v114
    v_and_b32 v229, 0xffff0000, v114
    v_lshlrev_b32 v230, 16, v115
    v_and_b32 v231, 0xffff0000, v115
    s_waitcnt lgkmcnt(2)
    v_mfma_f32_16x16x32_bf16 v[56:59], a[240:243], v[116:119], v[56:59]
    buffer_load_dwordx4 v17, s[16:19], s60 offen offset:1024 lds
    v_lshlrev_b32 v232, 16, v116
    v_and_b32 v233, 0xffff0000, v116
    v_lshlrev_b32 v234, 16, v117
    v_and_b32 v235, 0xffff0000, v117
    v_mfma_f32_16x16x32_bf16 v[60:63], v[116:119], v[116:119], v[60:63]
    v_lshlrev_b32 v236, 16, v118
    v_and_b32 v237, 0xffff0000, v118
    v_lshlrev_b32 v238, 16, v119
    v_and_b32 v239, 0xffff0000, v119
    s_waitcnt lgkmcnt(1)
    v_mfma_f32_16x16x32_bf16 v[56:59], a[240:243], v[120:123], v[56:59]
    buffer_load_dwordx4 v18, s[16:19], s60 offen offset:2048 lds
    v_lshlrev_b32 v240, 16, v120
    v_and_b32 v241, 0xffff0000, v120
    v_lshlrev_b32 v242, 16, v121
    v_and_b32 v243, 0xffff0000, v121
    v_mfma_f32_16x16x32_bf16 v[60:63], v[120:123], v[120:123], v[60:63]
    v_lshlrev_b32 v244, 16, v122
    v_and_b32 v245, 0xffff0000, v122
    v_lshlrev_b32 v246, 16, v123
    v_and_b32 v247, 0xffff0000, v123
    s_waitcnt lgkmcnt(0)
    v_mfma_f32_16x16x32_bf16 v[56:59], a[240:243], v[124:127], v[56:59]
    buffer_load_dwordx4 v19, s[16:19], s60 offen offset:3072 lds
    v_lshlrev_b32 v248, 16, v124
    v_and_b32 v249, 0xffff0000, v124
    v_lshlrev_b32 v250, 16, v125
    v_and_b32 v251, 0xffff0000, v125
    v_mfma_f32_16x16x32_bf16 v[60:63], v[124:127], v[124:127], v[60:63]
    v_lshlrev_b32 v252, 16, v126
    v_and_b32 v253, 0xffff0000, v126
    v_lshlrev_b32 v254, 16, v127
    v_and_b32 v255, 0xffff0000, v127
    s_nop 2
    v_mul_f32 v40, 0x3b000000, v56
    v_cvt_pk_bf16_f32 v42, v40, v40
    v_lshlrev_b32 v42, 16, v42
    v_mov_b32 v43, v40
    v_cndmask_b32 v60, v60, v61, s[70:71]
    v_cndmask_b32 v60, v60, v62, s[72:73]
    v_cndmask_b32 v60, v60, v63, s[74:75]
    v_cndmask_b32 v40, 0, v60, s[68:69]
    v_mov_b32 v41, v40
    s_nop 1
    v_permlane32_swap_b32 v40, v41
    v_add_f32 v40, v40, v41
    v_mov_b32 v41, v40
    s_nop 1
    v_permlane16_swap_b32 v40, v41
    v_add_f32 v40, v40, v41
    v_mul_f32 v40, 0x3b000000, v40
    v_fma_f32 v40, -v43, v43, v40
    v_max_f32 v40, 0, v40
    v_cvt_pk_bf16_f32 v40, v40, v40
    v_lshlrev_b32 v40, 16, v40
    v_add_f32 v40, 0x3727c5ac, v40
    v_cvt_pk_bf16_f32 v40, v40, v40
    v_lshlrev_b32 v40, 16, v40
    v_sqrt_f32 v40, v40
    s_nop 0
    v_cvt_pk_bf16_f32 v40, v40, v40
    v_lshlrev_b32 v40, 16, v40
    v_rcp_f32 v56, v40
    s_nop 0
    v_mul_f32 v57, -v42, v56
    v_pk_fma_f32 v[128:129], v[128:129], v[56:57], v[56:57] op_sel:[0,0,1] op_sel_hi:[1,0,1]
    v_pk_fma_f32 v[130:131], v[130:131], v[56:57], v[56:57] op_sel:[0,0,1] op_sel_hi:[1,0,1]
    v_pk_fma_f32 v[132:133], v[132:133], v[56:57], v[56:57] op_sel:[0,0,1] op_sel_hi:[1,0,1]
    v_pk_fma_f32 v[134:135], v[134:135], v[56:57], v[56:57] op_sel:[0,0,1] op_sel_hi:[1,0,1]
    v_pk_fma_f32 v[136:137], v[136:137], v[56:57], v[56:57] op_sel:[0,0,1] op_sel_hi:[1,0,1]
    v_pk_fma_f32 v[138:139], v[138:139], v[56:57], v[56:57] op_sel:[0,0,1] op_sel_hi:[1,0,1]
    v_pk_fma_f32 v[140:141], v[140:141], v[56:57], v[56:57] op_sel:[0,0,1] op_sel_hi:[1,0,1]
    v_pk_fma_f32 v[142:143], v[142:143], v[56:57], v[56:57] op_sel:[0,0,1] op_sel_hi:[1,0,1]
    v_cvt_pk_bf16_f32 v64, v128, v129
    v_cvt_pk_bf16_f32 v65, v130, v131
    v_cvt_pk_bf16_f32 v66, v132, v133
    v_cvt_pk_bf16_f32 v67, v134, v135
    v_cvt_pk_bf16_f32 v68, v136, v137
    v_cvt_pk_bf16_f32 v69, v138, v139
    v_cvt_pk_bf16_f32 v70, v140, v141
    v_cvt_pk_bf16_f32 v71, v142, v143
    v_pk_fma_f32 v[144:145], v[144:145], v[56:57], v[56:57] op_sel:[0,0,1] op_sel_hi:[1,0,1]
    v_pk_fma_f32 v[146:147], v[146:147], v[56:57], v[56:57] op_sel:[0,0,1] op_sel_hi:[1,0,1]
    v_pk_fma_f32 v[148:149], v[148:149], v[56:57], v[56:57] op_sel:[0,0,1] op_sel_hi:[1,0,1]
    v_pk_fma_f32 v[150:151], v[150:151], v[56:57], v[56:57] op_sel:[0,0,1] op_sel_hi:[1,0,1]
    v_pk_fma_f32 v[152:153], v[152:153], v[56:57], v[56:57] op_sel:[0,0,1] op_sel_hi:[1,0,1]
    v_pk_fma_f32 v[154:155], v[154:155], v[56:57], v[56:57] op_sel:[0,0,1] op_sel_hi:[1,0,1]
    v_pk_fma_f32 v[156:157], v[156:157], v[56:57], v[56:57] op_sel:[0,0,1] op_sel_hi:[1,0,1]
    v_pk_fma_f32 v[158:159], v[158:159], v[56:57], v[56:57] op_sel:[0,0,1] op_sel_hi:[1,0,1]
    ds_write_b128 v38, v[64:67] offset:0
    ds_write_b128 v38, v[68:71] offset:1024
    v_cvt_pk_bf16_f32 v72, v144, v145
    v_cvt_pk_bf16_f32 v73, v146, v147
    v_cvt_pk_bf16_f32 v74, v148, v149
    v_cvt_pk_bf16_f32 v75, v150, v151
    v_cvt_pk_bf16_f32 v76, v152, v153
    v_cvt_pk_bf16_f32 v77, v154, v155
    v_cvt_pk_bf16_f32 v78, v156, v157
    v_cvt_pk_bf16_f32 v79, v158, v159
    v_pk_fma_f32 v[160:161], v[160:161], v[56:57], v[56:57] op_sel:[0,0,1] op_sel_hi:[1,0,1]
    v_pk_fma_f32 v[162:163], v[162:163], v[56:57], v[56:57] op_sel:[0,0,1] op_sel_hi:[1,0,1]
    v_pk_fma_f32 v[164:165], v[164:165], v[56:57], v[56:57] op_sel:[0,0,1] op_sel_hi:[1,0,1]
    v_pk_fma_f32 v[166:167], v[166:167], v[56:57], v[56:57] op_sel:[0,0,1] op_sel_hi:[1,0,1]
    v_pk_fma_f32 v[168:169], v[168:169], v[56:57], v[56:57] op_sel:[0,0,1] op_sel_hi:[1,0,1]
    v_pk_fma_f32 v[170:171], v[170:171], v[56:57], v[56:57] op_sel:[0,0,1] op_sel_hi:[1,0,1]
    v_pk_fma_f32 v[172:173], v[172:173], v[56:57], v[56:57] op_sel:[0,0,1] op_sel_hi:[1,0,1]
    v_pk_fma_f32 v[174:175], v[174:175], v[56:57], v[56:57] op_sel:[0,0,1] op_sel_hi:[1,0,1]
    ds_write_b128 v38, v[72:75] offset:2048
    ds_write_b128 v38, v[76:79] offset:3072
    v_cvt_pk_bf16_f32 v80, v160, v161
    v_cvt_pk_bf16_f32 v81, v162, v163
    v_cvt_pk_bf16_f32 v82, v164, v165
    v_cvt_pk_bf16_f32 v83, v166, v167
    v_cvt_pk_bf16_f32 v84, v168, v169
    v_cvt_pk_bf16_f32 v85, v170, v171
    v_cvt_pk_bf16_f32 v86, v172, v173
    v_cvt_pk_bf16_f32 v87, v174, v175
    v_pk_fma_f32 v[176:177], v[176:177], v[56:57], v[56:57] op_sel:[0,0,1] op_sel_hi:[1,0,1]
    v_pk_fma_f32 v[178:179], v[178:179], v[56:57], v[56:57] op_sel:[0,0,1] op_sel_hi:[1,0,1]
    v_pk_fma_f32 v[180:181], v[180:181], v[56:57], v[56:57] op_sel:[0,0,1] op_sel_hi:[1,0,1]
    v_pk_fma_f32 v[182:183], v[182:183], v[56:57], v[56:57] op_sel:[0,0,1] op_sel_hi:[1,0,1]
    v_pk_fma_f32 v[184:185], v[184:185], v[56:57], v[56:57] op_sel:[0,0,1] op_sel_hi:[1,0,1]
    v_pk_fma_f32 v[186:187], v[186:187], v[56:57], v[56:57] op_sel:[0,0,1] op_sel_hi:[1,0,1]
    v_pk_fma_f32 v[188:189], v[188:189], v[56:57], v[56:57] op_sel:[0,0,1] op_sel_hi:[1,0,1]
    v_pk_fma_f32 v[190:191], v[190:191], v[56:57], v[56:57] op_sel:[0,0,1] op_sel_hi:[1,0,1]
    ds_write_b128 v38, v[80:83] offset:4096
    ds_write_b128 v38, v[84:87] offset:5120
    v_cvt_pk_bf16_f32 v88, v176, v177
    v_cvt_pk_bf16_f32 v89, v178, v179
    v_cvt_pk_bf16_f32 v90, v180, v181
    v_cvt_pk_bf16_f32 v91, v182, v183
    v_cvt_pk_bf16_f32 v92, v184, v185
    v_cvt_pk_bf16_f32 v93, v186, v187
    v_cvt_pk_bf16_f32 v94, v188, v189
    v_cvt_pk_bf16_f32 v95, v190, v191
    v_pk_fma_f32 v[192:193], v[192:193], v[56:57], v[56:57] op_sel:[0,0,1] op_sel_hi:[1,0,1]
    v_pk_fma_f32 v[194:195], v[194:195], v[56:57], v[56:57] op_sel:[0,0,1] op_sel_hi:[1,0,1]
    v_pk_fma_f32 v[196:197], v[196:197], v[56:57], v[56:57] op_sel:[0,0,1] op_sel_hi:[1,0,1]
    v_pk_fma_f32 v[198:199], v[198:199], v[56:57], v[56:57] op_sel:[0,0,1] op_sel_hi:[1,0,1]
    v_pk_fma_f32 v[200:201], v[200:201], v[56:57], v[56:57] op_sel:[0,0,1] op_sel_hi:[1,0,1]
    v_pk_fma_f32 v[202:203], v[202:203], v[56:57], v[56:57] op_sel:[0,0,1] op_sel_hi:[1,0,1]
    v_pk_fma_f32 v[204:205], v[204:205], v[56:57], v[56:57] op_sel:[0,0,1] op_sel_hi:[1,0,1]
    v_pk_fma_f32 v[206:207], v[206:207], v[56:57], v[56:57] op_sel:[0,0,1] op_sel_hi:[1,0,1]
    ds_write_b128 v38, v[88:91] offset:6144
    ds_write_b128 v38, v[92:95] offset:7168
    v_cvt_pk_bf16_f32 v96, v192, v193
    v_cvt_pk_bf16_f32 v97, v194, v195
    v_cvt_pk_bf16_f32 v98, v196, v197
    v_cvt_pk_bf16_f32 v99, v198, v199
    v_cvt_pk_bf16_f32 v100, v200, v201
    v_cvt_pk_bf16_f32 v101, v202, v203
    v_cvt_pk_bf16_f32 v102, v204, v205
    v_cvt_pk_bf16_f32 v103, v206, v207
    v_pk_fma_f32 v[208:209], v[208:209], v[56:57], v[56:57] op_sel:[0,0,1] op_sel_hi:[1,0,1]
    v_pk_fma_f32 v[210:211], v[210:211], v[56:57], v[56:57] op_sel:[0,0,1] op_sel_hi:[1,0,1]
    v_pk_fma_f32 v[212:213], v[212:213], v[56:57], v[56:57] op_sel:[0,0,1] op_sel_hi:[1,0,1]
    v_pk_fma_f32 v[214:215], v[214:215], v[56:57], v[56:57] op_sel:[0,0,1] op_sel_hi:[1,0,1]
    v_pk_fma_f32 v[216:217], v[216:217], v[56:57], v[56:57] op_sel:[0,0,1] op_sel_hi:[1,0,1]
    v_pk_fma_f32 v[218:219], v[218:219], v[56:57], v[56:57] op_sel:[0,0,1] op_sel_hi:[1,0,1]
    v_pk_fma_f32 v[220:221], v[220:221], v[56:57], v[56:57] op_sel:[0,0,1] op_sel_hi:[1,0,1]
    v_pk_fma_f32 v[222:223], v[222:223], v[56:57], v[56:57] op_sel:[0,0,1] op_sel_hi:[1,0,1]
    ds_write_b128 v38, v[96:99] offset:8192
    ds_write_b128 v38, v[100:103] offset:9216
    v_cvt_pk_bf16_f32 v104, v208, v209
    v_cvt_pk_bf16_f32 v105, v210, v211
    v_cvt_pk_bf16_f32 v106, v212, v213
    v_cvt_pk_bf16_f32 v107, v214, v215
    v_cvt_pk_bf16_f32 v108, v216, v217
    v_cvt_pk_bf16_f32 v109, v218, v219
    v_cvt_pk_bf16_f32 v110, v220, v221
    v_cvt_pk_bf16_f32 v111, v222, v223
    v_pk_fma_f32 v[224:225], v[224:225], v[56:57], v[56:57] op_sel:[0,0,1] op_sel_hi:[1,0,1]
    v_pk_fma_f32 v[226:227], v[226:227], v[56:57], v[56:57] op_sel:[0,0,1] op_sel_hi:[1,0,1]
    v_pk_fma_f32 v[228:229], v[228:229], v[56:57], v[56:57] op_sel:[0,0,1] op_sel_hi:[1,0,1]
    v_pk_fma_f32 v[230:231], v[230:231], v[56:57], v[56:57] op_sel:[0,0,1] op_sel_hi:[1,0,1]
    v_pk_fma_f32 v[232:233], v[232:233], v[56:57], v[56:57] op_sel:[0,0,1] op_sel_hi:[1,0,1]
    v_pk_fma_f32 v[234:235], v[234:235], v[56:57], v[56:57] op_sel:[0,0,1] op_sel_hi:[1,0,1]
    v_pk_fma_f32 v[236:237], v[236:237], v[56:57], v[56:57] op_sel:[0,0,1] op_sel_hi:[1,0,1]
    v_pk_fma_f32 v[238:239], v[238:239], v[56:57], v[56:57] op_sel:[0,0,1] op_sel_hi:[1,0,1]
    ds_write_b128 v38, v[104:107] offset:10240
    ds_write_b128 v38, v[108:111] offset:11264
    v_cvt_pk_bf16_f32 v112, v224, v225
    v_cvt_pk_bf16_f32 v113, v226, v227
    v_cvt_pk_bf16_f32 v114, v228, v229
    v_cvt_pk_bf16_f32 v115, v230, v231
    v_cvt_pk_bf16_f32 v116, v232, v233
    v_cvt_pk_bf16_f32 v117, v234, v235
    v_cvt_pk_bf16_f32 v118, v236, v237
    v_cvt_pk_bf16_f32 v119, v238, v239
    v_pk_fma_f32 v[240:241], v[240:241], v[56:57], v[56:57] op_sel:[0,0,1] op_sel_hi:[1,0,1]
    v_pk_fma_f32 v[242:243], v[242:243], v[56:57], v[56:57] op_sel:[0,0,1] op_sel_hi:[1,0,1]
    v_pk_fma_f32 v[244:245], v[244:245], v[56:57], v[56:57] op_sel:[0,0,1] op_sel_hi:[1,0,1]
    v_pk_fma_f32 v[246:247], v[246:247], v[56:57], v[56:57] op_sel:[0,0,1] op_sel_hi:[1,0,1]
    v_pk_fma_f32 v[248:249], v[248:249], v[56:57], v[56:57] op_sel:[0,0,1] op_sel_hi:[1,0,1]
    v_pk_fma_f32 v[250:251], v[250:251], v[56:57], v[56:57] op_sel:[0,0,1] op_sel_hi:[1,0,1]
    v_pk_fma_f32 v[252:253], v[252:253], v[56:57], v[56:57] op_sel:[0,0,1] op_sel_hi:[1,0,1]
    v_pk_fma_f32 v[254:255], v[254:255], v[56:57], v[56:57] op_sel:[0,0,1] op_sel_hi:[1,0,1]
    ds_write_b128 v38, v[112:115] offset:12288
    ds_write_b128 v38, v[116:119] offset:13312
    v_cvt_pk_bf16_f32 v120, v240, v241
    v_cvt_pk_bf16_f32 v121, v242, v243
    v_cvt_pk_bf16_f32 v122, v244, v245
    v_cvt_pk_bf16_f32 v123, v246, v247
    v_cvt_pk_bf16_f32 v124, v248, v249
    v_cvt_pk_bf16_f32 v125, v250, v251
    v_cvt_pk_bf16_f32 v126, v252, v253
    v_cvt_pk_bf16_f32 v127, v254, v255
    ds_write_b128 v38, v[120:123] offset:14336
    ds_write_b128 v38, v[124:127] offset:15360
    s_add_u32 m0, s59, 49152
    s_mov_b32 s60, 262272
    buffer_load_dwordx4 v16, s[16:19], s60 offen offset:0 lds
    buffer_load_dwordx4 v17, s[16:19], s60 offen offset:1024 lds
    buffer_load_dwordx4 v18, s[16:19], s60 offen offset:2048 lds
    buffer_load_dwordx4 v19, s[16:19], s60 offen offset:3072 lds
    s_add_u32 m0, s59, 65536
    s_mov_b32 s60, 524288
    buffer_load_dwordx4 v16, s[16:19], s60 offen offset:0 lds
    buffer_load_dwordx4 v17, s[16:19], s60 offen offset:1024 lds
    buffer_load_dwordx4 v18, s[16:19], s60 offen offset:2048 lds
    buffer_load_dwordx4 v19, s[16:19], s60 offen offset:3072 lds
    s_add_u32 m0, s59, 81920
    s_mov_b32 s60, 524416
    buffer_load_dwordx4 v16, s[16:19], s60 offen offset:0 lds
    buffer_load_dwordx4 v17, s[16:19], s60 offen offset:1024 lds
    buffer_load_dwordx4 v18, s[16:19], s60 offen offset:2048 lds
    buffer_load_dwordx4 v19, s[16:19], s60 offen offset:3072 lds
    s_mov_b64 exec, 0xfffffff
    global_load_dword v49, v54, s[100:101]
    s_mov_b64 exec, -1
    s_waitcnt lgkmcnt(0)
    s_barrier
    s_and_b32 s55, s52, 1
    s_lshl_b32 s55, s55, 2
    s_add_u32 s55, s55, s54
    s_cmp_eq_u32 s55, 7
    s_cselect_b32 s68, 0x40000, 0
    v_add_u32 v50, s68, v2
    s_and_b32 s55, s52, 1
    s_lshl_b32 s55, s55, 2
    s_add_u32 s55, s55, s54
    s_cmp_eq_u32 s55, 3
    s_cselect_b32 s69, 0x40000, 0
    v_add_u32 v51, s69, v2
    s_waitcnt vmcnt(21)
    ds_read_b64_tr_b16 a[128:129], v4 offset:0
    ds_read_b64_tr_b16 a[130:131], v4 offset:512
    ds_read_b64_tr_b16 a[132:133], v5 offset:0
    ds_read_b64_tr_b16 a[134:135], v5 offset:512
    ds_read_b64_tr_b16 a[136:137], v6 offset:0
    ds_read_b64_tr_b16 a[138:139], v6 offset:512
    ds_read_b128 a[160:163], v2 offset:0
    ds_read_b128 a[164:167], v2 offset:16384
    ds_read_b128 a[168:171], v2 offset:32768
    ds_read_b128 a[172:175], v2 offset:49152
    s_waitcnt lgkmcnt(0)
    v_mfma_f32_16x16x32_bf16 a[0:3], a[128:131], a[160:163], 0
    ds_read_b64_tr_b16 a[140:141], v7 offset:0
    v_mfma_f32_16x16x32_bf16 a[4:7], a[128:131], a[164:167], 0
    ds_read_b64_tr_b16 a[142:143], v7 offset:512
    v_mfma_f32_16x16x32_bf16 a[8:11], a[128:131], a[168:171], 0
    v_mfma_f32_16x16x32_bf16 a[12:15], a[128:131], a[172:175], 0
    v_mfma_f32_16x16x32_bf16 a[28:31], a[132:135], a[172:175], 0
    s_waitcnt vmcnt(17)
    ds_read_b64_tr_b16 a[144:145], v4 offset:16384
    v_mfma_f32_16x16x32_bf16 a[24:27], a[132:135], a[168:171], 0
    ds_read_b64_tr_b16 a[146:147], v4 offset:16896
    v_mfma_f32_16x16x32_bf16 a[20:23], a[132:135], a[164:167], 0
    ds_read_b128 a[176:179], v2 offset:1024
    v_mfma_f32_16x16x32_bf16 a[16:19], a[132:135], a[160:163], 0
    v_mfma_f32_16x16x32_bf16 a[32:35], a[136:139], a[160:163], 0
    ds_read_b64_tr_b16 a[148:149], v5 offset:16384
    v_mfma_f32_16x16x32_bf16 a[36:39], a[136:139], a[164:167], 0
    ds_read_b64_tr_b16 a[150:151], v5 offset:16896
    v_mfma_f32_16x16x32_bf16 a[40:43], a[136:139], a[168:171], 0
    ds_read_b128 a[180:183], v2 offset:17408
    v_mfma_f32_16x16x32_bf16 a[44:47], a[136:139], a[172:175], 0
    s_waitcnt lgkmcnt(6)
    v_mfma_f32_16x16x32_bf16 a[60:63], a[140:143], a[172:175], 0
    ds_read_b64_tr_b16 a[152:153], v6 offset:16384
    v_mfma_f32_16x16x32_bf16 a[56:59], a[140:143], a[168:171], 0
    ds_read_b64_tr_b16 a[154:155], v6 offset:16896
    v_mfma_f32_16x16x32_bf16 a[52:55], a[140:143], a[164:167], 0
    ds_read_b128 a[184:187], v2 offset:33792
    v_mfma_f32_16x16x32_bf16 a[48:51], a[140:143], a[160:163], 0
    s_waitcnt lgkmcnt(7)
    v_mfma_f32_16x16x32_bf16 a[64:67], a[144:147], a[160:163], 0
    ds_read_b64_tr_b16 a[156:157], v7 offset:16384
    v_mfma_f32_16x16x32_bf16 a[68:71], a[144:147], a[164:167], 0
    ds_read_b64_tr_b16 a[158:159], v7 offset:16896
    v_mfma_f32_16x16x32_bf16 a[72:75], a[144:147], a[168:171], 0
    s_add_u32 m0, s59, 0
    s_mov_b32 s60, 786432
    ds_read_b128 a[188:191], v2 offset:50176
    v_mfma_f32_16x16x32_bf16 a[76:79], a[144:147], a[172:175], 0
    s_waitcnt lgkmcnt(7)
    buffer_load_dwordx4 v16, s[16:19], s60 offen offset:0 lds
    v_mfma_f32_16x16x32_bf16 a[92:95], a[148:151], a[172:175], 0
    s_waitcnt vmcnt(14)
    ds_read_b64_tr_b16 a[128:129], v4 offset:32768
    v_mfma_f32_16x16x32_bf16 a[88:91], a[148:151], a[168:171], 0
    ds_read_b64_tr_b16 a[130:131], v4 offset:33280
    v_mfma_f32_16x16x32_bf16 a[84:87], a[148:151], a[164:167], 0
    v_mfma_f32_16x16x32_bf16 a[80:83], a[148:151], a[160:163], 0
    s_waitcnt lgkmcnt(6)
    buffer_load_dwordx4 v17, s[16:19], s60 offen offset:1024 lds
    v_mfma_f32_16x16x32_bf16 a[96:99], a[152:155], a[160:163], 0
    ds_read_b64_tr_b16 a[132:133], v5 offset:32768
    v_mfma_f32_16x16x32_bf16 a[100:103], a[152:155], a[164:167], 0
    ds_read_b64_tr_b16 a[134:135], v5 offset:33280
    v_mfma_f32_16x16x32_bf16 a[104:107], a[152:155], a[168:171], 0
    v_mfma_f32_16x16x32_bf16 a[108:111], a[152:155], a[172:175], 0
    s_waitcnt lgkmcnt(5)
    buffer_load_dwordx4 v18, s[16:19], s60 offen offset:2048 lds
    v_mfma_f32_16x16x32_bf16 a[124:127], a[156:159], a[172:175], 0
    ds_read_b64_tr_b16 a[136:137], v6 offset:32768
    v_mfma_f32_16x16x32_bf16 a[120:123], a[156:159], a[168:171], 0
    ds_read_b64_tr_b16 a[138:139], v6 offset:33280
    v_mfma_f32_16x16x32_bf16 a[116:119], a[156:159], a[164:167], 0
    v_mfma_f32_16x16x32_bf16 a[112:115], a[156:159], a[160:163], 0
    s_waitcnt lgkmcnt(4)
    buffer_load_dwordx4 v19, s[16:19], s60 offen offset:3072 lds
    v_mfma_f32_16x16x32_bf16 a[0:3], a[128:131], a[176:179], a[0:3]
    ds_read_b64_tr_b16 a[140:141], v7 offset:32768
    v_mfma_f32_16x16x32_bf16 a[4:7], a[128:131], a[180:183], a[4:7]
    ds_read_b64_tr_b16 a[142:143], v7 offset:33280
    v_mfma_f32_16x16x32_bf16 a[8:11], a[128:131], a[184:187], a[8:11]
    s_add_u32 m0, s59, 16384
    s_mov_b32 s60, 786560
    v_mfma_f32_16x16x32_bf16 a[12:15], a[128:131], a[188:191], a[12:15]
    s_waitcnt lgkmcnt(4)
    buffer_load_dwordx4 v16, s[16:19], s60 offen offset:0 lds
    v_mfma_f32_16x16x32_bf16 a[28:31], a[132:135], a[188:191], a[28:31]
    s_waitcnt vmcnt(14)
    ds_read_b64_tr_b16 a[144:145], v8 offset:0
    v_mfma_f32_16x16x32_bf16 a[24:27], a[132:135], a[184:187], a[24:27]
    ds_read_b64_tr_b16 a[146:147], v8 offset:512
    v_mfma_f32_16x16x32_bf16 a[20:23], a[132:135], a[180:183], a[20:23]
    ds_read_b128 a[160:163], v2 offset:2048
    v_mfma_f32_16x16x32_bf16 a[16:19], a[132:135], a[176:179], a[16:19]
    s_waitcnt lgkmcnt(5)
    buffer_load_dwordx4 v17, s[16:19], s60 offen offset:1024 lds
    v_mfma_f32_16x16x32_bf16 a[32:35], a[136:139], a[176:179], a[32:35]
    ds_read_b64_tr_b16 a[148:149], v9 offset:0
    v_mfma_f32_16x16x32_bf16 a[36:39], a[136:139], a[180:183], a[36:39]
    ds_read_b64_tr_b16 a[150:151], v9 offset:512
    v_mfma_f32_16x16x32_bf16 a[40:43], a[136:139], a[184:187], a[40:43]
    ds_read_b128 a[164:167], v2 offset:18432
    v_mfma_f32_16x16x32_bf16 a[44:47], a[136:139], a[188:191], a[44:47]
    s_waitcnt lgkmcnt(6)
    buffer_load_dwordx4 v18, s[16:19], s60 offen offset:2048 lds
    v_mfma_f32_16x16x32_bf16 a[60:63], a[140:143], a[188:191], a[60:63]
    ds_read_b64_tr_b16 a[152:153], v10 offset:0
    v_mfma_f32_16x16x32_bf16 a[56:59], a[140:143], a[184:187], a[56:59]
    ds_read_b64_tr_b16 a[154:155], v10 offset:512
    v_mfma_f32_16x16x32_bf16 a[52:55], a[140:143], a[180:183], a[52:55]
    ds_read_b128 a[168:171], v2 offset:34816
    v_mfma_f32_16x16x32_bf16 a[48:51], a[140:143], a[176:179], a[48:51]
    s_waitcnt lgkmcnt(7)
    buffer_load_dwordx4 v19, s[16:19], s60 offen offset:3072 lds
    v_mfma_f32_16x16x32_bf16 a[64:67], a[144:147], a[176:179], a[64:67]
    ds_read_b64_tr_b16 a[156:157], v11 offset:0
    v_mfma_f32_16x16x32_bf16 a[68:71], a[144:147], a[180:183], a[68:71]
    ds_read_b64_tr_b16 a[158:159], v11 offset:512
    v_mfma_f32_16x16x32_bf16 a[72:75], a[144:147], a[184:187], a[72:75]
    s_add_u32 m0, s59, 32768
    s_mov_b32 s60, 1048576
    ds_read_b128 a[172:175], v2 offset:51200
    v_mfma_f32_16x16x32_bf16 a[76:79], a[144:147], a[188:191], a[76:79]
    s_waitcnt lgkmcnt(7)
    buffer_load_dwordx4 v16, s[16:19], s60 offen offset:0 lds
    v_mfma_f32_16x16x32_bf16 a[92:95], a[148:151], a[188:191], a[92:95]
    s_waitcnt vmcnt(14)
    ds_read_b64_tr_b16 a[128:129], v8 offset:16384
    v_mfma_f32_16x16x32_bf16 a[88:91], a[148:151], a[184:187], a[88:91]
    ds_read_b64_tr_b16 a[130:131], v8 offset:16896
    v_mfma_f32_16x16x32_bf16 a[84:87], a[148:151], a[180:183], a[84:87]
    v_mfma_f32_16x16x32_bf16 a[80:83], a[148:151], a[176:179], a[80:83]
    s_waitcnt lgkmcnt(6)
    buffer_load_dwordx4 v17, s[16:19], s60 offen offset:1024 lds
    v_mfma_f32_16x16x32_bf16 a[96:99], a[152:155], a[176:179], a[96:99]
    ds_read_b64_tr_b16 a[132:133], v9 offset:16384
    v_mfma_f32_16x16x32_bf16 a[100:103], a[152:155], a[180:183], a[100:103]
    ds_read_b64_tr_b16 a[134:135], v9 offset:16896
    v_mfma_f32_16x16x32_bf16 a[104:107], a[152:155], a[184:187], a[104:107]
    v_mfma_f32_16x16x32_bf16 a[108:111], a[152:155], a[188:191], a[108:111]
    s_waitcnt lgkmcnt(5)
    buffer_load_dwordx4 v18, s[16:19], s60 offen offset:2048 lds
    v_mfma_f32_16x16x32_bf16 a[124:127], a[156:159], a[188:191], a[124:127]
    ds_read_b64_tr_b16 a[136:137], v10 offset:16384
    v_mfma_f32_16x16x32_bf16 a[120:123], a[156:159], a[184:187], a[120:123]
    ds_read_b64_tr_b16 a[138:139], v10 offset:16896
    v_mfma_f32_16x16x32_bf16 a[116:119], a[156:159], a[180:183], a[116:119]
    v_mfma_f32_16x16x32_bf16 a[112:115], a[156:159], a[176:179], a[112:115]
    s_waitcnt lgkmcnt(4)
    buffer_load_dwordx4 v19, s[16:19], s60 offen offset:3072 lds
    v_mfma_f32_16x16x32_bf16 a[0:3], a[128:131], a[160:163], a[0:3]
    ds_read_b64_tr_b16 a[140:141], v11 offset:16384
    v_mfma_f32_16x16x32_bf16 a[4:7], a[128:131], a[164:167], a[4:7]
    ds_read_b64_tr_b16 a[142:143], v11 offset:16896
    v_mfma_f32_16x16x32_bf16 a[8:11], a[128:131], a[168:171], a[8:11]
    s_add_u32 m0, s59, 49152
    s_mov_b32 s60, 1048704
    v_mfma_f32_16x16x32_bf16 a[12:15], a[128:131], a[172:175], a[12:15]
    s_waitcnt lgkmcnt(4)
    buffer_load_dwordx4 v16, s[16:19], s60 offen offset:0 lds
    v_mfma_f32_16x16x32_bf16 a[28:31], a[132:135], a[172:175], a[28:31]
    s_waitcnt vmcnt(14)
    ds_read_b64_tr_b16 a[144:145], v8 offset:32768
    v_mfma_f32_16x16x32_bf16 a[24:27], a[132:135], a[168:171], a[24:27]
    ds_read_b64_tr_b16 a[146:147], v8 offset:33280
    v_mfma_f32_16x16x32_bf16 a[20:23], a[132:135], a[164:167], a[20:23]
    ds_read_b128 a[176:179], v2 offset:3072
    v_mfma_f32_16x16x32_bf16 a[16:19], a[132:135], a[160:163], a[16:19]
    s_waitcnt lgkmcnt(5)
    buffer_load_dwordx4 v17, s[16:19], s60 offen offset:1024 lds
    v_mfma_f32_16x16x32_bf16 a[32:35], a[136:139], a[160:163], a[32:35]
    ds_read_b64_tr_b16 a[148:149], v9 offset:32768
    v_mfma_f32_16x16x32_bf16 a[36:39], a[136:139], a[164:167], a[36:39]
    ds_read_b64_tr_b16 a[150:151], v9 offset:33280
    v_mfma_f32_16x16x32_bf16 a[40:43], a[136:139], a[168:171], a[40:43]
    ds_read_b128 a[180:183], v2 offset:19456
    v_mfma_f32_16x16x32_bf16 a[44:47], a[136:139], a[172:175], a[44:47]
    s_waitcnt lgkmcnt(6)
    buffer_load_dwordx4 v18, s[16:19], s60 offen offset:2048 lds
    v_mfma_f32_16x16x32_bf16 a[60:63], a[140:143], a[172:175], a[60:63]
    ds_read_b64_tr_b16 a[152:153], v10 offset:32768
    v_mfma_f32_16x16x32_bf16 a[56:59], a[140:143], a[168:171], a[56:59]
    ds_read_b64_tr_b16 a[154:155], v10 offset:33280
    v_mfma_f32_16x16x32_bf16 a[52:55], a[140:143], a[164:167], a[52:55]
    ds_read_b128 a[184:187], v2 offset:35840
    v_mfma_f32_16x16x32_bf16 a[48:51], a[140:143], a[160:163], a[48:51]
    s_waitcnt lgkmcnt(7)
    buffer_load_dwordx4 v19, s[16:19], s60 offen offset:3072 lds
    v_mfma_f32_16x16x32_bf16 a[64:67], a[144:147], a[160:163], a[64:67]
    ds_read_b64_tr_b16 a[156:157], v11 offset:32768
    v_mfma_f32_16x16x32_bf16 a[68:71], a[144:147], a[164:167], a[68:71]
    ds_read_b64_tr_b16 a[158:159], v11 offset:33280
    v_mfma_f32_16x16x32_bf16 a[72:75], a[144:147], a[168:171], a[72:75]
    s_add_u32 m0, s59, 65536
    s_mov_b32 s60, 1310720
    ds_read_b128 a[188:191], v2 offset:52224
    v_mfma_f32_16x16x32_bf16 a[76:79], a[144:147], a[172:175], a[76:79]
    s_waitcnt lgkmcnt(7)
    buffer_load_dwordx4 v16, s[16:19], s60 offen offset:0 lds
    v_mfma_f32_16x16x32_bf16 a[92:95], a[148:151], a[172:175], a[92:95]
    s_waitcnt vmcnt(13)
    ds_read_b64_tr_b16 a[128:129], v4 offset:0
    v_mfma_f32_16x16x32_bf16 a[88:91], a[148:151], a[168:171], a[88:91]
    ds_read_b64_tr_b16 a[130:131], v4 offset:512
    v_mfma_f32_16x16x32_bf16 a[84:87], a[148:151], a[164:167], a[84:87]
    v_mfma_f32_16x16x32_bf16 a[80:83], a[148:151], a[160:163], a[80:83]
    s_waitcnt lgkmcnt(6)
    buffer_load_dwordx4 v17, s[16:19], s60 offen offset:1024 lds
    v_mfma_f32_16x16x32_bf16 a[96:99], a[152:155], a[160:163], a[96:99]
    ds_read_b64_tr_b16 a[132:133], v5 offset:0
    v_mfma_f32_16x16x32_bf16 a[100:103], a[152:155], a[164:167], a[100:103]
    ds_read_b64_tr_b16 a[134:135], v5 offset:512
    v_mfma_f32_16x16x32_bf16 a[104:107], a[152:155], a[168:171], a[104:107]
    v_mfma_f32_16x16x32_bf16 a[108:111], a[152:155], a[172:175], a[108:111]
    s_waitcnt lgkmcnt(5)
    buffer_load_dwordx4 v18, s[16:19], s60 offen offset:2048 lds
    v_mfma_f32_16x16x32_bf16 a[124:127], a[156:159], a[172:175], a[124:127]
    ds_read_b64_tr_b16 a[136:137], v6 offset:0
    v_mfma_f32_16x16x32_bf16 a[120:123], a[156:159], a[168:171], a[120:123]
    ds_read_b64_tr_b16 a[138:139], v6 offset:512
    v_mfma_f32_16x16x32_bf16 a[116:119], a[156:159], a[164:167], a[116:119]
    v_mfma_f32_16x16x32_bf16 a[112:115], a[156:159], a[160:163], a[112:115]
    s_waitcnt lgkmcnt(4)
    buffer_load_dwordx4 v19, s[16:19], s60 offen offset:3072 lds
    v_mfma_f32_16x16x32_bf16 a[0:3], a[128:131], a[176:179], a[0:3]
    ds_read_b64_tr_b16 a[140:141], v7 offset:0
    v_mfma_f32_16x16x32_bf16 a[4:7], a[128:131], a[180:183], a[4:7]
    ds_read_b64_tr_b16 a[142:143], v7 offset:512
    v_mfma_f32_16x16x32_bf16 a[8:11], a[128:131], a[184:187], a[8:11]
    s_add_u32 m0, s59, 81920
    s_mov_b32 s60, 1310848
    v_mfma_f32_16x16x32_bf16 a[12:15], a[128:131], a[188:191], a[12:15]
    s_waitcnt lgkmcnt(4)
    buffer_load_dwordx4 v16, s[16:19], s60 offen offset:0 lds
    v_mfma_f32_16x16x32_bf16 a[28:31], a[132:135], a[188:191], a[28:31]
    s_waitcnt vmcnt(13)
    ds_read_b64_tr_b16 a[144:145], v4 offset:16384
    v_mfma_f32_16x16x32_bf16 a[24:27], a[132:135], a[184:187], a[24:27]
    ds_read_b64_tr_b16 a[146:147], v4 offset:16896
    v_mfma_f32_16x16x32_bf16 a[20:23], a[132:135], a[180:183], a[20:23]
    ds_read_b128 a[160:163], v2 offset:4096
    v_mfma_f32_16x16x32_bf16 a[16:19], a[132:135], a[176:179], a[16:19]
    s_waitcnt lgkmcnt(5)
    buffer_load_dwordx4 v17, s[16:19], s60 offen offset:1024 lds
    v_mfma_f32_16x16x32_bf16 a[32:35], a[136:139], a[176:179], a[32:35]
    ds_read_b64_tr_b16 a[148:149], v5 offset:16384
    v_mfma_f32_16x16x32_bf16 a[36:39], a[136:139], a[180:183], a[36:39]
    ds_read_b64_tr_b16 a[150:151], v5 offset:16896
    v_mfma_f32_16x16x32_bf16 a[40:43], a[136:139], a[184:187], a[40:43]
    ds_read_b128 a[164:167], v2 offset:20480
    v_mfma_f32_16x16x32_bf16 a[44:47], a[136:139], a[188:191], a[44:47]
    s_waitcnt lgkmcnt(6)
    buffer_load_dwordx4 v18, s[16:19], s60 offen offset:2048 lds
    v_mfma_f32_16x16x32_bf16 a[60:63], a[140:143], a[188:191], a[60:63]
    ds_read_b64_tr_b16 a[152:153], v6 offset:16384
    v_mfma_f32_16x16x32_bf16 a[56:59], a[140:143], a[184:187], a[56:59]
    ds_read_b64_tr_b16 a[154:155], v6 offset:16896
    v_mfma_f32_16x16x32_bf16 a[52:55], a[140:143], a[180:183], a[52:55]
    ds_read_b128 a[168:171], v2 offset:36864
    v_mfma_f32_16x16x32_bf16 a[48:51], a[140:143], a[176:179], a[48:51]
    s_waitcnt lgkmcnt(7)
    buffer_load_dwordx4 v19, s[16:19], s60 offen offset:3072 lds
    v_mfma_f32_16x16x32_bf16 a[64:67], a[144:147], a[176:179], a[64:67]
    ds_read_b64_tr_b16 a[156:157], v7 offset:16384
    v_mfma_f32_16x16x32_bf16 a[68:71], a[144:147], a[180:183], a[68:71]
    ds_read_b64_tr_b16 a[158:159], v7 offset:16896
    v_mfma_f32_16x16x32_bf16 a[72:75], a[144:147], a[184:187], a[72:75]
    s_add_u32 m0, s59, 0
    s_mov_b32 s60, 1572864
    ds_read_b128 a[172:175], v2 offset:53248
    v_mfma_f32_16x16x32_bf16 a[76:79], a[144:147], a[188:191], a[76:79]
    s_waitcnt lgkmcnt(7)
    buffer_load_dwordx4 v16, s[16:19], s60 offen offset:0 lds
    v_mfma_f32_16x16x32_bf16 a[92:95], a[148:151], a[188:191], a[92:95]
    s_waitcnt vmcnt(13)
    ds_read_b64_tr_b16 a[128:129], v4 offset:32768
    v_mfma_f32_16x16x32_bf16 a[88:91], a[148:151], a[184:187], a[88:91]
    ds_read_b64_tr_b16 a[130:131], v4 offset:33280
    v_mfma_f32_16x16x32_bf16 a[84:87], a[148:151], a[180:183], a[84:87]
    v_mfma_f32_16x16x32_bf16 a[80:83], a[148:151], a[176:179], a[80:83]
    s_waitcnt lgkmcnt(6)
    buffer_load_dwordx4 v17, s[16:19], s60 offen offset:1024 lds
    v_mfma_f32_16x16x32_bf16 a[96:99], a[152:155], a[176:179], a[96:99]
    ds_read_b64_tr_b16 a[132:133], v5 offset:32768
    v_mfma_f32_16x16x32_bf16 a[100:103], a[152:155], a[180:183], a[100:103]
    ds_read_b64_tr_b16 a[134:135], v5 offset:33280
    v_mfma_f32_16x16x32_bf16 a[104:107], a[152:155], a[184:187], a[104:107]
    v_mfma_f32_16x16x32_bf16 a[108:111], a[152:155], a[188:191], a[108:111]
    s_waitcnt lgkmcnt(5)
    buffer_load_dwordx4 v18, s[16:19], s60 offen offset:2048 lds
    v_mfma_f32_16x16x32_bf16 a[124:127], a[156:159], a[188:191], a[124:127]
    ds_read_b64_tr_b16 a[136:137], v6 offset:32768
    v_mfma_f32_16x16x32_bf16 a[120:123], a[156:159], a[184:187], a[120:123]
    ds_read_b64_tr_b16 a[138:139], v6 offset:33280
    v_mfma_f32_16x16x32_bf16 a[116:119], a[156:159], a[180:183], a[116:119]
    v_mfma_f32_16x16x32_bf16 a[112:115], a[156:159], a[176:179], a[112:115]
    s_waitcnt lgkmcnt(4)
    buffer_load_dwordx4 v19, s[16:19], s60 offen offset:3072 lds
    v_mfma_f32_16x16x32_bf16 a[0:3], a[128:131], a[160:163], a[0:3]
    ds_read_b64_tr_b16 a[140:141], v7 offset:32768
    v_mfma_f32_16x16x32_bf16 a[4:7], a[128:131], a[164:167], a[4:7]
    ds_read_b64_tr_b16 a[142:143], v7 offset:33280
    v_mfma_f32_16x16x32_bf16 a[8:11], a[128:131], a[168:171], a[8:11]
    s_add_u32 m0, s59, 16384
    s_mov_b32 s60, 1572992
    v_mfma_f32_16x16x32_bf16 a[12:15], a[128:131], a[172:175], a[12:15]
    s_waitcnt lgkmcnt(4)
    buffer_load_dwordx4 v16, s[16:19], s60 offen offset:0 lds
    v_mfma_f32_16x16x32_bf16 a[28:31], a[132:135], a[172:175], a[28:31]
    s_waitcnt vmcnt(13)
    ds_read_b64_tr_b16 a[144:145], v8 offset:0
    v_mfma_f32_16x16x32_bf16 a[24:27], a[132:135], a[168:171], a[24:27]
    ds_read_b64_tr_b16 a[146:147], v8 offset:512
    v_mfma_f32_16x16x32_bf16 a[20:23], a[132:135], a[164:167], a[20:23]
    ds_read_b128 a[176:179], v2 offset:5120
    v_mfma_f32_16x16x32_bf16 a[16:19], a[132:135], a[160:163], a[16:19]
    s_waitcnt lgkmcnt(5)
    buffer_load_dwordx4 v17, s[16:19], s60 offen offset:1024 lds
    v_mfma_f32_16x16x32_bf16 a[32:35], a[136:139], a[160:163], a[32:35]
    ds_read_b64_tr_b16 a[148:149], v9 offset:0
    v_mfma_f32_16x16x32_bf16 a[36:39], a[136:139], a[164:167], a[36:39]
    ds_read_b64_tr_b16 a[150:151], v9 offset:512
    v_mfma_f32_16x16x32_bf16 a[40:43], a[136:139], a[168:171], a[40:43]
    ds_read_b128 a[180:183], v2 offset:21504
    v_mfma_f32_16x16x32_bf16 a[44:47], a[136:139], a[172:175], a[44:47]
    s_waitcnt lgkmcnt(6)
    buffer_load_dwordx4 v18, s[16:19], s60 offen offset:2048 lds
    v_mfma_f32_16x16x32_bf16 a[60:63], a[140:143], a[172:175], a[60:63]
    ds_read_b64_tr_b16 a[152:153], v10 offset:0
    v_mfma_f32_16x16x32_bf16 a[56:59], a[140:143], a[168:171], a[56:59]
    ds_read_b64_tr_b16 a[154:155], v10 offset:512
    v_mfma_f32_16x16x32_bf16 a[52:55], a[140:143], a[164:167], a[52:55]
    ds_read_b128 a[184:187], v2 offset:37888
    v_mfma_f32_16x16x32_bf16 a[48:51], a[140:143], a[160:163], a[48:51]
    s_waitcnt lgkmcnt(7)
    buffer_load_dwordx4 v19, s[16:19], s60 offen offset:3072 lds
    v_mfma_f32_16x16x32_bf16 a[64:67], a[144:147], a[160:163], a[64:67]
    ds_read_b64_tr_b16 a[156:157], v11 offset:0
    v_mfma_f32_16x16x32_bf16 a[68:71], a[144:147], a[164:167], a[68:71]
    ds_read_b64_tr_b16 a[158:159], v11 offset:512
    v_mfma_f32_16x16x32_bf16 a[72:75], a[144:147], a[168:171], a[72:75]
    s_add_u32 m0, s59, 32768
    s_mov_b32 s60, 1835008
    ds_read_b128 a[188:191], v2 offset:54272
    v_mfma_f32_16x16x32_bf16 a[76:79], a[144:147], a[172:175], a[76:79]
    s_waitcnt lgkmcnt(7)
    buffer_load_dwordx4 v16, s[16:19], s60 offen offset:0 lds
    v_mfma_f32_16x16x32_bf16 a[92:95], a[148:151], a[172:175], a[92:95]
    s_waitcnt vmcnt(13)
    ds_read_b64_tr_b16 a[128:129], v8 offset:16384
    v_mfma_f32_16x16x32_bf16 a[88:91], a[148:151], a[168:171], a[88:91]
    ds_read_b64_tr_b16 a[130:131], v8 offset:16896
    v_mfma_f32_16x16x32_bf16 a[84:87], a[148:151], a[164:167], a[84:87]
    v_mfma_f32_16x16x32_bf16 a[80:83], a[148:151], a[160:163], a[80:83]
    s_waitcnt lgkmcnt(6)
    buffer_load_dwordx4 v17, s[16:19], s60 offen offset:1024 lds
    v_mfma_f32_16x16x32_bf16 a[96:99], a[152:155], a[160:163], a[96:99]
    ds_read_b64_tr_b16 a[132:133], v9 offset:16384
    v_mfma_f32_16x16x32_bf16 a[100:103], a[152:155], a[164:167], a[100:103]
    ds_read_b64_tr_b16 a[134:135], v9 offset:16896
    v_mfma_f32_16x16x32_bf16 a[104:107], a[152:155], a[168:171], a[104:107]
    v_mfma_f32_16x16x32_bf16 a[108:111], a[152:155], a[172:175], a[108:111]
    s_waitcnt lgkmcnt(5)
    buffer_load_dwordx4 v18, s[16:19], s60 offen offset:2048 lds
    v_mfma_f32_16x16x32_bf16 a[124:127], a[156:159], a[172:175], a[124:127]
    ds_read_b64_tr_b16 a[136:137], v10 offset:16384
    v_mfma_f32_16x16x32_bf16 a[120:123], a[156:159], a[168:171], a[120:123]
    ds_read_b64_tr_b16 a[138:139], v10 offset:16896
    v_mfma_f32_16x16x32_bf16 a[116:119], a[156:159], a[164:167], a[116:119]
    v_mfma_f32_16x16x32_bf16 a[112:115], a[156:159], a[160:163], a[112:115]
    s_waitcnt lgkmcnt(4)
    buffer_load_dwordx4 v19, s[16:19], s60 offen offset:3072 lds
    v_mfma_f32_16x16x32_bf16 a[0:3], a[128:131], a[176:179], a[0:3]
    ds_read_b64_tr_b16 a[140:141], v11 offset:16384
    v_mfma_f32_16x16x32_bf16 a[4:7], a[128:131], a[180:183], a[4:7]
    ds_read_b64_tr_b16 a[142:143], v11 offset:16896
    v_mfma_f32_16x16x32_bf16 a[8:11], a[128:131], a[184:187], a[8:11]
    s_add_u32 m0, s59, 49152
    s_mov_b32 s60, 1835136
    v_mfma_f32_16x16x32_bf16 a[12:15], a[128:131], a[188:191], a[12:15]
    s_waitcnt lgkmcnt(4)
    buffer_load_dwordx4 v16, s[16:19], s60 offen offset:0 lds
    v_mfma_f32_16x16x32_bf16 a[28:31], a[132:135], a[188:191], a[28:31]
    s_waitcnt vmcnt(13)
    ds_read_b64_tr_b16 a[144:145], v8 offset:32768
    v_mfma_f32_16x16x32_bf16 a[24:27], a[132:135], a[184:187], a[24:27]
    ds_read_b64_tr_b16 a[146:147], v8 offset:33280
    v_mfma_f32_16x16x32_bf16 a[20:23], a[132:135], a[180:183], a[20:23]
    ds_read_b128 a[160:163], v2 offset:6144
    v_mfma_f32_16x16x32_bf16 a[16:19], a[132:135], a[176:179], a[16:19]
    s_waitcnt lgkmcnt(5)
    buffer_load_dwordx4 v17, s[16:19], s60 offen offset:1024 lds
    v_mfma_f32_16x16x32_bf16 a[32:35], a[136:139], a[176:179], a[32:35]
    ds_read_b64_tr_b16 a[148:149], v9 offset:32768
    v_mfma_f32_16x16x32_bf16 a[36:39], a[136:139], a[180:183], a[36:39]
    ds_read_b64_tr_b16 a[150:151], v9 offset:33280
    v_mfma_f32_16x16x32_bf16 a[40:43], a[136:139], a[184:187], a[40:43]
    ds_read_b128 a[164:167], v2 offset:22528
    v_mfma_f32_16x16x32_bf16 a[44:47], a[136:139], a[188:191], a[44:47]
    s_waitcnt lgkmcnt(6)
    buffer_load_dwordx4 v18, s[16:19], s60 offen offset:2048 lds
    v_mfma_f32_16x16x32_bf16 a[60:63], a[140:143], a[188:191], a[60:63]
    ds_read_b64_tr_b16 a[152:153], v10 offset:32768
    v_mfma_f32_16x16x32_bf16 a[56:59], a[140:143], a[184:187], a[56:59]
    ds_read_b64_tr_b16 a[154:155], v10 offset:33280
    v_mfma_f32_16x16x32_bf16 a[52:55], a[140:143], a[180:183], a[52:55]
    ds_read_b128 a[168:171], v2 offset:38912
    v_mfma_f32_16x16x32_bf16 a[48:51], a[140:143], a[176:179], a[48:51]
    s_waitcnt lgkmcnt(7)
    buffer_load_dwordx4 v19, s[16:19], s60 offen offset:3072 lds
    v_mfma_f32_16x16x32_bf16 a[64:67], a[144:147], a[176:179], a[64:67]
    ds_read_b64_tr_b16 a[156:157], v11 offset:32768
    v_mfma_f32_16x16x32_bf16 a[68:71], a[144:147], a[180:183], a[68:71]
    ds_read_b64_tr_b16 a[158:159], v11 offset:33280
    v_mfma_f32_16x16x32_bf16 a[72:75], a[144:147], a[184:187], a[72:75]
    s_add_u32 m0, s59, 65536
    s_mov_b32 s60, 2097152
    ds_read_b128 a[172:175], v2 offset:55296
    v_mfma_f32_16x16x32_bf16 a[76:79], a[144:147], a[188:191], a[76:79]
    s_waitcnt lgkmcnt(7)
    buffer_load_dwordx4 v16, s[16:19], s60 offen offset:0 lds
    v_mfma_f32_16x16x32_bf16 a[92:95], a[148:151], a[188:191], a[92:95]
    s_waitcnt vmcnt(13)
    ds_read_b64_tr_b16 a[128:129], v4 offset:0
    v_mfma_f32_16x16x32_bf16 a[88:91], a[148:151], a[184:187], a[88:91]
    ds_read_b64_tr_b16 a[130:131], v4 offset:512
    v_mfma_f32_16x16x32_bf16 a[84:87], a[148:151], a[180:183], a[84:87]
    v_mfma_f32_16x16x32_bf16 a[80:83], a[148:151], a[176:179], a[80:83]
    s_waitcnt lgkmcnt(6)
    buffer_load_dwordx4 v17, s[16:19], s60 offen offset:1024 lds
    v_mfma_f32_16x16x32_bf16 a[96:99], a[152:155], a[176:179], a[96:99]
    ds_read_b64_tr_b16 a[132:133], v5 offset:0
    v_mfma_f32_16x16x32_bf16 a[100:103], a[152:155], a[180:183], a[100:103]
    ds_read_b64_tr_b16 a[134:135], v5 offset:512
    v_mfma_f32_16x16x32_bf16 a[104:107], a[152:155], a[184:187], a[104:107]
    v_mfma_f32_16x16x32_bf16 a[108:111], a[152:155], a[188:191], a[108:111]
    s_waitcnt lgkmcnt(5)
    buffer_load_dwordx4 v18, s[16:19], s60 offen offset:2048 lds
    v_mfma_f32_16x16x32_bf16 a[124:127], a[156:159], a[188:191], a[124:127]
    ds_read_b64_tr_b16 a[136:137], v6 offset:0
    v_mfma_f32_16x16x32_bf16 a[120:123], a[156:159], a[184:187], a[120:123]
    ds_read_b64_tr_b16 a[138:139], v6 offset:512
    v_mfma_f32_16x16x32_bf16 a[116:119], a[156:159], a[180:183], a[116:119]
    v_mfma_f32_16x16x32_bf16 a[112:115], a[156:159], a[176:179], a[112:115]
    s_waitcnt lgkmcnt(4)
    buffer_load_dwordx4 v19, s[16:19], s60 offen offset:3072 lds
    v_mfma_f32_16x16x32_bf16 a[0:3], a[128:131], a[160:163], a[0:3]
    ds_read_b64_tr_b16 a[140:141], v7 offset:0
    v_mfma_f32_16x16x32_bf16 a[4:7], a[128:131], a[164:167], a[4:7]
    ds_read_b64_tr_b16 a[142:143], v7 offset:512
    v_mfma_f32_16x16x32_bf16 a[8:11], a[128:131], a[168:171], a[8:11]
    s_add_u32 m0, s59, 81920
    s_mov_b32 s60, 2097280
    v_mfma_f32_16x16x32_bf16 a[12:15], a[128:131], a[172:175], a[12:15]
    s_waitcnt lgkmcnt(4)
    buffer_load_dwordx4 v16, s[16:19], s60 offen offset:0 lds
    v_mfma_f32_16x16x32_bf16 a[28:31], a[132:135], a[172:175], a[28:31]
    s_waitcnt vmcnt(13)
    ds_read_b64_tr_b16 a[144:145], v4 offset:16384
    v_mfma_f32_16x16x32_bf16 a[24:27], a[132:135], a[168:171], a[24:27]
    ds_read_b64_tr_b16 a[146:147], v4 offset:16896
    v_mfma_f32_16x16x32_bf16 a[20:23], a[132:135], a[164:167], a[20:23]
    ds_read_b128 a[176:179], v2 offset:7168
    v_mfma_f32_16x16x32_bf16 a[16:19], a[132:135], a[160:163], a[16:19]
    s_waitcnt lgkmcnt(5)
    buffer_load_dwordx4 v17, s[16:19], s60 offen offset:1024 lds
    v_mfma_f32_16x16x32_bf16 a[32:35], a[136:139], a[160:163], a[32:35]
    ds_read_b64_tr_b16 a[148:149], v5 offset:16384
    v_mfma_f32_16x16x32_bf16 a[36:39], a[136:139], a[164:167], a[36:39]
    ds_read_b64_tr_b16 a[150:151], v5 offset:16896
    v_mfma_f32_16x16x32_bf16 a[40:43], a[136:139], a[168:171], a[40:43]
    ds_read_b128 a[180:183], v2 offset:23552
    v_mfma_f32_16x16x32_bf16 a[44:47], a[136:139], a[172:175], a[44:47]
    s_waitcnt lgkmcnt(6)
    buffer_load_dwordx4 v18, s[16:19], s60 offen offset:2048 lds
    v_mfma_f32_16x16x32_bf16 a[60:63], a[140:143], a[172:175], a[60:63]
    ds_read_b64_tr_b16 a[152:153], v6 offset:16384
    v_mfma_f32_16x16x32_bf16 a[56:59], a[140:143], a[168:171], a[56:59]
    ds_read_b64_tr_b16 a[154:155], v6 offset:16896
    v_mfma_f32_16x16x32_bf16 a[52:55], a[140:143], a[164:167], a[52:55]
    ds_read_b128 a[184:187], v2 offset:39936
    v_mfma_f32_16x16x32_bf16 a[48:51], a[140:143], a[160:163], a[48:51]
    s_waitcnt lgkmcnt(7)
    buffer_load_dwordx4 v19, s[16:19], s60 offen offset:3072 lds
    v_mfma_f32_16x16x32_bf16 a[64:67], a[144:147], a[160:163], a[64:67]
    ds_read_b64_tr_b16 a[156:157], v7 offset:16384
    v_mfma_f32_16x16x32_bf16 a[68:71], a[144:147], a[164:167], a[68:71]
    ds_read_b64_tr_b16 a[158:159], v7 offset:16896
    v_mfma_f32_16x16x32_bf16 a[72:75], a[144:147], a[168:171], a[72:75]
    s_add_u32 m0, s59, 0
    s_mov_b32 s60, 2359296
    ds_read_b128 a[188:191], v2 offset:56320
    v_mfma_f32_16x16x32_bf16 a[76:79], a[144:147], a[172:175], a[76:79]
    s_waitcnt lgkmcnt(7)
    buffer_load_dwordx4 v16, s[16:19], s60 offen offset:0 lds
    v_mfma_f32_16x16x32_bf16 a[92:95], a[148:151], a[172:175], a[92:95]
    s_waitcnt vmcnt(13)
    ds_read_b64_tr_b16 a[128:129], v4 offset:32768
    v_mfma_f32_16x16x32_bf16 a[88:91], a[148:151], a[168:171], a[88:91]
    ds_read_b64_tr_b16 a[130:131], v4 offset:33280
    v_mfma_f32_16x16x32_bf16 a[84:87], a[148:151], a[164:167], a[84:87]
    v_mfma_f32_16x16x32_bf16 a[80:83], a[148:151], a[160:163], a[80:83]
    s_waitcnt lgkmcnt(6)
    buffer_load_dwordx4 v17, s[16:19], s60 offen offset:1024 lds
    v_mfma_f32_16x16x32_bf16 a[96:99], a[152:155], a[160:163], a[96:99]
    ds_read_b64_tr_b16 a[132:133], v5 offset:32768
    v_mfma_f32_16x16x32_bf16 a[100:103], a[152:155], a[164:167], a[100:103]
    ds_read_b64_tr_b16 a[134:135], v5 offset:33280
    v_mfma_f32_16x16x32_bf16 a[104:107], a[152:155], a[168:171], a[104:107]
    v_mfma_f32_16x16x32_bf16 a[108:111], a[152:155], a[172:175], a[108:111]
    s_waitcnt lgkmcnt(5)
    buffer_load_dwordx4 v18, s[16:19], s60 offen offset:2048 lds
    v_mfma_f32_16x16x32_bf16 a[124:127], a[156:159], a[172:175], a[124:127]
    ds_read_b64_tr_b16 a[136:137], v6 offset:32768
    v_mfma_f32_16x16x32_bf16 a[120:123], a[156:159], a[168:171], a[120:123]
    ds_read_b64_tr_b16 a[138:139], v6 offset:33280
    v_mfma_f32_16x16x32_bf16 a[116:119], a[156:159], a[164:167], a[116:119]
    v_mfma_f32_16x16x32_bf16 a[112:115], a[156:159], a[160:163], a[112:115]
    s_waitcnt lgkmcnt(4)
    buffer_load_dwordx4 v19, s[16:19], s60 offen offset:3072 lds
    v_mfma_f32_16x16x32_bf16 a[0:3], a[128:131], a[176:179], a[0:3]
    ds_read_b64_tr_b16 a[140:141], v7 offset:32768
    v_mfma_f32_16x16x32_bf16 a[4:7], a[128:131], a[180:183], a[4:7]
    ds_read_b64_tr_b16 a[142:143], v7 offset:33280
    v_mfma_f32_16x16x32_bf16 a[8:11], a[128:131], a[184:187], a[8:11]
    s_add_u32 m0, s59, 16384
    s_mov_b32 s60, 2359424
    v_mfma_f32_16x16x32_bf16 a[12:15], a[128:131], a[188:191], a[12:15]
    s_waitcnt lgkmcnt(4)
    buffer_load_dwordx4 v16, s[16:19], s60 offen offset:0 lds
    v_mfma_f32_16x16x32_bf16 a[28:31], a[132:135], a[188:191], a[28:31]
    s_waitcnt vmcnt(13)
    ds_read_b64_tr_b16 a[144:145], v8 offset:0
    v_mfma_f32_16x16x32_bf16 a[24:27], a[132:135], a[184:187], a[24:27]
    ds_read_b64_tr_b16 a[146:147], v8 offset:512
    v_mfma_f32_16x16x32_bf16 a[20:23], a[132:135], a[180:183], a[20:23]
    ds_read_b128 a[160:163], v2 offset:8192
    v_mfma_f32_16x16x32_bf16 a[16:19], a[132:135], a[176:179], a[16:19]
    s_waitcnt lgkmcnt(5)
    buffer_load_dwordx4 v17, s[16:19], s60 offen offset:1024 lds
    v_mfma_f32_16x16x32_bf16 a[32:35], a[136:139], a[176:179], a[32:35]
    ds_read_b64_tr_b16 a[148:149], v9 offset:0
    v_mfma_f32_16x16x32_bf16 a[36:39], a[136:139], a[180:183], a[36:39]
    ds_read_b64_tr_b16 a[150:151], v9 offset:512
    v_mfma_f32_16x16x32_bf16 a[40:43], a[136:139], a[184:187], a[40:43]
    ds_read_b128 a[164:167], v2 offset:24576
    v_mfma_f32_16x16x32_bf16 a[44:47], a[136:139], a[188:191], a[44:47]
    s_waitcnt lgkmcnt(6)
    buffer_load_dwordx4 v18, s[16:19], s60 offen offset:2048 lds
    v_mfma_f32_16x16x32_bf16 a[60:63], a[140:143], a[188:191], a[60:63]
    ds_read_b64_tr_b16 a[152:153], v10 offset:0
    v_mfma_f32_16x16x32_bf16 a[56:59], a[140:143], a[184:187], a[56:59]
    ds_read_b64_tr_b16 a[154:155], v10 offset:512
    v_mfma_f32_16x16x32_bf16 a[52:55], a[140:143], a[180:183], a[52:55]
    ds_read_b128 a[168:171], v2 offset:40960
    v_mfma_f32_16x16x32_bf16 a[48:51], a[140:143], a[176:179], a[48:51]
    s_waitcnt lgkmcnt(7)
    buffer_load_dwordx4 v19, s[16:19], s60 offen offset:3072 lds
    v_mfma_f32_16x16x32_bf16 a[64:67], a[144:147], a[176:179], a[64:67]
    ds_read_b64_tr_b16 a[156:157], v11 offset:0
    v_mfma_f32_16x16x32_bf16 a[68:71], a[144:147], a[180:183], a[68:71]
    ds_read_b64_tr_b16 a[158:159], v11 offset:512
    v_mfma_f32_16x16x32_bf16 a[72:75], a[144:147], a[184:187], a[72:75]
    s_add_u32 m0, s59, 32768
    s_mov_b32 s60, 2621440
    ds_read_b128 a[172:175], v2 offset:57344
    v_mfma_f32_16x16x32_bf16 a[76:79], a[144:147], a[188:191], a[76:79]
    s_waitcnt lgkmcnt(7)
    buffer_load_dwordx4 v16, s[16:19], s60 offen offset:0 lds
    v_mfma_f32_16x16x32_bf16 a[92:95], a[148:151], a[188:191], a[92:95]
    s_waitcnt vmcnt(13)
    ds_read_b64_tr_b16 a[128:129], v8 offset:16384
    v_mfma_f32_16x16x32_bf16 a[88:91], a[148:151], a[184:187], a[88:91]
    ds_read_b64_tr_b16 a[130:131], v8 offset:16896
    v_mfma_f32_16x16x32_bf16 a[84:87], a[148:151], a[180:183], a[84:87]
    v_mfma_f32_16x16x32_bf16 a[80:83], a[148:151], a[176:179], a[80:83]
    s_waitcnt lgkmcnt(6)
    buffer_load_dwordx4 v17, s[16:19], s60 offen offset:1024 lds
    v_mfma_f32_16x16x32_bf16 a[96:99], a[152:155], a[176:179], a[96:99]
    ds_read_b64_tr_b16 a[132:133], v9 offset:16384
    v_mfma_f32_16x16x32_bf16 a[100:103], a[152:155], a[180:183], a[100:103]
    ds_read_b64_tr_b16 a[134:135], v9 offset:16896
    v_mfma_f32_16x16x32_bf16 a[104:107], a[152:155], a[184:187], a[104:107]
    v_mfma_f32_16x16x32_bf16 a[108:111], a[152:155], a[188:191], a[108:111]
    s_waitcnt lgkmcnt(5)
    buffer_load_dwordx4 v18, s[16:19], s60 offen offset:2048 lds
    v_mfma_f32_16x16x32_bf16 a[124:127], a[156:159], a[188:191], a[124:127]
    ds_read_b64_tr_b16 a[136:137], v10 offset:16384
    v_mfma_f32_16x16x32_bf16 a[120:123], a[156:159], a[184:187], a[120:123]
    ds_read_b64_tr_b16 a[138:139], v10 offset:16896
    v_mfma_f32_16x16x32_bf16 a[116:119], a[156:159], a[180:183], a[116:119]
    v_mfma_f32_16x16x32_bf16 a[112:115], a[156:159], a[176:179], a[112:115]
    s_waitcnt lgkmcnt(4)
    buffer_load_dwordx4 v19, s[16:19], s60 offen offset:3072 lds
    v_mfma_f32_16x16x32_bf16 a[0:3], a[128:131], a[160:163], a[0:3]
    ds_read_b64_tr_b16 a[140:141], v11 offset:16384
    v_mfma_f32_16x16x32_bf16 a[4:7], a[128:131], a[164:167], a[4:7]
    ds_read_b64_tr_b16 a[142:143], v11 offset:16896
    v_mfma_f32_16x16x32_bf16 a[8:11], a[128:131], a[168:171], a[8:11]
    s_add_u32 m0, s59, 49152
    s_mov_b32 s60, 2621568
    v_mfma_f32_16x16x32_bf16 a[12:15], a[128:131], a[172:175], a[12:15]
    s_waitcnt lgkmcnt(4)
    buffer_load_dwordx4 v16, s[16:19], s60 offen offset:0 lds
    v_mfma_f32_16x16x32_bf16 a[28:31], a[132:135], a[172:175], a[28:31]
    s_waitcnt vmcnt(13)
    ds_read_b64_tr_b16 a[144:145], v8 offset:32768
    v_mfma_f32_16x16x32_bf16 a[24:27], a[132:135], a[168:171], a[24:27]
    ds_read_b64_tr_b16 a[146:147], v8 offset:33280
    v_mfma_f32_16x16x32_bf16 a[20:23], a[132:135], a[164:167], a[20:23]
    ds_read_b128 a[176:179], v2 offset:9216
    v_mfma_f32_16x16x32_bf16 a[16:19], a[132:135], a[160:163], a[16:19]
    s_waitcnt lgkmcnt(5)
    buffer_load_dwordx4 v17, s[16:19], s60 offen offset:1024 lds
    v_mfma_f32_16x16x32_bf16 a[32:35], a[136:139], a[160:163], a[32:35]
    ds_read_b64_tr_b16 a[148:149], v9 offset:32768
    v_mfma_f32_16x16x32_bf16 a[36:39], a[136:139], a[164:167], a[36:39]
    ds_read_b64_tr_b16 a[150:151], v9 offset:33280
    v_mfma_f32_16x16x32_bf16 a[40:43], a[136:139], a[168:171], a[40:43]
    ds_read_b128 a[180:183], v2 offset:25600
    v_mfma_f32_16x16x32_bf16 a[44:47], a[136:139], a[172:175], a[44:47]
    s_waitcnt lgkmcnt(6)
    buffer_load_dwordx4 v18, s[16:19], s60 offen offset:2048 lds
    v_mfma_f32_16x16x32_bf16 a[60:63], a[140:143], a[172:175], a[60:63]
    ds_read_b64_tr_b16 a[152:153], v10 offset:32768
    v_mfma_f32_16x16x32_bf16 a[56:59], a[140:143], a[168:171], a[56:59]
    ds_read_b64_tr_b16 a[154:155], v10 offset:33280
    v_mfma_f32_16x16x32_bf16 a[52:55], a[140:143], a[164:167], a[52:55]
    ds_read_b128 a[184:187], v2 offset:41984
    v_mfma_f32_16x16x32_bf16 a[48:51], a[140:143], a[160:163], a[48:51]
    s_waitcnt lgkmcnt(7)
    buffer_load_dwordx4 v19, s[16:19], s60 offen offset:3072 lds
    v_mfma_f32_16x16x32_bf16 a[64:67], a[144:147], a[160:163], a[64:67]
    ds_read_b64_tr_b16 a[156:157], v11 offset:32768
    v_mfma_f32_16x16x32_bf16 a[68:71], a[144:147], a[164:167], a[68:71]
    ds_read_b64_tr_b16 a[158:159], v11 offset:33280
    v_mfma_f32_16x16x32_bf16 a[72:75], a[144:147], a[168:171], a[72:75]
    s_add_u32 m0, s59, 65536
    s_mov_b32 s60, 2883584
    ds_read_b128 a[188:191], v2 offset:58368
    v_mfma_f32_16x16x32_bf16 a[76:79], a[144:147], a[172:175], a[76:79]
    s_waitcnt lgkmcnt(7)
    buffer_load_dwordx4 v16, s[16:19], s60 offen offset:0 lds
    v_mfma_f32_16x16x32_bf16 a[92:95], a[148:151], a[172:175], a[92:95]
    s_waitcnt vmcnt(13)
    ds_read_b64_tr_b16 a[128:129], v4 offset:0
    v_mfma_f32_16x16x32_bf16 a[88:91], a[148:151], a[168:171], a[88:91]
    ds_read_b64_tr_b16 a[130:131], v4 offset:512
    v_mfma_f32_16x16x32_bf16 a[84:87], a[148:151], a[164:167], a[84:87]
    v_mfma_f32_16x16x32_bf16 a[80:83], a[148:151], a[160:163], a[80:83]
    s_waitcnt lgkmcnt(6)
    buffer_load_dwordx4 v17, s[16:19], s60 offen offset:1024 lds
    v_mfma_f32_16x16x32_bf16 a[96:99], a[152:155], a[160:163], a[96:99]
    ds_read_b64_tr_b16 a[132:133], v5 offset:0
    v_mfma_f32_16x16x32_bf16 a[100:103], a[152:155], a[164:167], a[100:103]
    ds_read_b64_tr_b16 a[134:135], v5 offset:512
    s_mov_b64 exec, 0xffffffff
    global_load_dword v46, v52, s[100:101]
    s_mov_b64 exec, -1
    v_mfma_f32_16x16x32_bf16 a[104:107], a[152:155], a[168:171], a[104:107]
    v_mfma_f32_16x16x32_bf16 a[108:111], a[152:155], a[172:175], a[108:111]
    s_waitcnt lgkmcnt(5)
    buffer_load_dwordx4 v18, s[16:19], s60 offen offset:2048 lds
    v_mfma_f32_16x16x32_bf16 a[124:127], a[156:159], a[172:175], a[124:127]
    ds_read_b64_tr_b16 a[136:137], v6 offset:0
    v_mfma_f32_16x16x32_bf16 a[120:123], a[156:159], a[168:171], a[120:123]
    ds_read_b64_tr_b16 a[138:139], v6 offset:512
    v_mfma_f32_16x16x32_bf16 a[116:119], a[156:159], a[164:167], a[116:119]
    v_mfma_f32_16x16x32_bf16 a[112:115], a[156:159], a[160:163], a[112:115]
    s_waitcnt lgkmcnt(4)
    buffer_load_dwordx4 v19, s[16:19], s60 offen offset:3072 lds
    v_mfma_f32_16x16x32_bf16 a[0:3], a[128:131], a[176:179], a[0:3]
    ds_read_b64_tr_b16 a[140:141], v7 offset:0
    v_mfma_f32_16x16x32_bf16 a[4:7], a[128:131], a[180:183], a[4:7]
    ds_read_b64_tr_b16 a[142:143], v7 offset:512
    v_mfma_f32_16x16x32_bf16 a[8:11], a[128:131], a[184:187], a[8:11]
    s_add_u32 m0, s59, 81920
    s_mov_b32 s60, 2883712
    v_mfma_f32_16x16x32_bf16 a[12:15], a[128:131], a[188:191], a[12:15]
    s_waitcnt lgkmcnt(4)
    buffer_load_dwordx4 v16, s[16:19], s60 offen offset:0 lds
    v_mfma_f32_16x16x32_bf16 a[28:31], a[132:135], a[188:191], a[28:31]
    s_waitcnt vmcnt(14)
    ds_read_b64_tr_b16 a[144:145], v4 offset:16384
    v_mfma_f32_16x16x32_bf16 a[24:27], a[132:135], a[184:187], a[24:27]
    ds_read_b64_tr_b16 a[146:147], v4 offset:16896
    v_mfma_f32_16x16x32_bf16 a[20:23], a[132:135], a[180:183], a[20:23]
    ds_read_b128 a[160:163], v2 offset:10240
    v_mfma_f32_16x16x32_bf16 a[16:19], a[132:135], a[176:179], a[16:19]
    s_waitcnt lgkmcnt(5)
    buffer_load_dwordx4 v17, s[16:19], s60 offen offset:1024 lds
    v_mfma_f32_16x16x32_bf16 a[32:35], a[136:139], a[176:179], a[32:35]
    ds_read_b64_tr_b16 a[148:149], v5 offset:16384
    v_mfma_f32_16x16x32_bf16 a[36:39], a[136:139], a[180:183], a[36:39]
    ds_read_b64_tr_b16 a[150:151], v5 offset:16896
    v_mfma_f32_16x16x32_bf16 a[40:43], a[136:139], a[184:187], a[40:43]
    ds_read_b128 a[164:167], v2 offset:26624
    v_mfma_f32_16x16x32_bf16 a[44:47], a[136:139], a[188:191], a[44:47]
    s_waitcnt lgkmcnt(6)
    buffer_load_dwordx4 v18, s[16:19], s60 offen offset:2048 lds
    v_mfma_f32_16x16x32_bf16 a[60:63], a[140:143], a[188:191], a[60:63]
    ds_read_b64_tr_b16 a[152:153], v6 offset:16384
    v_mfma_f32_16x16x32_bf16 a[56:59], a[140:143], a[184:187], a[56:59]
    ds_read_b64_tr_b16 a[154:155], v6 offset:16896
    v_mfma_f32_16x16x32_bf16 a[52:55], a[140:143], a[180:183], a[52:55]
    ds_read_b128 a[168:171], v2 offset:43008
    v_mfma_f32_16x16x32_bf16 a[48:51], a[140:143], a[176:179], a[48:51]
    s_waitcnt lgkmcnt(7)
    buffer_load_dwordx4 v19, s[16:19], s60 offen offset:3072 lds
    v_mfma_f32_16x16x32_bf16 a[64:67], a[144:147], a[176:179], a[64:67]
    ds_read_b64_tr_b16 a[156:157], v7 offset:16384
    v_mfma_f32_16x16x32_bf16 a[68:71], a[144:147], a[180:183], a[68:71]
    ds_read_b64_tr_b16 a[158:159], v7 offset:16896
    v_mfma_f32_16x16x32_bf16 a[72:75], a[144:147], a[184:187], a[72:75]
    s_add_u32 m0, s59, 0
    s_mov_b32 s60, 3145728
    ds_read_b128 a[172:175], v2 offset:59392
    v_mfma_f32_16x16x32_bf16 a[76:79], a[144:147], a[188:191], a[76:79]
    s_waitcnt lgkmcnt(7)
    buffer_load_dwordx4 v16, s[16:19], s60 offen offset:0 lds
    v_mfma_f32_16x16x32_bf16 a[92:95], a[148:151], a[188:191], a[92:95]
    s_waitcnt vmcnt(14)
    ds_read_b64_tr_b16 a[128:129], v4 offset:32768
    v_mfma_f32_16x16x32_bf16 a[88:91], a[148:151], a[184:187], a[88:91]
    ds_read_b64_tr_b16 a[130:131], v4 offset:33280
    v_mfma_f32_16x16x32_bf16 a[84:87], a[148:151], a[180:183], a[84:87]
    v_mfma_f32_16x16x32_bf16 a[80:83], a[148:151], a[176:179], a[80:83]
    s_waitcnt lgkmcnt(6)
    buffer_load_dwordx4 v17, s[16:19], s60 offen offset:1024 lds
    v_mfma_f32_16x16x32_bf16 a[96:99], a[152:155], a[176:179], a[96:99]
    ds_read_b64_tr_b16 a[132:133], v5 offset:32768
    v_mfma_f32_16x16x32_bf16 a[100:103], a[152:155], a[180:183], a[100:103]
    ds_read_b64_tr_b16 a[134:135], v5 offset:33280
    v_mfma_f32_16x16x32_bf16 a[104:107], a[152:155], a[184:187], a[104:107]
    v_mfma_f32_16x16x32_bf16 a[108:111], a[152:155], a[188:191], a[108:111]
    s_waitcnt lgkmcnt(5)
    buffer_load_dwordx4 v18, s[16:19], s60 offen offset:2048 lds
    v_mfma_f32_16x16x32_bf16 a[124:127], a[156:159], a[188:191], a[124:127]
    ds_read_b64_tr_b16 a[136:137], v6 offset:32768
    v_mfma_f32_16x16x32_bf16 a[120:123], a[156:159], a[184:187], a[120:123]
    ds_read_b64_tr_b16 a[138:139], v6 offset:33280
    v_mfma_f32_16x16x32_bf16 a[116:119], a[156:159], a[180:183], a[116:119]
    v_mfma_f32_16x16x32_bf16 a[112:115], a[156:159], a[176:179], a[112:115]
    s_waitcnt lgkmcnt(4)
    buffer_load_dwordx4 v19, s[16:19], s60 offen offset:3072 lds
    v_mfma_f32_16x16x32_bf16 a[0:3], a[128:131], a[160:163], a[0:3]
    ds_read_b64_tr_b16 a[140:141], v7 offset:32768
    v_mfma_f32_16x16x32_bf16 a[4:7], a[128:131], a[164:167], a[4:7]
    ds_read_b64_tr_b16 a[142:143], v7 offset:33280
    v_mfma_f32_16x16x32_bf16 a[8:11], a[128:131], a[168:171], a[8:11]
    s_add_u32 m0, s59, 16384
    s_mov_b32 s60, 3145856
    v_mfma_f32_16x16x32_bf16 a[12:15], a[128:131], a[172:175], a[12:15]
    s_waitcnt lgkmcnt(4)
    buffer_load_dwordx4 v16, s[16:19], s60 offen offset:0 lds
    v_mfma_f32_16x16x32_bf16 a[28:31], a[132:135], a[172:175], a[28:31]
    s_waitcnt vmcnt(14)
    ds_read_b64_tr_b16 a[144:145], v8 offset:0
    v_mfma_f32_16x16x32_bf16 a[24:27], a[132:135], a[168:171], a[24:27]
    ds_read_b64_tr_b16 a[146:147], v8 offset:512
    v_mfma_f32_16x16x32_bf16 a[20:23], a[132:135], a[164:167], a[20:23]
    ds_read_b128 a[176:179], v2 offset:11264
    v_mfma_f32_16x16x32_bf16 a[16:19], a[132:135], a[160:163], a[16:19]
    s_waitcnt lgkmcnt(5)
    buffer_load_dwordx4 v17, s[16:19], s60 offen offset:1024 lds
    v_mfma_f32_16x16x32_bf16 a[32:35], a[136:139], a[160:163], a[32:35]
    ds_read_b64_tr_b16 a[148:149], v9 offset:0
    v_mfma_f32_16x16x32_bf16 a[36:39], a[136:139], a[164:167], a[36:39]
    ds_read_b64_tr_b16 a[150:151], v9 offset:512
    v_mfma_f32_16x16x32_bf16 a[40:43], a[136:139], a[168:171], a[40:43]
    ds_read_b128 a[180:183], v2 offset:27648
    v_mfma_f32_16x16x32_bf16 a[44:47], a[136:139], a[172:175], a[44:47]
    s_waitcnt lgkmcnt(6)
    buffer_load_dwordx4 v18, s[16:19], s60 offen offset:2048 lds
    v_mfma_f32_16x16x32_bf16 a[60:63], a[140:143], a[172:175], a[60:63]
    ds_read_b64_tr_b16 a[152:153], v10 offset:0
    v_mfma_f32_16x16x32_bf16 a[56:59], a[140:143], a[168:171], a[56:59]
    ds_read_b64_tr_b16 a[154:155], v10 offset:512
    v_mfma_f32_16x16x32_bf16 a[52:55], a[140:143], a[164:167], a[52:55]
    ds_read_b128 a[184:187], v2 offset:44032
    v_mfma_f32_16x16x32_bf16 a[48:51], a[140:143], a[160:163], a[48:51]
    s_waitcnt lgkmcnt(7)
    buffer_load_dwordx4 v19, s[16:19], s60 offen offset:3072 lds
    v_mfma_f32_16x16x32_bf16 a[64:67], a[144:147], a[160:163], a[64:67]
    ds_read_b64_tr_b16 a[156:157], v11 offset:0
    v_mfma_f32_16x16x32_bf16 a[68:71], a[144:147], a[164:167], a[68:71]
    ds_read_b64_tr_b16 a[158:159], v11 offset:512
    v_mfma_f32_16x16x32_bf16 a[72:75], a[144:147], a[168:171], a[72:75]
    s_add_u32 m0, s59, 32768
    s_mov_b32 s60, 3407872
    ds_read_b128 a[188:191], v2 offset:60416
    v_mfma_f32_16x16x32_bf16 a[76:79], a[144:147], a[172:175], a[76:79]
    s_waitcnt lgkmcnt(7)
    buffer_load_dwordx4 v16, s[16:19], s60 offen offset:0 lds
    v_mfma_f32_16x16x32_bf16 a[92:95], a[148:151], a[172:175], a[92:95]
    s_waitcnt vmcnt(13)
    ds_read_b64_tr_b16 a[128:129], v8 offset:16384
    v_mfma_f32_16x16x32_bf16 a[88:91], a[148:151], a[168:171], a[88:91]
    ds_read_b64_tr_b16 a[130:131], v8 offset:16896
    v_mfma_f32_16x16x32_bf16 a[84:87], a[148:151], a[164:167], a[84:87]
    v_mfma_f32_16x16x32_bf16 a[80:83], a[148:151], a[160:163], a[80:83]
    s_waitcnt lgkmcnt(6)
    buffer_load_dwordx4 v17, s[16:19], s60 offen offset:1024 lds
    v_mfma_f32_16x16x32_bf16 a[96:99], a[152:155], a[160:163], a[96:99]
    ds_read_b64_tr_b16 a[132:133], v9 offset:16384
    v_mfma_f32_16x16x32_bf16 a[100:103], a[152:155], a[164:167], a[100:103]
    ds_read_b64_tr_b16 a[134:135], v9 offset:16896
    v_mfma_f32_16x16x32_bf16 a[104:107], a[152:155], a[168:171], a[104:107]
    v_mfma_f32_16x16x32_bf16 a[108:111], a[152:155], a[172:175], a[108:111]
    s_waitcnt lgkmcnt(5)
    buffer_load_dwordx4 v18, s[16:19], s60 offen offset:2048 lds
    v_mfma_f32_16x16x32_bf16 a[124:127], a[156:159], a[172:175], a[124:127]
    ds_read_b64_tr_b16 a[136:137], v10 offset:16384
    v_mfma_f32_16x16x32_bf16 a[120:123], a[156:159], a[168:171], a[120:123]
    ds_read_b64_tr_b16 a[138:139], v10 offset:16896
    v_mfma_f32_16x16x32_bf16 a[116:119], a[156:159], a[164:167], a[116:119]
    v_mfma_f32_16x16x32_bf16 a[112:115], a[156:159], a[160:163], a[112:115]
    s_waitcnt lgkmcnt(4)
    buffer_load_dwordx4 v19, s[16:19], s60 offen offset:3072 lds
    v_mfma_f32_16x16x32_bf16 a[0:3], a[128:131], a[176:179], a[0:3]
    ds_read_b64_tr_b16 a[140:141], v11 offset:16384
    v_mfma_f32_16x16x32_bf16 a[4:7], a[128:131], a[180:183], a[4:7]
    ds_read_b64_tr_b16 a[142:143], v11 offset:16896
    v_mfma_f32_16x16x32_bf16 a[8:11], a[128:131], a[184:187], a[8:11]
    s_add_u32 m0, s59, 49152
    s_mov_b32 s60, 3408000
    v_mfma_f32_16x16x32_bf16 a[12:15], a[128:131], a[188:191], a[12:15]
    s_waitcnt lgkmcnt(4)
    buffer_load_dwordx4 v16, s[16:19], s60 offen offset:0 lds
    v_mfma_f32_16x16x32_bf16 a[28:31], a[132:135], a[188:191], a[28:31]
    s_waitcnt vmcnt(13)
    ds_read_b64_tr_b16 a[144:145], v8 offset:32768
    v_mfma_f32_16x16x32_bf16 a[24:27], a[132:135], a[184:187], a[24:27]
    ds_read_b64_tr_b16 a[146:147], v8 offset:33280
    v_mfma_f32_16x16x32_bf16 a[20:23], a[132:135], a[180:183], a[20:23]
    ds_read_b128 a[160:163], v2 offset:12288
    v_mfma_f32_16x16x32_bf16 a[16:19], a[132:135], a[176:179], a[16:19]
    s_waitcnt lgkmcnt(5)
    buffer_load_dwordx4 v17, s[16:19], s60 offen offset:1024 lds
    v_mfma_f32_16x16x32_bf16 a[32:35], a[136:139], a[176:179], a[32:35]
    ds_read_b64_tr_b16 a[148:149], v9 offset:32768
    v_mfma_f32_16x16x32_bf16 a[36:39], a[136:139], a[180:183], a[36:39]
    ds_read_b64_tr_b16 a[150:151], v9 offset:33280
    v_mfma_f32_16x16x32_bf16 a[40:43], a[136:139], a[184:187], a[40:43]
    ds_read_b128 a[164:167], v2 offset:28672
    v_mfma_f32_16x16x32_bf16 a[44:47], a[136:139], a[188:191], a[44:47]
    s_waitcnt lgkmcnt(6)
    buffer_load_dwordx4 v18, s[16:19], s60 offen offset:2048 lds
    v_mfma_f32_16x16x32_bf16 a[60:63], a[140:143], a[188:191], a[60:63]
    ds_read_b64_tr_b16 a[152:153], v10 offset:32768
    v_mfma_f32_16x16x32_bf16 a[56:59], a[140:143], a[184:187], a[56:59]
    ds_read_b64_tr_b16 a[154:155], v10 offset:33280
    v_mfma_f32_16x16x32_bf16 a[52:55], a[140:143], a[180:183], a[52:55]
    ds_read_b128 a[168:171], v2 offset:45056
    v_mfma_f32_16x16x32_bf16 a[48:51], a[140:143], a[176:179], a[48:51]
    s_waitcnt lgkmcnt(7)
    buffer_load_dwordx4 v19, s[16:19], s60 offen offset:3072 lds
    v_mfma_f32_16x16x32_bf16 a[64:67], a[144:147], a[176:179], a[64:67]
    ds_read_b64_tr_b16 a[156:157], v11 offset:32768
    v_mfma_f32_16x16x32_bf16 a[68:71], a[144:147], a[180:183], a[68:71]
    ds_read_b64_tr_b16 a[158:159], v11 offset:33280
    v_mfma_f32_16x16x32_bf16 a[72:75], a[144:147], a[184:187], a[72:75]
    s_add_u32 m0, s59, 65536
    s_mov_b32 s60, 3670016
    ds_read_b128 a[172:175], v2 offset:61440
    v_mfma_f32_16x16x32_bf16 a[76:79], a[144:147], a[188:191], a[76:79]
    s_waitcnt lgkmcnt(7)
    buffer_load_dwordx4 v16, s[16:19], s60 offen offset:0 lds
    v_mfma_f32_16x16x32_bf16 a[92:95], a[148:151], a[188:191], a[92:95]
    s_waitcnt vmcnt(13)
    ds_read_b64_tr_b16 a[128:129], v4 offset:0
    v_mfma_f32_16x16x32_bf16 a[88:91], a[148:151], a[184:187], a[88:91]
    ds_read_b64_tr_b16 a[130:131], v4 offset:512
    v_mfma_f32_16x16x32_bf16 a[84:87], a[148:151], a[180:183], a[84:87]
    v_mfma_f32_16x16x32_bf16 a[80:83], a[148:151], a[176:179], a[80:83]
    s_waitcnt lgkmcnt(6)
    buffer_load_dwordx4 v17, s[16:19], s60 offen offset:1024 lds
    v_mfma_f32_16x16x32_bf16 a[96:99], a[152:155], a[176:179], a[96:99]
    ds_read_b64_tr_b16 a[132:133], v5 offset:0
    v_mfma_f32_16x16x32_bf16 a[100:103], a[152:155], a[180:183], a[100:103]
    ds_read_b64_tr_b16 a[134:135], v5 offset:512
    v_mfma_f32_16x16x32_bf16 a[104:107], a[152:155], a[184:187], a[104:107]
    v_mfma_f32_16x16x32_bf16 a[108:111], a[152:155], a[188:191], a[108:111]
    s_waitcnt lgkmcnt(5)
    buffer_load_dwordx4 v18, s[16:19], s60 offen offset:2048 lds
    v_mfma_f32_16x16x32_bf16 a[124:127], a[156:159], a[188:191], a[124:127]
    ds_read_b64_tr_b16 a[136:137], v6 offset:0
    v_mfma_f32_16x16x32_bf16 a[120:123], a[156:159], a[184:187], a[120:123]
    ds_read_b64_tr_b16 a[138:139], v6 offset:512
    v_mfma_f32_16x16x32_bf16 a[116:119], a[156:159], a[180:183], a[116:119]
    v_mfma_f32_16x16x32_bf16 a[112:115], a[156:159], a[176:179], a[112:115]
    s_waitcnt lgkmcnt(4)
    buffer_load_dwordx4 v19, s[16:19], s60 offen offset:3072 lds
    v_mfma_f32_16x16x32_bf16 a[0:3], a[128:131], a[160:163], a[0:3]
    ds_read_b64_tr_b16 a[140:141], v7 offset:0
    v_mfma_f32_16x16x32_bf16 a[4:7], a[128:131], a[164:167], a[4:7]
    ds_read_b64_tr_b16 a[142:143], v7 offset:512
    v_mfma_f32_16x16x32_bf16 a[8:11], a[128:131], a[168:171], a[8:11]
    s_add_u32 m0, s59, 81920
    s_mov_b32 s60, 3670144
    v_mfma_f32_16x16x32_bf16 a[12:15], a[128:131], a[172:175], a[12:15]
    s_waitcnt lgkmcnt(4)
    buffer_load_dwordx4 v16, s[16:19], s60 offen offset:0 lds
    v_mfma_f32_16x16x32_bf16 a[28:31], a[132:135], a[172:175], a[28:31]
    s_waitcnt vmcnt(13)
    ds_read_b64_tr_b16 a[144:145], v4 offset:16384
    v_mfma_f32_16x16x32_bf16 a[24:27], a[132:135], a[168:171], a[24:27]
    ds_read_b64_tr_b16 a[146:147], v4 offset:16896
    v_mfma_f32_16x16x32_bf16 a[20:23], a[132:135], a[164:167], a[20:23]
    ds_read_b128 a[176:179], v2 offset:13312
    v_mfma_f32_16x16x32_bf16 a[16:19], a[132:135], a[160:163], a[16:19]
    s_waitcnt lgkmcnt(5)
    buffer_load_dwordx4 v17, s[16:19], s60 offen offset:1024 lds
    v_mfma_f32_16x16x32_bf16 a[32:35], a[136:139], a[160:163], a[32:35]
    ds_read_b64_tr_b16 a[148:149], v5 offset:16384
    v_mfma_f32_16x16x32_bf16 a[36:39], a[136:139], a[164:167], a[36:39]
    ds_read_b64_tr_b16 a[150:151], v5 offset:16896
    v_mfma_f32_16x16x32_bf16 a[40:43], a[136:139], a[168:171], a[40:43]
    ds_read_b128 a[180:183], v2 offset:29696
    v_mfma_f32_16x16x32_bf16 a[44:47], a[136:139], a[172:175], a[44:47]
    s_waitcnt lgkmcnt(6)
    buffer_load_dwordx4 v18, s[16:19], s60 offen offset:2048 lds
    v_mfma_f32_16x16x32_bf16 a[60:63], a[140:143], a[172:175], a[60:63]
    ds_read_b64_tr_b16 a[152:153], v6 offset:16384
    v_mfma_f32_16x16x32_bf16 a[56:59], a[140:143], a[168:171], a[56:59]
    ds_read_b64_tr_b16 a[154:155], v6 offset:16896
    v_mfma_f32_16x16x32_bf16 a[52:55], a[140:143], a[164:167], a[52:55]
    ds_read_b128 a[184:187], v2 offset:46080
    v_mfma_f32_16x16x32_bf16 a[48:51], a[140:143], a[160:163], a[48:51]
    s_waitcnt lgkmcnt(7)
    buffer_load_dwordx4 v19, s[16:19], s60 offen offset:3072 lds
    v_mfma_f32_16x16x32_bf16 a[64:67], a[144:147], a[160:163], a[64:67]
    ds_read_b64_tr_b16 a[156:157], v7 offset:16384
    v_mfma_f32_16x16x32_bf16 a[68:71], a[144:147], a[164:167], a[68:71]
    ds_read_b64_tr_b16 a[158:159], v7 offset:16896
    v_mfma_f32_16x16x32_bf16 a[72:75], a[144:147], a[168:171], a[72:75]
    s_add_u32 m0, s59, 0
    s_mov_b32 s60, 3932160
    ds_read_b128 a[188:191], v2 offset:62464
    v_mfma_f32_16x16x32_bf16 a[76:79], a[144:147], a[172:175], a[76:79]
    s_waitcnt lgkmcnt(7)
    buffer_load_dwordx4 v16, s[16:19], s60 offen offset:0 lds
    v_mfma_f32_16x16x32_bf16 a[92:95], a[148:151], a[172:175], a[92:95]
    s_waitcnt vmcnt(13)
    ds_read_b64_tr_b16 a[128:129], v4 offset:32768
    v_mfma_f32_16x16x32_bf16 a[88:91], a[148:151], a[168:171], a[88:91]
    ds_read_b64_tr_b16 a[130:131], v4 offset:33280
    v_mfma_f32_16x16x32_bf16 a[84:87], a[148:151], a[164:167], a[84:87]
    v_mfma_f32_16x16x32_bf16 a[80:83], a[148:151], a[160:163], a[80:83]
    s_waitcnt lgkmcnt(6)
    buffer_load_dwordx4 v17, s[16:19], s60 offen offset:1024 lds
    v_mfma_f32_16x16x32_bf16 a[96:99], a[152:155], a[160:163], a[96:99]
    ds_read_b64_tr_b16 a[132:133], v5 offset:32768
    v_mfma_f32_16x16x32_bf16 a[100:103], a[152:155], a[164:167], a[100:103]
    ds_read_b64_tr_b16 a[134:135], v5 offset:33280
    v_mfma_f32_16x16x32_bf16 a[104:107], a[152:155], a[168:171], a[104:107]
    v_mfma_f32_16x16x32_bf16 a[108:111], a[152:155], a[172:175], a[108:111]
    s_waitcnt lgkmcnt(5)
    buffer_load_dwordx4 v18, s[16:19], s60 offen offset:2048 lds
    v_mfma_f32_16x16x32_bf16 a[124:127], a[156:159], a[172:175], a[124:127]
    ds_read_b64_tr_b16 a[136:137], v6 offset:32768
    v_mfma_f32_16x16x32_bf16 a[120:123], a[156:159], a[168:171], a[120:123]
    ds_read_b64_tr_b16 a[138:139], v6 offset:33280
    v_mfma_f32_16x16x32_bf16 a[116:119], a[156:159], a[164:167], a[116:119]
    v_mfma_f32_16x16x32_bf16 a[112:115], a[156:159], a[160:163], a[112:115]
    s_waitcnt lgkmcnt(4)
    buffer_load_dwordx4 v19, s[16:19], s60 offen offset:3072 lds
    v_mfma_f32_16x16x32_bf16 a[0:3], a[128:131], a[176:179], a[0:3]
    ds_read_b64_tr_b16 a[140:141], v7 offset:32768
    v_mfma_f32_16x16x32_bf16 a[4:7], a[128:131], a[180:183], a[4:7]
    ds_read_b64_tr_b16 a[142:143], v7 offset:33280
    v_mfma_f32_16x16x32_bf16 a[8:11], a[128:131], a[184:187], a[8:11]
    s_add_u32 m0, s59, 16384
    s_mov_b32 s60, 3932288
    v_mfma_f32_16x16x32_bf16 a[12:15], a[128:131], a[188:191], a[12:15]
    s_waitcnt lgkmcnt(4)
    buffer_load_dwordx4 v16, s[16:19], s60 offen offset:0 lds
    v_mfma_f32_16x16x32_bf16 a[28:31], a[132:135], a[188:191], a[28:31]
    s_waitcnt vmcnt(13)
    ds_read_b64_tr_b16 a[144:145], v8 offset:0
    v_mfma_f32_16x16x32_bf16 a[24:27], a[132:135], a[184:187], a[24:27]
    ds_read_b64_tr_b16 a[146:147], v8 offset:512
    v_mfma_f32_16x16x32_bf16 a[20:23], a[132:135], a[180:183], a[20:23]
    ds_read_b128 a[160:163], v2 offset:14336
    v_mfma_f32_16x16x32_bf16 a[16:19], a[132:135], a[176:179], a[16:19]
    s_waitcnt lgkmcnt(5)
    buffer_load_dwordx4 v17, s[16:19], s60 offen offset:1024 lds
    v_mfma_f32_16x16x32_bf16 a[32:35], a[136:139], a[176:179], a[32:35]
    ds_read_b64_tr_b16 a[148:149], v9 offset:0
    v_mfma_f32_16x16x32_bf16 a[36:39], a[136:139], a[180:183], a[36:39]
    ds_read_b64_tr_b16 a[150:151], v9 offset:512
    v_mfma_f32_16x16x32_bf16 a[40:43], a[136:139], a[184:187], a[40:43]
    ds_read_b128 a[164:167], v2 offset:30720
    v_mfma_f32_16x16x32_bf16 a[44:47], a[136:139], a[188:191], a[44:47]
    s_waitcnt lgkmcnt(6)
    buffer_load_dwordx4 v18, s[16:19], s60 offen offset:2048 lds
    v_mfma_f32_16x16x32_bf16 a[60:63], a[140:143], a[188:191], a[60:63]
    ds_read_b64_tr_b16 a[152:153], v10 offset:0
    v_mfma_f32_16x16x32_bf16 a[56:59], a[140:143], a[184:187], a[56:59]
    ds_read_b64_tr_b16 a[154:155], v10 offset:512
    v_mfma_f32_16x16x32_bf16 a[52:55], a[140:143], a[180:183], a[52:55]
    ds_read_b128 a[168:171], v2 offset:47104
    v_mfma_f32_16x16x32_bf16 a[48:51], a[140:143], a[176:179], a[48:51]
    s_waitcnt lgkmcnt(7)
    buffer_load_dwordx4 v19, s[16:19], s60 offen offset:3072 lds
    v_mfma_f32_16x16x32_bf16 a[64:67], a[144:147], a[176:179], a[64:67]
    ds_read_b64_tr_b16 a[156:157], v11 offset:0
    v_mfma_f32_16x16x32_bf16 a[68:71], a[144:147], a[180:183], a[68:71]
    ds_read_b64_tr_b16 a[158:159], v11 offset:512
    v_mfma_f32_16x16x32_bf16 a[72:75], a[144:147], a[184:187], a[72:75]
    s_add_u32 m0, s59, 32768
    s_mov_b32 s60, 0
    ds_read_b128 a[172:175], v2 offset:63488
    v_mfma_f32_16x16x32_bf16 a[76:79], a[144:147], a[188:191], a[76:79]
    s_waitcnt lgkmcnt(7)
    buffer_load_dwordx4 v12, s[24:27], s60 offen offset:0 lds
    v_mfma_f32_16x16x32_bf16 a[92:95], a[148:151], a[188:191], a[92:95]
    s_lshl_b32 s56, s54, 8
    s_waitcnt vmcnt(13)
    ds_read_b64_tr_b16 a[128:129], v8 offset:16384
    v_bfe_u32 v45, v1, 1, 2
    v_mfma_f32_16x16x32_bf16 a[88:91], a[148:151], a[184:187], a[88:91]
    ds_read_b64_tr_b16 a[130:131], v8 offset:16896
    v_bfe_u32 v46, v1, 4, 1
    v_mfma_f32_16x16x32_bf16 a[84:87], a[148:151], a[180:183], a[84:87]
    v_xor_b32 v45, v45, v46
    v_and_b32 v46, 1, v1
    v_mfma_f32_16x16x32_bf16 a[80:83], a[148:151], a[176:179], a[80:83]
    s_waitcnt lgkmcnt(6)
    buffer_load_dwordx4 v13, s[24:27], s60 offen offset:1024 lds
    v_lshlrev_b32 v46, 4, v46
    v_mfma_f32_16x16x32_bf16 a[96:99], a[152:155], a[176:179], a[96:99]
    ds_read_b64_tr_b16 a[132:133], v9 offset:16384
    v_lshl_add_u32 v45, v45, 5, v46
    v_mfma_f32_16x16x32_bf16 a[100:103], a[152:155], a[180:183], a[100:103]
    ds_read_b64_tr_b16 a[134:135], v9 offset:16896
    v_bfe_u32 v46, v1, 3, 2
    v_mfma_f32_16x16x32_bf16 a[104:107], a[152:155], a[184:187], a[104:107]
    v_bfe_u32 v47, v1, 5, 1
    v_lshl_add_u32 v46, v47, 4, v46
    v_mfma_f32_16x16x32_bf16 a[108:111], a[152:155], a[188:191], a[108:111]
    s_waitcnt lgkmcnt(5)
    buffer_load_dwordx4 v14, s[24:27], s60 offen offset:2048 lds
    v_mul_u32_u24 v46, 1024, v46
    v_mfma_f32_16x16x32_bf16 a[124:127], a[156:159], a[188:191], a[124:127]
    ds_read_b64_tr_b16 a[136:137], v10 offset:16384
    v_add3_u32 v45, v45, v46, s56
    v_mfma_f32_16x16x32_bf16 a[120:123], a[156:159], a[184:187], a[120:123]
    ds_read_b64_tr_b16 a[138:139], v10 offset:16896
    v_add_u32 v16, 0, v45
    v_mfma_f32_16x16x32_bf16 a[116:119], a[156:159], a[180:183], a[116:119]
    v_bfe_u32 v45, v1, 1, 2
    v_bfe_u32 v46, v1, 4, 1
    v_mfma_f32_16x16x32_bf16 a[112:115], a[156:159], a[176:179], a[112:115]
    s_waitcnt lgkmcnt(4)
    buffer_load_dwordx4 v15, s[24:27], s60 offen offset:3072 lds
    v_xor_b32 v45, v45, v46
    v_mfma_f32_16x16x32_bf16 a[0:3], a[128:131], a[160:163], a[0:3]
    ds_read_b64_tr_b16 a[140:141], v11 offset:16384
    v_xor_b32 v45, 2, v45
    v_mfma_f32_16x16x32_bf16 a[4:7], a[128:131], a[164:167], a[4:7]
    ds_read_b64_tr_b16 a[142:143], v11 offset:16896
    v_and_b32 v46, 1, v1
    v_mfma_f32_16x16x32_bf16 a[8:11], a[128:131], a[168:171], a[8:11]
    s_add_u32 m0, s59, 49152
    s_mov_b32 s60, 0
    v_lshlrev_b32 v46, 4, v46
    v_lshl_add_u32 v45, v45, 5, v46
    v_mfma_f32_16x16x32_bf16 a[12:15], a[128:131], a[172:175], a[12:15]
    s_waitcnt lgkmcnt(4)
    buffer_load_dwordx4 v12, s[28:31], s60 offen offset:0 lds
    v_bfe_u32 v46, v1, 3, 2
    v_mfma_f32_16x16x32_bf16 a[28:31], a[132:135], a[172:175], a[28:31]
    s_waitcnt vmcnt(13)
    ds_read_b64_tr_b16 a[144:145], v8 offset:32768
    v_bfe_u32 v47, v1, 5, 1
    v_mfma_f32_16x16x32_bf16 a[24:27], a[132:135], a[168:171], a[24:27]
    ds_read_b64_tr_b16 a[146:147], v8 offset:33280
    v_lshl_add_u32 v46, v47, 4, v46
    v_mfma_f32_16x16x32_bf16 a[20:23], a[132:135], a[164:167], a[20:23]
    ds_read_b128 a[176:179], v2 offset:15360
    v_mul_u32_u24 v46, 1024, v46
    v_mfma_f32_16x16x32_bf16 a[16:19], a[132:135], a[160:163], a[16:19]
    s_waitcnt lgkmcnt(5)
    buffer_load_dwordx4 v13, s[28:31], s60 offen offset:1024 lds
    v_add3_u32 v45, v45, v46, s56
    v_mfma_f32_16x16x32_bf16 a[32:35], a[136:139], a[160:163], a[32:35]
    ds_read_b64_tr_b16 a[148:149], v9 offset:32768
    v_add_u32 v17, 3072, v45
    v_mfma_f32_16x16x32_bf16 a[36:39], a[136:139], a[164:167], a[36:39]
    ds_read_b64_tr_b16 a[150:151], v9 offset:33280
    v_bfe_u32 v45, v1, 1, 2
    v_mfma_f32_16x16x32_bf16 a[40:43], a[136:139], a[168:171], a[40:43]
    ds_read_b128 a[180:183], v2 offset:31744
    v_bfe_u32 v46, v1, 4, 1
    v_mfma_f32_16x16x32_bf16 a[44:47], a[136:139], a[172:175], a[44:47]
    s_waitcnt lgkmcnt(6)
    buffer_load_dwordx4 v14, s[28:31], s60 offen offset:2048 lds
    v_xor_b32 v45, v45, v46
    v_mfma_f32_16x16x32_bf16 a[60:63], a[140:143], a[172:175], a[60:63]
    ds_read_b64_tr_b16 a[152:153], v10 offset:32768
    v_and_b32 v46, 1, v1
    v_mfma_f32_16x16x32_bf16 a[56:59], a[140:143], a[168:171], a[56:59]
    ds_read_b64_tr_b16 a[154:155], v10 offset:33280
    v_lshlrev_b32 v46, 4, v46
    v_mfma_f32_16x16x32_bf16 a[52:55], a[140:143], a[164:167], a[52:55]
    ds_read_b128 a[184:187], v2 offset:48128
    v_lshl_add_u32 v45, v45, 5, v46
    v_mfma_f32_16x16x32_bf16 a[48:51], a[140:143], a[160:163], a[48:51]
    s_waitcnt lgkmcnt(7)
    buffer_load_dwordx4 v15, s[28:31], s60 offen offset:3072 lds
    v_bfe_u32 v46, v1, 3, 2
    v_mfma_f32_16x16x32_bf16 a[64:67], a[144:147], a[160:163], a[64:67]
    ds_read_b64_tr_b16 a[156:157], v11 offset:32768
    v_bfe_u32 v47, v1, 5, 1
    v_mfma_f32_16x16x32_bf16 a[68:71], a[144:147], a[164:167], a[68:71]
    ds_read_b64_tr_b16 a[158:159], v11 offset:33280
    v_lshl_add_u32 v46, v47, 4, v46
    v_mfma_f32_16x16x32_bf16 a[72:75], a[144:147], a[168:171], a[72:75]
    s_add_u32 m0, s59, 65536
    s_mov_b32 s60, 114688
    ds_read_b128 a[188:191], v2 offset:64512
    v_mul_u32_u24 v46, 1024, v46
    v_mfma_f32_16x16x32_bf16 a[76:79], a[144:147], a[172:175], a[76:79]
    s_waitcnt lgkmcnt(7)
    buffer_load_dwordx4 v12, s[24:27], s60 offen offset:0 lds
    v_add3_u32 v45, v45, v46, s56
    v_mfma_f32_16x16x32_bf16 a[92:95], a[148:151], a[172:175], a[92:95]
    s_waitcnt vmcnt(13)
    ds_read_b64_tr_b16 a[128:129], v4 offset:0
    v_add_u32 v18, 6144, v45
    v_mfma_f32_16x16x32_bf16 a[88:91], a[148:151], a[168:171], a[88:91]
    ds_read_b64_tr_b16 a[130:131], v4 offset:512
    v_bfe_u32 v45, v1, 1, 2
    v_mfma_f32_16x16x32_bf16 a[84:87], a[148:151], a[164:167], a[84:87]
    v_bfe_u32 v46, v1, 4, 1
    v_xor_b32 v45, v45, v46
    v_mfma_f32_16x16x32_bf16 a[80:83], a[148:151], a[160:163], a[80:83]
    s_waitcnt lgkmcnt(6)
    buffer_load_dwordx4 v13, s[24:27], s60 offen offset:1024 lds
    v_xor_b32 v45, 2, v45
    v_mfma_f32_16x16x32_bf16 a[96:99], a[152:155], a[160:163], a[96:99]
    ds_read_b64_tr_b16 a[132:133], v5 offset:0
    v_and_b32 v46, 1, v1
    v_mfma_f32_16x16x32_bf16 a[100:103], a[152:155], a[164:167], a[100:103]
    ds_read_b64_tr_b16 a[134:135], v5 offset:512
    v_lshlrev_b32 v46, 4, v46
    v_mfma_f32_16x16x32_bf16 a[104:107], a[152:155], a[168:171], a[104:107]
    v_lshl_add_u32 v45, v45, 5, v46
    v_bfe_u32 v46, v1, 3, 2
    v_mfma_f32_16x16x32_bf16 a[108:111], a[152:155], a[172:175], a[108:111]
    s_waitcnt lgkmcnt(5)
    buffer_load_dwordx4 v14, s[24:27], s60 offen offset:2048 lds
    v_bfe_u32 v47, v1, 5, 1
    v_mfma_f32_16x16x32_bf16 a[124:127], a[156:159], a[172:175], a[124:127]
    ds_read_b64_tr_b16 a[136:137], v6 offset:0
    v_lshl_add_u32 v46, v47, 4, v46
    v_mfma_f32_16x16x32_bf16 a[120:123], a[156:159], a[168:171], a[120:123]
    ds_read_b64_tr_b16 a[138:139], v6 offset:512
    v_mul_u32_u24 v46, 1024, v46
    v_mfma_f32_16x16x32_bf16 a[116:119], a[156:159], a[164:167], a[116:119]
    v_add3_u32 v45, v45, v46, s56
    v_add_u32 v19, 9216, v45
    s_mul_i32 s67, s54, 458496
    s_lshl_b32 s58, s77, 7
    s_add_u32 s67, s67, s58
    v_mfma_f32_16x16x32_bf16 a[112:115], a[156:159], a[160:163], a[112:115]
    s_waitcnt lgkmcnt(4)
    buffer_load_dwordx4 v15, s[24:27], s60 offen offset:3072 lds
    v_mov_b32 v42, 0x3e0293ee
    v_mfma_f32_16x16x32_bf16 a[0:3], a[128:131], a[176:179], a[0:3]
    ds_read_b64_tr_b16 a[140:141], v7 offset:0
    v_and_b32 v45, 15, v1
    v_mfma_f32_16x16x32_bf16 a[4:7], a[128:131], a[180:183], a[4:7]
    ds_read_b64_tr_b16 a[142:143], v7 offset:512
    v_bfe_u32 v44, v1, 5, 1
    v_mfma_f32_16x16x32_bf16 a[8:11], a[128:131], a[184:187], a[8:11]
    s_add_u32 m0, s59, 81920
    s_mov_b32 s60, 114688
    v_lshl_add_u32 v45, v44, 4, v45
    v_lshlrev_b32 v45, 4, v45
    v_mfma_f32_16x16x32_bf16 a[12:15], a[128:131], a[188:191], a[12:15]
    s_waitcnt lgkmcnt(4)
    buffer_load_dwordx4 v12, s[28:31], s60 offen offset:0 lds
    v_bfe_u32 v44, v1, 4, 1
    v_mfma_f32_16x16x32_bf16 a[28:31], a[132:135], a[188:191], a[28:31]
    s_waitcnt vmcnt(13)
    ds_read_b64_tr_b16 a[144:145], v4 offset:16384
    v_lshl_add_u32 v44, v44, 3, v45
    s_lshl_b32 s56, s54, 14
    v_mfma_f32_16x16x32_bf16 a[24:27], a[132:135], a[184:187], a[24:27]
    ds_read_b64_tr_b16 a[146:147], v4 offset:16896
    v_add_u32 v44, s56, v44
    v_mfma_f32_16x16x32_bf16 a[20:23], a[132:135], a[180:183], a[20:23]
    ds_read_b128 a[160:163], v50 offset:0
    v_accvgpr_write_b32 a224, 0
    v_mfma_f32_16x16x32_bf16 a[16:19], a[132:135], a[176:179], a[16:19]
    s_waitcnt lgkmcnt(5)
    buffer_load_dwordx4 v13, s[28:31], s60 offen offset:1024 lds
    v_accvgpr_write_b32 a225, 0
    v_mfma_f32_16x16x32_bf16 a[32:35], a[136:139], a[176:179], a[32:35]
    ds_read_b64_tr_b16 a[148:149], v5 offset:16384
    v_accvgpr_write_b32 a226, 0
    v_mfma_f32_16x16x32_bf16 a[36:39], a[136:139], a[180:183], a[36:39]
    ds_read_b64_tr_b16 a[150:151], v5 offset:16896
    v_accvgpr_write_b32 a227, 0
    v_mfma_f32_16x16x32_bf16 a[40:43], a[136:139], a[184:187], a[40:43]
    ds_read_b128 a[164:167], v50 offset:16384
    v_accvgpr_write_b32 a228, 0
    v_mfma_f32_16x16x32_bf16 a[44:47], a[136:139], a[188:191], a[44:47]
    s_waitcnt lgkmcnt(6)
    buffer_load_dwordx4 v14, s[28:31], s60 offen offset:2048 lds
    v_accvgpr_write_b32 a229, 0
    v_mfma_f32_16x16x32_bf16 a[60:63], a[140:143], a[188:191], a[60:63]
    ds_read_b64_tr_b16 a[152:153], v6 offset:16384
    v_accvgpr_write_b32 a230, 0
    v_mfma_f32_16x16x32_bf16 a[56:59], a[140:143], a[184:187], a[56:59]
    ds_read_b64_tr_b16 a[154:155], v6 offset:16896
    v_accvgpr_write_b32 a231, 0
    v_mfma_f32_16x16x32_bf16 a[52:55], a[140:143], a[180:183], a[52:55]
    ds_read_b128 a[168:171], v51 offset:32768
    v_accvgpr_write_b32 a232, 0
    v_mfma_f32_16x16x32_bf16 a[48:51], a[140:143], a[176:179], a[48:51]
    s_waitcnt lgkmcnt(7)
    buffer_load_dwordx4 v15, s[28:31], s60 offen offset:3072 lds
    v_accvgpr_write_b32 a233, 0
    v_mfma_f32_16x16x32_bf16 a[64:67], a[144:147], a[176:179], a[64:67]
    ds_read_b64_tr_b16 a[156:157], v7 offset:16384
    v_accvgpr_write_b32 a234, 0
    v_mfma_f32_16x16x32_bf16 a[68:71], a[144:147], a[180:183], a[68:71]
    ds_read_b64_tr_b16 a[158:159], v7 offset:16896
    v_accvgpr_write_b32 a235, 0
    v_mfma_f32_16x16x32_bf16 a[72:75], a[144:147], a[184:187], a[72:75]
    s_add_u32 m0, s59, 0
    s_mov_b32 s60, 229376
    ds_read_b128 a[172:175], v51 offset:49152
    v_accvgpr_write_b32 a236, 0
    v_mfma_f32_16x16x32_bf16 a[76:79], a[144:147], a[188:191], a[76:79]
    s_waitcnt lgkmcnt(7)
    buffer_load_dwordx4 v12, s[24:27], s60 offen offset:0 lds
    v_accvgpr_write_b32 a237, 0
    v_mfma_f32_16x16x32_bf16 a[92:95], a[148:151], a[188:191], a[92:95]
    s_waitcnt vmcnt(13)
    ds_read_b64_tr_b16 a[128:129], v4 offset:32768
    v_accvgpr_write_b32 a238, 0
    v_mfma_f32_16x16x32_bf16 a[88:91], a[148:151], a[184:187], a[88:91]
    ds_read_b64_tr_b16 a[130:131], v4 offset:33280
    v_accvgpr_write_b32 a239, 0
    v_mfma_f32_16x16x32_bf16 a[84:87], a[148:151], a[180:183], a[84:87]
    v_mfma_f32_16x16x32_bf16 a[80:83], a[148:151], a[176:179], a[80:83]
    s_waitcnt lgkmcnt(6)
    buffer_load_dwordx4 v13, s[24:27], s60 offen offset:1024 lds
    v_mfma_f32_16x16x32_bf16 a[96:99], a[152:155], a[176:179], a[96:99]
    ds_read_b64_tr_b16 a[132:133], v5 offset:32768
    v_mfma_f32_16x16x32_bf16 a[100:103], a[152:155], a[180:183], a[100:103]
    ds_read_b64_tr_b16 a[134:135], v5 offset:33280
    v_mfma_f32_16x16x32_bf16 a[104:107], a[152:155], a[184:187], a[104:107]
    v_mfma_f32_16x16x32_bf16 a[108:111], a[152:155], a[188:191], a[108:111]
    s_waitcnt lgkmcnt(5)
    buffer_load_dwordx4 v14, s[24:27], s60 offen offset:2048 lds
    v_mfma_f32_16x16x32_bf16 a[124:127], a[156:159], a[188:191], a[124:127]
    ds_read_b64_tr_b16 a[136:137], v6 offset:32768
    v_mfma_f32_16x16x32_bf16 a[120:123], a[156:159], a[184:187], a[120:123]
    ds_read_b64_tr_b16 a[138:139], v6 offset:33280
    v_mfma_f32_16x16x32_bf16 a[116:119], a[156:159], a[180:183], a[116:119]
    v_mfma_f32_16x16x32_bf16 a[112:115], a[156:159], a[176:179], a[112:115]
    s_waitcnt lgkmcnt(4)
    buffer_load_dwordx4 v15, s[24:27], s60 offen offset:3072 lds
    v_mfma_f32_16x16x32_bf16 v[128:131], a[128:131], a[160:163], 0
    ds_read_b64_tr_b16 a[140:141], v7 offset:32768
    v_mfma_f32_16x16x32_bf16 v[132:135], a[128:131], a[164:167], 0
    ds_read_b64_tr_b16 a[142:143], v7 offset:33280
    v_mfma_f32_16x16x32_bf16 v[136:139], a[128:131], a[168:171], 0
    s_add_u32 m0, s59, 16384
    s_mov_b32 s60, 229376
    v_mfma_f32_16x16x32_bf16 v[140:143], a[128:131], a[172:175], 0
    s_waitcnt lgkmcnt(4)
    buffer_load_dwordx4 v12, s[28:31], s60 offen offset:0 lds
    v_mfma_f32_16x16x32_bf16 v[156:159], a[132:135], a[172:175], 0
    s_waitcnt vmcnt(13)
    ds_read_b64_tr_b16 a[144:145], v8 offset:0
    v_mfma_f32_16x16x32_bf16 v[152:155], a[132:135], a[168:171], 0
    ds_read_b64_tr_b16 a[146:147], v8 offset:512
    v_mfma_f32_16x16x32_bf16 v[148:151], a[132:135], a[164:167], 0
    ds_read_b128 a[176:179], v50 offset:1024
    v_mfma_f32_16x16x32_bf16 v[144:147], a[132:135], a[160:163], 0
    s_waitcnt lgkmcnt(5)
    buffer_load_dwordx4 v13, s[28:31], s60 offen offset:1024 lds
    v_mfma_f32_16x16x32_bf16 v[160:163], a[136:139], a[160:163], 0
    ds_read_b64_tr_b16 a[148:149], v9 offset:0
    v_mfma_f32_16x16x32_bf16 v[164:167], a[136:139], a[164:167], 0
    ds_read_b64_tr_b16 a[150:151], v9 offset:512
    v_mfma_f32_16x16x32_bf16 v[168:171], a[136:139], a[168:171], 0
    ds_read_b128 a[180:183], v50 offset:17408
    v_mfma_f32_16x16x32_bf16 v[172:175], a[136:139], a[172:175], 0
    s_waitcnt lgkmcnt(6)
    buffer_load_dwordx4 v14, s[28:31], s60 offen offset:2048 lds
    v_mfma_f32_16x16x32_bf16 v[188:191], a[140:143], a[172:175], 0
    ds_read_b64_tr_b16 a[152:153], v10 offset:0
    v_accvgpr_read_b32 v64, a0
    v_mfma_f32_16x16x32_bf16 v[184:187], a[140:143], a[168:171], 0
    ds_read_b64_tr_b16 a[154:155], v10 offset:512
    v_accvgpr_read_b32 v72, a4
    v_mfma_f32_16x16x32_bf16 v[180:183], a[140:143], a[164:167], 0
    ds_read_b128 a[184:187], v51 offset:33792
    v_accvgpr_read_b32 v65, a1
    v_mfma_f32_16x16x32_bf16 v[176:179], a[140:143], a[160:163], 0
    s_waitcnt lgkmcnt(7)
    buffer_load_dwordx4 v15, s[28:31], s60 offen offset:3072 lds
    v_accvgpr_read_b32 v73, a5
    v_mfma_f32_16x16x32_bf16 v[192:195], a[144:147], a[160:163], 0
    ds_read_b64_tr_b16 a[156:157], v11 offset:0
    v_accvgpr_read_b32 v66, a2
    v_mfma_f32_16x16x32_bf16 v[196:199], a[144:147], a[164:167], 0
    ds_read_b64_tr_b16 a[158:159], v11 offset:512
    v_accvgpr_read_b32 v74, a6
    v_mfma_f32_16x16x32_bf16 v[200:203], a[144:147], a[168:171], 0
    s_add_u32 m0, s59, 32768
    s_mov_b32 s60, 344064
    ds_read_b128 a[188:191], v51 offset:50176
    v_accvgpr_read_b32 v67, a3
    v_mfma_f32_16x16x32_bf16 v[204:207], a[144:147], a[172:175], 0
    s_waitcnt lgkmcnt(7)
    buffer_load_dwordx4 v12, s[24:27], s60 offen offset:0 lds
    v_accvgpr_read_b32 v75, a7
    v_mfma_f32_16x16x32_bf16 v[220:223], a[148:151], a[172:175], 0
    s_waitcnt vmcnt(13)
    ds_read_b64_tr_b16 a[128:129], v8 offset:16384
    v_accvgpr_read_b32 v68, a16
    v_mfma_f32_16x16x32_bf16 v[216:219], a[148:151], a[168:171], 0
    ds_read_b64_tr_b16 a[130:131], v8 offset:16896
    v_accvgpr_read_b32 v76, a20
    v_mfma_f32_16x16x32_bf16 v[212:215], a[148:151], a[164:167], 0
    v_accvgpr_read_b32 v69, a17
    v_accvgpr_read_b32 v77, a21
    v_mfma_f32_16x16x32_bf16 v[208:211], a[148:151], a[160:163], 0
    s_waitcnt lgkmcnt(6)
    buffer_load_dwordx4 v13, s[24:27], s60 offen offset:1024 lds
    v_accvgpr_read_b32 v70, a18
    v_mfma_f32_16x16x32_bf16 v[224:227], a[152:155], a[160:163], 0
    ds_read_b64_tr_b16 a[132:133], v9 offset:16384
    v_accvgpr_read_b32 v78, a22
    v_mfma_f32_16x16x32_bf16 v[228:231], a[152:155], a[164:167], 0
    ds_read_b64_tr_b16 a[134:135], v9 offset:16896
    v_accvgpr_read_b32 v71, a19
    v_mfma_f32_16x16x32_bf16 v[232:235], a[152:155], a[168:171], 0
    v_accvgpr_read_b32 v79, a23
    v_mul_f32 v64, v42, v64
    v_mfma_f32_16x16x32_bf16 v[236:239], a[152:155], a[172:175], 0
    s_waitcnt lgkmcnt(5)
    buffer_load_dwordx4 v14, s[24:27], s60 offen offset:2048 lds
    v_mul_f32 v72, v42, v72
    v_mfma_f32_16x16x32_bf16 v[252:255], a[156:159], a[172:175], 0
    ds_read_b64_tr_b16 a[136:137], v10 offset:16384
    v_mul_f32 v65, v42, v65
    v_mfma_f32_16x16x32_bf16 v[248:251], a[156:159], a[168:171], 0
    ds_read_b64_tr_b16 a[138:139], v10 offset:16896
    v_mul_f32 v73, v42, v73
    v_mfma_f32_16x16x32_bf16 v[244:247], a[156:159], a[164:167], 0
    v_mul_f32 v66, v42, v66
    v_mul_f32 v74, v42, v74
    v_mfma_f32_16x16x32_bf16 v[240:243], a[156:159], a[160:163], 0
    s_waitcnt lgkmcnt(4)
    buffer_load_dwordx4 v15, s[24:27], s60 offen offset:3072 lds
    v_mul_f32 v67, v42, v67
    v_mfma_f32_16x16x32_bf16 v[128:131], a[128:131], a[176:179], v[128:131]
    ds_read_b64_tr_b16 a[140:141], v11 offset:16384
    v_mul_f32 v75, v42, v75
    v_mfma_f32_16x16x32_bf16 v[132:135], a[128:131], a[180:183], v[132:135]
    ds_read_b64_tr_b16 a[142:143], v11 offset:16896
    v_mul_f32 v68, v42, v68
    v_mfma_f32_16x16x32_bf16 v[136:139], a[128:131], a[184:187], v[136:139]
    s_add_u32 m0, s59, 49152
    s_mov_b32 s60, 344064
    v_mul_f32 v76, v42, v76
    v_mul_f32 v69, v42, v69
    v_mfma_f32_16x16x32_bf16 v[140:143], a[128:131], a[188:191], v[140:143]
    s_waitcnt lgkmcnt(4)
    buffer_load_dwordx4 v12, s[28:31], s60 offen offset:0 lds
    v_mul_f32 v77, v42, v77
    v_mfma_f32_16x16x32_bf16 v[156:159], a[132:135], a[188:191], v[156:159]
    s_waitcnt vmcnt(13)
    ds_read_b64_tr_b16 a[144:145], v8 offset:32768
    v_mul_f32 v70, v42, v70
    v_mfma_f32_16x16x32_bf16 v[152:155], a[132:135], a[184:187], v[152:155]
    ds_read_b64_tr_b16 a[146:147], v8 offset:33280
    v_mul_f32 v78, v42, v78
    v_mfma_f32_16x16x32_bf16 v[148:151], a[132:135], a[180:183], v[148:151]
    ds_read_b128 a[160:163], v50 offset:2048
    v_mul_f32 v71, v42, v71
    v_mfma_f32_16x16x32_bf16 v[144:147], a[132:135], a[176:179], v[144:147]
    s_waitcnt lgkmcnt(5)
    buffer_load_dwordx4 v13, s[28:31], s60 offen offset:1024 lds
    v_mul_f32 v79, v42, v79
    v_mfma_f32_16x16x32_bf16 v[160:163], a[136:139], a[176:179], v[160:163]
    ds_read_b64_tr_b16 a[148:149], v9 offset:32768
    v_cvt_pk_bf16_f32 v64, v64, v65
    v_mfma_f32_16x16x32_bf16 v[164:167], a[136:139], a[180:183], v[164:167]
    ds_read_b64_tr_b16 a[150:151], v9 offset:33280
    v_cvt_pk_bf16_f32 v72, v72, v73
    v_mfma_f32_16x16x32_bf16 v[168:171], a[136:139], a[184:187], v[168:171]
    ds_read_b128 a[164:167], v50 offset:18432
    v_cvt_pk_bf16_f32 v65, v66, v67
    v_mfma_f32_16x16x32_bf16 v[172:175], a[136:139], a[188:191], v[172:175]
    s_waitcnt lgkmcnt(6)
    buffer_load_dwordx4 v14, s[28:31], s60 offen offset:2048 lds
    v_cvt_pk_bf16_f32 v73, v74, v75
    v_mfma_f32_16x16x32_bf16 v[188:191], a[140:143], a[188:191], v[188:191]
    ds_read_b64_tr_b16 a[152:153], v10 offset:32768
    v_cvt_pk_bf16_f32 v66, v68, v69
    v_mfma_f32_16x16x32_bf16 v[184:187], a[140:143], a[184:187], v[184:187]
    ds_read_b64_tr_b16 a[154:155], v10 offset:33280
    v_cvt_pk_bf16_f32 v74, v76, v77
    v_mfma_f32_16x16x32_bf16 v[180:183], a[140:143], a[180:183], v[180:183]
    ds_read_b128 a[168:171], v51 offset:34816
    v_cvt_pk_bf16_f32 v67, v70, v71
    v_mfma_f32_16x16x32_bf16 v[176:179], a[140:143], a[176:179], v[176:179]
    s_waitcnt lgkmcnt(7)
    buffer_load_dwordx4 v15, s[28:31], s60 offen offset:3072 lds
    v_cvt_pk_bf16_f32 v75, v78, v79
    v_mfma_f32_16x16x32_bf16 v[192:195], a[144:147], a[176:179], v[192:195]
    ds_read_b64_tr_b16 a[156:157], v11 offset:32768
    v_permlane32_swap_b32 v64, v66
    v_mfma_f32_16x16x32_bf16 v[196:199], a[144:147], a[180:183], v[196:199]
    ds_read_b64_tr_b16 a[158:159], v11 offset:33280
    v_permlane32_swap_b32 v72, v74
    v_mfma_f32_16x16x32_bf16 v[200:203], a[144:147], a[184:187], v[200:203]
    s_add_u32 m0, s59, 65536
    s_mov_b32 s60, 458752
    ds_read_b128 a[172:175], v51 offset:51200
    v_permlane32_swap_b32 v65, v67
    v_mfma_f32_16x16x32_bf16 v[204:207], a[144:147], a[188:191], v[204:207]
    s_waitcnt lgkmcnt(7)
    buffer_load_dwordx4 v12, s[24:27], s60 offen offset:0 lds
    v_permlane32_swap_b32 v73, v75
    v_mfma_f32_16x16x32_bf16 v[220:223], a[148:151], a[188:191], v[220:223]
    s_waitcnt vmcnt(13)
    ds_read_b64_tr_b16 a[128:129], v4 offset:0
    v_permlane16_swap_b32 v64, v66
    v_mfma_f32_16x16x32_bf16 v[216:219], a[148:151], a[184:187], v[216:219]
    ds_read_b64_tr_b16 a[130:131], v4 offset:512
    v_permlane16_swap_b32 v72, v74
    v_mfma_f32_16x16x32_bf16 v[212:215], a[148:151], a[180:183], v[212:215]
    v_permlane16_swap_b32 v65, v67
    v_permlane16_swap_b32 v73, v75
    v_mfma_f32_16x16x32_bf16 v[208:211], a[148:151], a[176:179], v[208:211]
    s_waitcnt lgkmcnt(6)
    buffer_load_dwordx4 v13, s[24:27], s60 offen offset:1024 lds
    v_accvgpr_write_b32 a0, v64
    v_mfma_f32_16x16x32_bf16 v[224:227], a[152:155], a[176:179], v[224:227]
    ds_read_b64_tr_b16 a[132:133], v5 offset:0
    v_accvgpr_write_b32 a4, v72
    v_mfma_f32_16x16x32_bf16 v[228:231], a[152:155], a[180:183], v[228:231]
    ds_read_b64_tr_b16 a[134:135], v5 offset:512
    v_accvgpr_write_b32 a1, v65
    v_mfma_f32_16x16x32_bf16 v[232:235], a[152:155], a[184:187], v[232:235]
    v_accvgpr_write_b32 a5, v73
    v_accvgpr_write_b32 a2, v66
    v_mfma_f32_16x16x32_bf16 v[236:239], a[152:155], a[188:191], v[236:239]
    s_waitcnt lgkmcnt(5)
    buffer_load_dwordx4 v14, s[24:27], s60 offen offset:2048 lds
    v_accvgpr_write_b32 a6, v74
    v_mfma_f32_16x16x32_bf16 v[252:255], a[156:159], a[188:191], v[252:255]
    ds_read_b64_tr_b16 a[136:137], v6 offset:0
    v_accvgpr_write_b32 a3, v67
    v_mfma_f32_16x16x32_bf16 v[248:251], a[156:159], a[184:187], v[248:251]
    ds_read_b64_tr_b16 a[138:139], v6 offset:512
    v_accvgpr_write_b32 a7, v75
    v_mfma_f32_16x16x32_bf16 v[244:247], a[156:159], a[180:183], v[244:247]
    v_accvgpr_read_b32 v80, a8
    v_accvgpr_read_b32 v88, a12
    v_mfma_f32_16x16x32_bf16 v[240:243], a[156:159], a[176:179], v[240:243]
    s_waitcnt lgkmcnt(4)
    buffer_load_dwordx4 v15, s[24:27], s60 offen offset:3072 lds
    v_accvgpr_read_b32 v81, a9
    v_mfma_f32_16x16x32_bf16 v[128:131], a[128:131], a[160:163], v[128:131]
    ds_read_b64_tr_b16 a[140:141], v7 offset:0
    v_accvgpr_read_b32 v89, a13
    v_mfma_f32_16x16x32_bf16 v[132:135], a[128:131], a[164:167], v[132:135]
    ds_read_b64_tr_b16 a[142:143], v7 offset:512
    v_accvgpr_read_b32 v82, a10
    v_mfma_f32_16x16x32_bf16 v[136:139], a[128:131], a[168:171], v[136:139]
    s_add_u32 m0, s59, 81920
    s_mov_b32 s60, 458752
    v_accvgpr_read_b32 v90, a14
    v_accvgpr_read_b32 v83, a11
    v_mfma_f32_16x16x32_bf16 v[140:143], a[128:131], a[172:175], v[140:143]
    s_waitcnt lgkmcnt(4)
    buffer_load_dwordx4 v12, s[28:31], s60 offen offset:0 lds
    v_accvgpr_read_b32 v91, a15
    v_mfma_f32_16x16x32_bf16 v[156:159], a[132:135], a[172:175], v[156:159]
    s_waitcnt vmcnt(13)
    ds_read_b64_tr_b16 a[144:145], v4 offset:16384
    v_accvgpr_read_b32 v84, a24
    v_mfma_f32_16x16x32_bf16 v[152:155], a[132:135], a[168:171], v[152:155]
    ds_read_b64_tr_b16 a[146:147], v4 offset:16896
    v_accvgpr_read_b32 v92, a28
    v_mfma_f32_16x16x32_bf16 v[148:151], a[132:135], a[164:167], v[148:151]
    ds_read_b128 a[176:179], v50 offset:3072
    v_accvgpr_read_b32 v85, a25
    v_mfma_f32_16x16x32_bf16 v[144:147], a[132:135], a[160:163], v[144:147]
    s_waitcnt lgkmcnt(5)
    buffer_load_dwordx4 v13, s[28:31], s60 offen offset:1024 lds
    v_accvgpr_read_b32 v93, a29
    v_mfma_f32_16x16x32_bf16 v[160:163], a[136:139], a[160:163], v[160:163]
    ds_read_b64_tr_b16 a[148:149], v5 offset:16384
    v_accvgpr_read_b32 v86, a26
    v_mfma_f32_16x16x32_bf16 v[164:167], a[136:139], a[164:167], v[164:167]
    ds_read_b64_tr_b16 a[150:151], v5 offset:16896
    v_accvgpr_read_b32 v94, a30
    v_mfma_f32_16x16x32_bf16 v[168:171], a[136:139], a[168:171], v[168:171]
    ds_read_b128 a[180:183], v50 offset:19456
    v_accvgpr_read_b32 v87, a27
    v_mfma_f32_16x16x32_bf16 v[172:175], a[136:139], a[172:175], v[172:175]
    s_waitcnt lgkmcnt(6)
    buffer_load_dwordx4 v14, s[28:31], s60 offen offset:2048 lds
    v_accvgpr_read_b32 v95, a31
    v_mfma_f32_16x16x32_bf16 v[188:191], a[140:143], a[172:175], v[188:191]
    ds_read_b64_tr_b16 a[152:153], v6 offset:16384
    v_mul_f32 v80, v42, v80
    v_mfma_f32_16x16x32_bf16 v[184:187], a[140:143], a[168:171], v[184:187]
    ds_read_b64_tr_b16 a[154:155], v6 offset:16896
    v_mul_f32 v88, v42, v88
    v_mfma_f32_16x16x32_bf16 v[180:183], a[140:143], a[164:167], v[180:183]
    ds_read_b128 a[184:187], v51 offset:35840
    v_mul_f32 v81, v42, v81
    v_mfma_f32_16x16x32_bf16 v[176:179], a[140:143], a[160:163], v[176:179]
    s_waitcnt lgkmcnt(7)
    buffer_load_dwordx4 v15, s[28:31], s60 offen offset:3072 lds
    v_mul_f32 v89, v42, v89
    v_mfma_f32_16x16x32_bf16 v[192:195], a[144:147], a[160:163], v[192:195]
    ds_read_b64_tr_b16 a[156:157], v7 offset:16384
    v_mul_f32 v82, v42, v82
    v_mfma_f32_16x16x32_bf16 v[196:199], a[144:147], a[164:167], v[196:199]
    ds_read_b64_tr_b16 a[158:159], v7 offset:16896
    v_mul_f32 v90, v42, v90
    v_mfma_f32_16x16x32_bf16 v[200:203], a[144:147], a[168:171], v[200:203]
    s_add_u32 m0, s59, 0
    s_mov_b32 s60, 573440
    ds_read_b128 a[188:191], v51 offset:52224
    v_mul_f32 v83, v42, v83
    v_mfma_f32_16x16x32_bf16 v[204:207], a[144:147], a[172:175], v[204:207]
    s_waitcnt lgkmcnt(7)
    buffer_load_dwordx4 v12, s[24:27], s60 offen offset:0 lds
    v_mul_f32 v91, v42, v91
    v_mfma_f32_16x16x32_bf16 v[220:223], a[148:151], a[172:175], v[220:223]
    s_waitcnt vmcnt(13)
    ds_read_b64_tr_b16 a[128:129], v4 offset:32768
    v_mul_f32 v84, v42, v84
    v_mfma_f32_16x16x32_bf16 v[216:219], a[148:151], a[168:171], v[216:219]
    ds_read_b64_tr_b16 a[130:131], v4 offset:33280
    v_mul_f32 v92, v42, v92
    v_mfma_f32_16x16x32_bf16 v[212:215], a[148:151], a[164:167], v[212:215]
    v_mul_f32 v85, v42, v85
    v_mul_f32 v93, v42, v93
    v_mfma_f32_16x16x32_bf16 v[208:211], a[148:151], a[160:163], v[208:211]
    s_waitcnt lgkmcnt(6)
    buffer_load_dwordx4 v13, s[24:27], s60 offen offset:1024 lds
    v_mul_f32 v86, v42, v86
    v_mfma_f32_16x16x32_bf16 v[224:227], a[152:155], a[160:163], v[224:227]
    ds_read_b64_tr_b16 a[132:133], v5 offset:32768
    v_mul_f32 v94, v42, v94
    v_mfma_f32_16x16x32_bf16 v[228:231], a[152:155], a[164:167], v[228:231]
    ds_read_b64_tr_b16 a[134:135], v5 offset:33280
    v_mul_f32 v87, v42, v87
    v_mfma_f32_16x16x32_bf16 v[232:235], a[152:155], a[168:171], v[232:235]
    v_mul_f32 v95, v42, v95
    v_cvt_pk_bf16_f32 v80, v80, v81
    v_mfma_f32_16x16x32_bf16 v[236:239], a[152:155], a[172:175], v[236:239]
    s_waitcnt lgkmcnt(5)
    buffer_load_dwordx4 v14, s[24:27], s60 offen offset:2048 lds
    v_cvt_pk_bf16_f32 v88, v88, v89
    v_mfma_f32_16x16x32_bf16 v[252:255], a[156:159], a[172:175], v[252:255]
    ds_read_b64_tr_b16 a[136:137], v6 offset:32768
    v_cvt_pk_bf16_f32 v81, v82, v83
    v_mfma_f32_16x16x32_bf16 v[248:251], a[156:159], a[168:171], v[248:251]
    ds_read_b64_tr_b16 a[138:139], v6 offset:33280
    v_cvt_pk_bf16_f32 v89, v90, v91
    v_mfma_f32_16x16x32_bf16 v[244:247], a[156:159], a[164:167], v[244:247]
    v_cvt_pk_bf16_f32 v82, v84, v85
    v_cvt_pk_bf16_f32 v90, v92, v93
    v_mfma_f32_16x16x32_bf16 v[240:243], a[156:159], a[160:163], v[240:243]
    s_waitcnt lgkmcnt(4)
    buffer_load_dwordx4 v15, s[24:27], s60 offen offset:3072 lds
    v_cvt_pk_bf16_f32 v83, v86, v87
    v_mfma_f32_16x16x32_bf16 v[128:131], a[128:131], a[176:179], v[128:131]
    ds_read_b64_tr_b16 a[140:141], v7 offset:32768
    v_cvt_pk_bf16_f32 v91, v94, v95
    v_mfma_f32_16x16x32_bf16 v[132:135], a[128:131], a[180:183], v[132:135]
    ds_read_b64_tr_b16 a[142:143], v7 offset:33280
    v_permlane32_swap_b32 v80, v82
    v_mfma_f32_16x16x32_bf16 v[136:139], a[128:131], a[184:187], v[136:139]
    s_add_u32 m0, s59, 16384
    s_mov_b32 s60, 573440
    v_permlane32_swap_b32 v88, v90
    v_permlane32_swap_b32 v81, v83
    v_mfma_f32_16x16x32_bf16 v[140:143], a[128:131], a[188:191], v[140:143]
    s_waitcnt lgkmcnt(4)
    buffer_load_dwordx4 v12, s[28:31], s60 offen offset:0 lds
    v_permlane32_swap_b32 v89, v91
    v_mfma_f32_16x16x32_bf16 v[156:159], a[132:135], a[188:191], v[156:159]
    s_waitcnt vmcnt(13)
    ds_read_b64_tr_b16 a[144:145], v8 offset:0
    v_permlane16_swap_b32 v80, v82
    v_mfma_f32_16x16x32_bf16 v[152:155], a[132:135], a[184:187], v[152:155]
    ds_read_b64_tr_b16 a[146:147], v8 offset:512
    v_permlane16_swap_b32 v88, v90
    v_mfma_f32_16x16x32_bf16 v[148:151], a[132:135], a[180:183], v[148:151]
    ds_read_b128 a[160:163], v50 offset:4096
    v_permlane16_swap_b32 v81, v83
    v_mfma_f32_16x16x32_bf16 v[144:147], a[132:135], a[176:179], v[144:147]
    s_waitcnt lgkmcnt(5)
    buffer_load_dwordx4 v13, s[28:31], s60 offen offset:1024 lds
    v_permlane16_swap_b32 v89, v91
    v_mfma_f32_16x16x32_bf16 v[160:163], a[136:139], a[176:179], v[160:163]
    ds_read_b64_tr_b16 a[148:149], v9 offset:0
    v_accvgpr_write_b32 a8, v80
    v_mfma_f32_16x16x32_bf16 v[164:167], a[136:139], a[180:183], v[164:167]
    ds_read_b64_tr_b16 a[150:151], v9 offset:512
    v_accvgpr_write_b32 a12, v88
    v_mfma_f32_16x16x32_bf16 v[168:171], a[136:139], a[184:187], v[168:171]
    ds_read_b128 a[164:167], v50 offset:20480
    v_accvgpr_write_b32 a9, v81
    v_mfma_f32_16x16x32_bf16 v[172:175], a[136:139], a[188:191], v[172:175]
    s_waitcnt lgkmcnt(6)
    buffer_load_dwordx4 v14, s[28:31], s60 offen offset:2048 lds
    v_accvgpr_write_b32 a13, v89
    v_mfma_f32_16x16x32_bf16 v[188:191], a[140:143], a[188:191], v[188:191]
    ds_read_b64_tr_b16 a[152:153], v10 offset:0
    v_accvgpr_write_b32 a10, v82
    v_mfma_f32_16x16x32_bf16 v[184:187], a[140:143], a[184:187], v[184:187]
    ds_read_b64_tr_b16 a[154:155], v10 offset:512
    v_accvgpr_write_b32 a14, v90
    v_mfma_f32_16x16x32_bf16 v[180:183], a[140:143], a[180:183], v[180:183]
    ds_read_b128 a[168:171], v51 offset:36864
    v_accvgpr_write_b32 a11, v83
    v_mfma_f32_16x16x32_bf16 v[176:179], a[140:143], a[176:179], v[176:179]
    s_waitcnt lgkmcnt(7)
    buffer_load_dwordx4 v15, s[28:31], s60 offen offset:3072 lds
    v_accvgpr_write_b32 a15, v91
    v_mfma_f32_16x16x32_bf16 v[192:195], a[144:147], a[176:179], v[192:195]
    ds_read_b64_tr_b16 a[156:157], v11 offset:0
    v_accvgpr_read_b32 v64, a32
    v_mfma_f32_16x16x32_bf16 v[196:199], a[144:147], a[180:183], v[196:199]
    ds_read_b64_tr_b16 a[158:159], v11 offset:512
    v_accvgpr_read_b32 v72, a36
    v_mfma_f32_16x16x32_bf16 v[200:203], a[144:147], a[184:187], v[200:203]
    s_add_u32 m0, s59, 32768
    s_mov_b32 s60, 688128
    ds_read_b128 a[172:175], v51 offset:53248
    v_accvgpr_read_b32 v65, a33
    v_mfma_f32_16x16x32_bf16 v[204:207], a[144:147], a[188:191], v[204:207]
    s_waitcnt lgkmcnt(7)
    buffer_load_dwordx4 v12, s[24:27], s60 offen offset:0 lds
    v_accvgpr_read_b32 v73, a37
    v_mfma_f32_16x16x32_bf16 v[220:223], a[148:151], a[188:191], v[220:223]
    s_waitcnt vmcnt(13)
    ds_read_b64_tr_b16 a[128:129], v8 offset:16384
    v_accvgpr_read_b32 v66, a34
    v_mfma_f32_16x16x32_bf16 v[216:219], a[148:151], a[184:187], v[216:219]
    ds_read_b64_tr_b16 a[130:131], v8 offset:16896
    v_accvgpr_read_b32 v74, a38
    v_mfma_f32_16x16x32_bf16 v[212:215], a[148:151], a[180:183], v[212:215]
    v_accvgpr_read_b32 v67, a35
    v_accvgpr_read_b32 v75, a39
    v_mfma_f32_16x16x32_bf16 v[208:211], a[148:151], a[176:179], v[208:211]
    s_waitcnt lgkmcnt(6)
    buffer_load_dwordx4 v13, s[24:27], s60 offen offset:1024 lds
    v_accvgpr_read_b32 v68, a48
    v_mfma_f32_16x16x32_bf16 v[224:227], a[152:155], a[176:179], v[224:227]
    ds_read_b64_tr_b16 a[132:133], v9 offset:16384
    v_accvgpr_read_b32 v76, a52
    v_mfma_f32_16x16x32_bf16 v[228:231], a[152:155], a[180:183], v[228:231]
    ds_read_b64_tr_b16 a[134:135], v9 offset:16896
    v_accvgpr_read_b32 v69, a49
    v_mfma_f32_16x16x32_bf16 v[232:235], a[152:155], a[184:187], v[232:235]
    v_accvgpr_read_b32 v77, a53
    v_accvgpr_read_b32 v70, a50
    v_mfma_f32_16x16x32_bf16 v[236:239], a[152:155], a[188:191], v[236:239]
    s_waitcnt lgkmcnt(5)
    buffer_load_dwordx4 v14, s[24:27], s60 offen offset:2048 lds
    v_accvgpr_read_b32 v78, a54
    v_mfma_f32_16x16x32_bf16 v[252:255], a[156:159], a[188:191], v[252:255]
    ds_read_b64_tr_b16 a[136:137], v10 offset:16384
    v_accvgpr_read_b32 v71, a51
    v_mfma_f32_16x16x32_bf16 v[248:251], a[156:159], a[184:187], v[248:251]
    ds_read_b64_tr_b16 a[138:139], v10 offset:16896
    v_accvgpr_read_b32 v79, a55
    v_mfma_f32_16x16x32_bf16 v[244:247], a[156:159], a[180:183], v[244:247]
    v_mul_f32 v64, v42, v64
    v_mul_f32 v72, v42, v72
    v_mfma_f32_16x16x32_bf16 v[240:243], a[156:159], a[176:179], v[240:243]
    s_waitcnt lgkmcnt(4)
    buffer_load_dwordx4 v15, s[24:27], s60 offen offset:3072 lds
    v_mul_f32 v65, v42, v65
    v_mfma_f32_16x16x32_bf16 v[128:131], a[128:131], a[160:163], v[128:131]
    ds_read_b64_tr_b16 a[140:141], v11 offset:16384
    v_mul_f32 v73, v42, v73
    v_mfma_f32_16x16x32_bf16 v[132:135], a[128:131], a[164:167], v[132:135]
    ds_read_b64_tr_b16 a[142:143], v11 offset:16896
    v_mul_f32 v66, v42, v66
    v_mfma_f32_16x16x32_bf16 v[136:139], a[128:131], a[168:171], v[136:139]
    s_add_u32 m0, s59, 49152
    s_mov_b32 s60, 688128
    v_mul_f32 v74, v42, v74
    v_mul_f32 v67, v42, v67
    v_mfma_f32_16x16x32_bf16 v[140:143], a[128:131], a[172:175], v[140:143]
    s_waitcnt lgkmcnt(4)
    buffer_load_dwordx4 v12, s[28:31], s60 offen offset:0 lds
    v_mul_f32 v75, v42, v75
    v_mfma_f32_16x16x32_bf16 v[156:159], a[132:135], a[172:175], v[156:159]
    s_waitcnt vmcnt(13)
    ds_read_b64_tr_b16 a[144:145], v8 offset:32768
    v_mul_f32 v68, v42, v68
    v_mfma_f32_16x16x32_bf16 v[152:155], a[132:135], a[168:171], v[152:155]
    ds_read_b64_tr_b16 a[146:147], v8 offset:33280
    v_mul_f32 v76, v42, v76
    v_mfma_f32_16x16x32_bf16 v[148:151], a[132:135], a[164:167], v[148:151]
    ds_read_b128 a[176:179], v50 offset:5120
    v_mul_f32 v69, v42, v69
    v_mfma_f32_16x16x32_bf16 v[144:147], a[132:135], a[160:163], v[144:147]
    s_waitcnt lgkmcnt(5)
    buffer_load_dwordx4 v13, s[28:31], s60 offen offset:1024 lds
    v_mul_f32 v77, v42, v77
    v_mfma_f32_16x16x32_bf16 v[160:163], a[136:139], a[160:163], v[160:163]
    ds_read_b64_tr_b16 a[148:149], v9 offset:32768
    v_mul_f32 v70, v42, v70
    v_mfma_f32_16x16x32_bf16 v[164:167], a[136:139], a[164:167], v[164:167]
    ds_read_b64_tr_b16 a[150:151], v9 offset:33280
    v_mul_f32 v78, v42, v78
    v_mfma_f32_16x16x32_bf16 v[168:171], a[136:139], a[168:171], v[168:171]
    ds_read_b128 a[180:183], v50 offset:21504
    v_mul_f32 v71, v42, v71
    v_mfma_f32_16x16x32_bf16 v[172:175], a[136:139], a[172:175], v[172:175]
    s_waitcnt lgkmcnt(6)
    buffer_load_dwordx4 v14, s[28:31], s60 offen offset:2048 lds
    v_mul_f32 v79, v42, v79
    v_mfma_f32_16x16x32_bf16 v[188:191], a[140:143], a[172:175], v[188:191]
    ds_read_b64_tr_b16 a[152:153], v10 offset:32768
    v_cvt_pk_bf16_f32 v64, v64, v65
    v_mfma_f32_16x16x32_bf16 v[184:187], a[140:143], a[168:171], v[184:187]
    ds_read_b64_tr_b16 a[154:155], v10 offset:33280
    v_cvt_pk_bf16_f32 v72, v72, v73
    v_mfma_f32_16x16x32_bf16 v[180:183], a[140:143], a[164:167], v[180:183]
    ds_read_b128 a[184:187], v51 offset:37888
    v_cvt_pk_bf16_f32 v65, v66, v67
    v_mfma_f32_16x16x32_bf16 v[176:179], a[140:143], a[160:163], v[176:179]
    s_waitcnt lgkmcnt(7)
    buffer_load_dwordx4 v15, s[28:31], s60 offen offset:3072 lds
    v_cvt_pk_bf16_f32 v73, v74, v75
    v_mfma_f32_16x16x32_bf16 v[192:195], a[144:147], a[160:163], v[192:195]
    ds_read_b64_tr_b16 a[156:157], v11 offset:32768
    v_cvt_pk_bf16_f32 v66, v68, v69
    v_mfma_f32_16x16x32_bf16 v[196:199], a[144:147], a[164:167], v[196:199]
    ds_read_b64_tr_b16 a[158:159], v11 offset:33280
    v_cvt_pk_bf16_f32 v74, v76, v77
    v_mfma_f32_16x16x32_bf16 v[200:203], a[144:147], a[168:171], v[200:203]
    s_add_u32 m0, s59, 65536
    s_mov_b32 s60, 802816
    ds_read_b128 a[188:191], v51 offset:54272
    v_cvt_pk_bf16_f32 v67, v70, v71
    v_mfma_f32_16x16x32_bf16 v[204:207], a[144:147], a[172:175], v[204:207]
    s_waitcnt lgkmcnt(7)
    buffer_load_dwordx4 v12, s[24:27], s60 offen offset:0 lds
    v_cvt_pk_bf16_f32 v75, v78, v79
    v_mfma_f32_16x16x32_bf16 v[220:223], a[148:151], a[172:175], v[220:223]
    s_waitcnt vmcnt(13)
    ds_read_b64_tr_b16 a[128:129], v4 offset:0
    v_permlane32_swap_b32 v64, v66
    v_mfma_f32_16x16x32_bf16 v[216:219], a[148:151], a[168:171], v[216:219]
    ds_read_b64_tr_b16 a[130:131], v4 offset:512
    v_permlane32_swap_b32 v72, v74
    v_mfma_f32_16x16x32_bf16 v[212:215], a[148:151], a[164:167], v[212:215]
    v_permlane32_swap_b32 v65, v67
    v_permlane32_swap_b32 v73, v75
    v_mfma_f32_16x16x32_bf16 v[208:211], a[148:151], a[160:163], v[208:211]
    s_waitcnt lgkmcnt(6)
    buffer_load_dwordx4 v13, s[24:27], s60 offen offset:1024 lds
    v_permlane16_swap_b32 v64, v66
    v_mfma_f32_16x16x32_bf16 v[224:227], a[152:155], a[160:163], v[224:227]
    ds_read_b64_tr_b16 a[132:133], v5 offset:0
    v_permlane16_swap_b32 v72, v74
    v_mfma_f32_16x16x32_bf16 v[228:231], a[152:155], a[164:167], v[228:231]
    ds_read_b64_tr_b16 a[134:135], v5 offset:512
    v_permlane16_swap_b32 v65, v67
    v_mfma_f32_16x16x32_bf16 v[232:235], a[152:155], a[168:171], v[232:235]
    v_permlane16_swap_b32 v73, v75
    v_accvgpr_write_b32 a32, v64
    v_mfma_f32_16x16x32_bf16 v[236:239], a[152:155], a[172:175], v[236:239]
    s_waitcnt lgkmcnt(5)
    buffer_load_dwordx4 v14, s[24:27], s60 offen offset:2048 lds
    v_accvgpr_write_b32 a36, v72
    v_mfma_f32_16x16x32_bf16 v[252:255], a[156:159], a[172:175], v[252:255]
    ds_read_b64_tr_b16 a[136:137], v6 offset:0
    v_accvgpr_write_b32 a33, v65
    v_mfma_f32_16x16x32_bf16 v[248:251], a[156:159], a[168:171], v[248:251]
    ds_read_b64_tr_b16 a[138:139], v6 offset:512
    v_accvgpr_write_b32 a37, v73
    v_mfma_f32_16x16x32_bf16 v[244:247], a[156:159], a[164:167], v[244:247]
    v_accvgpr_write_b32 a34, v66
    v_accvgpr_write_b32 a38, v74
    v_mfma_f32_16x16x32_bf16 v[240:243], a[156:159], a[160:163], v[240:243]
    s_waitcnt lgkmcnt(4)
    buffer_load_dwordx4 v15, s[24:27], s60 offen offset:3072 lds
    v_accvgpr_write_b32 a35, v67
    v_mfma_f32_16x16x32_bf16 v[128:131], a[128:131], a[176:179], v[128:131]
    ds_read_b64_tr_b16 a[140:141], v7 offset:0
    v_accvgpr_write_b32 a39, v75
    v_mfma_f32_16x16x32_bf16 v[132:135], a[128:131], a[180:183], v[132:135]
    ds_read_b64_tr_b16 a[142:143], v7 offset:512
    v_accvgpr_read_b32 v80, a40
    v_mfma_f32_16x16x32_bf16 v[136:139], a[128:131], a[184:187], v[136:139]
    s_add_u32 m0, s59, 81920
    s_mov_b32 s60, 802816
    v_accvgpr_read_b32 v88, a44
    v_accvgpr_read_b32 v81, a41
    v_mfma_f32_16x16x32_bf16 v[140:143], a[128:131], a[188:191], v[140:143]
    s_waitcnt lgkmcnt(4)
    buffer_load_dwordx4 v12, s[28:31], s60 offen offset:0 lds
    v_accvgpr_read_b32 v89, a45
    v_mfma_f32_16x16x32_bf16 v[156:159], a[132:135], a[188:191], v[156:159]
    s_waitcnt vmcnt(13)
    ds_read_b64_tr_b16 a[144:145], v4 offset:16384
    v_accvgpr_read_b32 v82, a42
    v_mfma_f32_16x16x32_bf16 v[152:155], a[132:135], a[184:187], v[152:155]
    ds_read_b64_tr_b16 a[146:147], v4 offset:16896
    v_accvgpr_read_b32 v90, a46
    v_mfma_f32_16x16x32_bf16 v[148:151], a[132:135], a[180:183], v[148:151]
    ds_read_b128 a[160:163], v50 offset:6144
    v_accvgpr_read_b32 v83, a43
    v_mfma_f32_16x16x32_bf16 v[144:147], a[132:135], a[176:179], v[144:147]
    s_waitcnt lgkmcnt(5)
    buffer_load_dwordx4 v13, s[28:31], s60 offen offset:1024 lds
    v_accvgpr_read_b32 v91, a47
    v_mfma_f32_16x16x32_bf16 v[160:163], a[136:139], a[176:179], v[160:163]
    ds_read_b64_tr_b16 a[148:149], v5 offset:16384
    v_accvgpr_read_b32 v84, a56
    v_mfma_f32_16x16x32_bf16 v[164:167], a[136:139], a[180:183], v[164:167]
    ds_read_b64_tr_b16 a[150:151], v5 offset:16896
    v_accvgpr_read_b32 v92, a60
    v_mfma_f32_16x16x32_bf16 v[168:171], a[136:139], a[184:187], v[168:171]
    ds_read_b128 a[164:167], v50 offset:22528
    v_accvgpr_read_b32 v85, a57
    v_mfma_f32_16x16x32_bf16 v[172:175], a[136:139], a[188:191], v[172:175]
    s_waitcnt lgkmcnt(6)
    buffer_load_dwordx4 v14, s[28:31], s60 offen offset:2048 lds
    v_accvgpr_read_b32 v93, a61
    v_mfma_f32_16x16x32_bf16 v[188:191], a[140:143], a[188:191], v[188:191]
    ds_read_b64_tr_b16 a[152:153], v6 offset:16384
    v_accvgpr_read_b32 v86, a58
    v_mfma_f32_16x16x32_bf16 v[184:187], a[140:143], a[184:187], v[184:187]
    ds_read_b64_tr_b16 a[154:155], v6 offset:16896
    v_accvgpr_read_b32 v94, a62
    v_mfma_f32_16x16x32_bf16 v[180:183], a[140:143], a[180:183], v[180:183]
    ds_read_b128 a[168:171], v51 offset:38912
    v_accvgpr_read_b32 v87, a59
    v_mfma_f32_16x16x32_bf16 v[176:179], a[140:143], a[176:179], v[176:179]
    s_waitcnt lgkmcnt(7)
    buffer_load_dwordx4 v15, s[28:31], s60 offen offset:3072 lds
    v_accvgpr_read_b32 v95, a63
    v_mfma_f32_16x16x32_bf16 v[192:195], a[144:147], a[176:179], v[192:195]
    ds_read_b64_tr_b16 a[156:157], v7 offset:16384
    v_mul_f32 v80, v42, v80
    v_mfma_f32_16x16x32_bf16 v[196:199], a[144:147], a[180:183], v[196:199]
    ds_read_b64_tr_b16 a[158:159], v7 offset:16896
    v_mul_f32 v88, v42, v88
    v_mfma_f32_16x16x32_bf16 v[200:203], a[144:147], a[184:187], v[200:203]
    s_add_u32 m0, s59, 0
    s_mov_b32 s60, 917504
    ds_read_b128 a[172:175], v51 offset:55296
    v_mul_f32 v81, v42, v81
    v_mfma_f32_16x16x32_bf16 v[204:207], a[144:147], a[188:191], v[204:207]
    s_waitcnt lgkmcnt(7)
    buffer_load_dwordx4 v12, s[24:27], s60 offen offset:0 lds
    v_mul_f32 v89, v42, v89
    v_mfma_f32_16x16x32_bf16 v[220:223], a[148:151], a[188:191], v[220:223]
    s_waitcnt vmcnt(13)
    ds_read_b64_tr_b16 a[128:129], v4 offset:32768
    v_mul_f32 v82, v42, v82
    v_mfma_f32_16x16x32_bf16 v[216:219], a[148:151], a[184:187], v[216:219]
    ds_read_b64_tr_b16 a[130:131], v4 offset:33280
    v_mul_f32 v90, v42, v90
    v_mfma_f32_16x16x32_bf16 v[212:215], a[148:151], a[180:183], v[212:215]
    v_mul_f32 v83, v42, v83
    v_mul_f32 v91, v42, v91
    v_mfma_f32_16x16x32_bf16 v[208:211], a[148:151], a[176:179], v[208:211]
    s_waitcnt lgkmcnt(6)
    buffer_load_dwordx4 v13, s[24:27], s60 offen offset:1024 lds
    v_mul_f32 v84, v42, v84
    v_mfma_f32_16x16x32_bf16 v[224:227], a[152:155], a[176:179], v[224:227]
    ds_read_b64_tr_b16 a[132:133], v5 offset:32768
    v_mul_f32 v92, v42, v92
    v_mfma_f32_16x16x32_bf16 v[228:231], a[152:155], a[180:183], v[228:231]
    ds_read_b64_tr_b16 a[134:135], v5 offset:33280
    v_mul_f32 v85, v42, v85
    v_mfma_f32_16x16x32_bf16 v[232:235], a[152:155], a[184:187], v[232:235]
    v_mul_f32 v93, v42, v93
    v_mul_f32 v86, v42, v86
    v_mfma_f32_16x16x32_bf16 v[236:239], a[152:155], a[188:191], v[236:239]
    s_waitcnt lgkmcnt(5)
    buffer_load_dwordx4 v14, s[24:27], s60 offen offset:2048 lds
    v_mul_f32 v94, v42, v94
    v_mfma_f32_16x16x32_bf16 v[252:255], a[156:159], a[188:191], v[252:255]
    ds_read_b64_tr_b16 a[136:137], v6 offset:32768
    v_mul_f32 v87, v42, v87
    v_mfma_f32_16x16x32_bf16 v[248:251], a[156:159], a[184:187], v[248:251]
    ds_read_b64_tr_b16 a[138:139], v6 offset:33280
    v_mul_f32 v95, v42, v95
    v_mfma_f32_16x16x32_bf16 v[244:247], a[156:159], a[180:183], v[244:247]
    v_cvt_pk_bf16_f32 v80, v80, v81
    v_cvt_pk_bf16_f32 v88, v88, v89
    v_mfma_f32_16x16x32_bf16 v[240:243], a[156:159], a[176:179], v[240:243]
    s_waitcnt lgkmcnt(4)
    buffer_load_dwordx4 v15, s[24:27], s60 offen offset:3072 lds
    v_cvt_pk_bf16_f32 v81, v82, v83
    v_mfma_f32_16x16x32_bf16 v[128:131], a[128:131], a[160:163], v[128:131]
    ds_read_b64_tr_b16 a[140:141], v7 offset:32768
    v_cvt_pk_bf16_f32 v89, v90, v91
    v_mfma_f32_16x16x32_bf16 v[132:135], a[128:131], a[164:167], v[132:135]
    ds_read_b64_tr_b16 a[142:143], v7 offset:33280
    v_cvt_pk_bf16_f32 v82, v84, v85
    v_mfma_f32_16x16x32_bf16 v[136:139], a[128:131], a[168:171], v[136:139]
    s_add_u32 m0, s59, 16384
    s_mov_b32 s60, 917504
    v_cvt_pk_bf16_f32 v90, v92, v93
    v_cvt_pk_bf16_f32 v83, v86, v87
    v_mfma_f32_16x16x32_bf16 v[140:143], a[128:131], a[172:175], v[140:143]
    s_waitcnt lgkmcnt(4)
    buffer_load_dwordx4 v12, s[28:31], s60 offen offset:0 lds
    v_cvt_pk_bf16_f32 v91, v94, v95
    v_mfma_f32_16x16x32_bf16 v[156:159], a[132:135], a[172:175], v[156:159]
    s_waitcnt vmcnt(13)
    ds_read_b64_tr_b16 a[144:145], v8 offset:0
    v_permlane32_swap_b32 v80, v82
    v_mfma_f32_16x16x32_bf16 v[152:155], a[132:135], a[168:171], v[152:155]
    ds_read_b64_tr_b16 a[146:147], v8 offset:512
    v_permlane32_swap_b32 v88, v90
    v_mfma_f32_16x16x32_bf16 v[148:151], a[132:135], a[164:167], v[148:151]
    ds_read_b128 a[176:179], v50 offset:7168
    v_permlane32_swap_b32 v81, v83
    v_mfma_f32_16x16x32_bf16 v[144:147], a[132:135], a[160:163], v[144:147]
    s_waitcnt lgkmcnt(5)
    buffer_load_dwordx4 v13, s[28:31], s60 offen offset:1024 lds
    v_permlane32_swap_b32 v89, v91
    v_mfma_f32_16x16x32_bf16 v[160:163], a[136:139], a[160:163], v[160:163]
    ds_read_b64_tr_b16 a[148:149], v9 offset:0
    v_permlane16_swap_b32 v80, v82
    v_mfma_f32_16x16x32_bf16 v[164:167], a[136:139], a[164:167], v[164:167]
    ds_read_b64_tr_b16 a[150:151], v9 offset:512
    v_permlane16_swap_b32 v88, v90
    v_mfma_f32_16x16x32_bf16 v[168:171], a[136:139], a[168:171], v[168:171]
    ds_read_b128 a[180:183], v50 offset:23552
    v_permlane16_swap_b32 v81, v83
    v_mfma_f32_16x16x32_bf16 v[172:175], a[136:139], a[172:175], v[172:175]
    s_waitcnt lgkmcnt(6)
    buffer_load_dwordx4 v14, s[28:31], s60 offen offset:2048 lds
    v_permlane16_swap_b32 v89, v91
    v_mfma_f32_16x16x32_bf16 v[188:191], a[140:143], a[172:175], v[188:191]
    ds_read_b64_tr_b16 a[152:153], v10 offset:0
    v_accvgpr_write_b32 a40, v80
    v_mfma_f32_16x16x32_bf16 v[184:187], a[140:143], a[168:171], v[184:187]
    ds_read_b64_tr_b16 a[154:155], v10 offset:512
    v_accvgpr_write_b32 a44, v88
    v_mfma_f32_16x16x32_bf16 v[180:183], a[140:143], a[164:167], v[180:183]
    ds_read_b128 a[184:187], v51 offset:39936
    v_accvgpr_write_b32 a41, v81
    v_mfma_f32_16x16x32_bf16 v[176:179], a[140:143], a[160:163], v[176:179]
    s_waitcnt lgkmcnt(7)
    buffer_load_dwordx4 v15, s[28:31], s60 offen offset:3072 lds
    v_accvgpr_write_b32 a45, v89
    v_mfma_f32_16x16x32_bf16 v[192:195], a[144:147], a[160:163], v[192:195]
    ds_read_b64_tr_b16 a[156:157], v11 offset:0
    v_accvgpr_write_b32 a42, v82
    v_mfma_f32_16x16x32_bf16 v[196:199], a[144:147], a[164:167], v[196:199]
    ds_read_b64_tr_b16 a[158:159], v11 offset:512
    v_accvgpr_write_b32 a46, v90
    v_mfma_f32_16x16x32_bf16 v[200:203], a[144:147], a[168:171], v[200:203]
    s_add_u32 m0, s59, 32768
    s_mov_b32 s60, 1032192
    ds_read_b128 a[188:191], v51 offset:56320
    v_accvgpr_write_b32 a43, v83
    v_mfma_f32_16x16x32_bf16 v[204:207], a[144:147], a[172:175], v[204:207]
    s_waitcnt lgkmcnt(7)
    buffer_load_dwordx4 v12, s[24:27], s60 offen offset:0 lds
    v_accvgpr_write_b32 a47, v91
    v_mfma_f32_16x16x32_bf16 v[220:223], a[148:151], a[172:175], v[220:223]
    s_waitcnt vmcnt(13)
    ds_read_b64_tr_b16 a[128:129], v8 offset:16384
    v_accvgpr_read_b32 v64, a64
    v_mfma_f32_16x16x32_bf16 v[216:219], a[148:151], a[168:171], v[216:219]
    ds_read_b64_tr_b16 a[130:131], v8 offset:16896
    v_accvgpr_read_b32 v72, a68
    v_mfma_f32_16x16x32_bf16 v[212:215], a[148:151], a[164:167], v[212:215]
    v_accvgpr_read_b32 v65, a65
    v_accvgpr_read_b32 v73, a69
    v_mfma_f32_16x16x32_bf16 v[208:211], a[148:151], a[160:163], v[208:211]
    s_waitcnt lgkmcnt(6)
    buffer_load_dwordx4 v13, s[24:27], s60 offen offset:1024 lds
    v_accvgpr_read_b32 v66, a66
    v_mfma_f32_16x16x32_bf16 v[224:227], a[152:155], a[160:163], v[224:227]
    ds_read_b64_tr_b16 a[132:133], v9 offset:16384
    v_accvgpr_read_b32 v74, a70
    v_mfma_f32_16x16x32_bf16 v[228:231], a[152:155], a[164:167], v[228:231]
    ds_read_b64_tr_b16 a[134:135], v9 offset:16896
    v_accvgpr_read_b32 v67, a67
    v_mfma_f32_16x16x32_bf16 v[232:235], a[152:155], a[168:171], v[232:235]
    v_accvgpr_read_b32 v75, a71
    v_accvgpr_read_b32 v68, a80
    v_mfma_f32_16x16x32_bf16 v[236:239], a[152:155], a[172:175], v[236:239]
    s_waitcnt lgkmcnt(5)
    buffer_load_dwordx4 v14, s[24:27], s60 offen offset:2048 lds
    v_accvgpr_read_b32 v76, a84
    v_mfma_f32_16x16x32_bf16 v[252:255], a[156:159], a[172:175], v[252:255]
    ds_read_b64_tr_b16 a[136:137], v10 offset:16384
    v_accvgpr_read_b32 v69, a81
    v_mfma_f32_16x16x32_bf16 v[248:251], a[156:159], a[168:171], v[248:251]
    ds_read_b64_tr_b16 a[138:139], v10 offset:16896
    v_accvgpr_read_b32 v77, a85
    v_mfma_f32_16x16x32_bf16 v[244:247], a[156:159], a[164:167], v[244:247]
    v_accvgpr_read_b32 v70, a82
    v_accvgpr_read_b32 v78, a86
    v_mfma_f32_16x16x32_bf16 v[240:243], a[156:159], a[160:163], v[240:243]
    s_waitcnt lgkmcnt(4)
    buffer_load_dwordx4 v15, s[24:27], s60 offen offset:3072 lds
    v_accvgpr_read_b32 v71, a83
    v_mfma_f32_16x16x32_bf16 v[128:131], a[128:131], a[176:179], v[128:131]
    ds_read_b64_tr_b16 a[140:141], v11 offset:16384
    v_accvgpr_read_b32 v79, a87
    v_mfma_f32_16x16x32_bf16 v[132:135], a[128:131], a[180:183], v[132:135]
    ds_read_b64_tr_b16 a[142:143], v11 offset:16896
    v_mul_f32 v64, v42, v64
    v_mfma_f32_16x16x32_bf16 v[136:139], a[128:131], a[184:187], v[136:139]
    s_add_u32 m0, s59, 49152
    s_mov_b32 s60, 1032192
    v_mul_f32 v72, v42, v72
    v_mul_f32 v65, v42, v65
    v_mfma_f32_16x16x32_bf16 v[140:143], a[128:131], a[188:191], v[140:143]
    s_waitcnt lgkmcnt(4)
    buffer_load_dwordx4 v12, s[28:31], s60 offen offset:0 lds
    v_mul_f32 v73, v42, v73
    v_mfma_f32_16x16x32_bf16 v[156:159], a[132:135], a[188:191], v[156:159]
    s_waitcnt vmcnt(13)
    ds_read_b64_tr_b16 a[144:145], v8 offset:32768
    v_mul_f32 v66, v42, v66
    v_mfma_f32_16x16x32_bf16 v[152:155], a[132:135], a[184:187], v[152:155]
    ds_read_b64_tr_b16 a[146:147], v8 offset:33280
    v_mul_f32 v74, v42, v74
    v_mfma_f32_16x16x32_bf16 v[148:151], a[132:135], a[180:183], v[148:151]
    ds_read_b128 a[160:163], v50 offset:8192
    v_mul_f32 v67, v42, v67
    v_mfma_f32_16x16x32_bf16 v[144:147], a[132:135], a[176:179], v[144:147]
    s_waitcnt lgkmcnt(5)
    buffer_load_dwordx4 v13, s[28:31], s60 offen offset:1024 lds
    v_mul_f32 v75, v42, v75
    v_mfma_f32_16x16x32_bf16 v[160:163], a[136:139], a[176:179], v[160:163]
    ds_read_b64_tr_b16 a[148:149], v9 offset:32768
    v_mul_f32 v68, v42, v68
    v_mfma_f32_16x16x32_bf16 v[164:167], a[136:139], a[180:183], v[164:167]
    ds_read_b64_tr_b16 a[150:151], v9 offset:33280
    v_mul_f32 v76, v42, v76
    v_mfma_f32_16x16x32_bf16 v[168:171], a[136:139], a[184:187], v[168:171]
    ds_read_b128 a[164:167], v50 offset:24576
    v_mul_f32 v69, v42, v69
    v_mfma_f32_16x16x32_bf16 v[172:175], a[136:139], a[188:191], v[172:175]
    s_waitcnt lgkmcnt(6)
    buffer_load_dwordx4 v14, s[28:31], s60 offen offset:2048 lds
    v_mul_f32 v77, v42, v77
    v_mfma_f32_16x16x32_bf16 v[188:191], a[140:143], a[188:191], v[188:191]
    ds_read_b64_tr_b16 a[152:153], v10 offset:32768
    v_mul_f32 v70, v42, v70
    v_mfma_f32_16x16x32_bf16 v[184:187], a[140:143], a[184:187], v[184:187]
    ds_read_b64_tr_b16 a[154:155], v10 offset:33280
    v_mul_f32 v78, v42, v78
    v_mfma_f32_16x16x32_bf16 v[180:183], a[140:143], a[180:183], v[180:183]
    ds_read_b128 a[168:171], v51 offset:40960
    v_mul_f32 v71, v42, v71
    v_mfma_f32_16x16x32_bf16 v[176:179], a[140:143], a[176:179], v[176:179]
    s_waitcnt lgkmcnt(7)
    buffer_load_dwordx4 v15, s[28:31], s60 offen offset:3072 lds
    v_mul_f32 v79, v42, v79
    v_mfma_f32_16x16x32_bf16 v[192:195], a[144:147], a[176:179], v[192:195]
    ds_read_b64_tr_b16 a[156:157], v11 offset:32768
    v_cvt_pk_bf16_f32 v64, v64, v65
    v_mfma_f32_16x16x32_bf16 v[196:199], a[144:147], a[180:183], v[196:199]
    ds_read_b64_tr_b16 a[158:159], v11 offset:33280
    v_cvt_pk_bf16_f32 v72, v72, v73
    v_mfma_f32_16x16x32_bf16 v[200:203], a[144:147], a[184:187], v[200:203]
    s_add_u32 m0, s59, 65536
    s_mov_b32 s60, 1146880
    ds_read_b128 a[172:175], v51 offset:57344
    v_cvt_pk_bf16_f32 v65, v66, v67
    v_mfma_f32_16x16x32_bf16 v[204:207], a[144:147], a[188:191], v[204:207]
    s_waitcnt lgkmcnt(7)
    buffer_load_dwordx4 v12, s[24:27], s60 offen offset:0 lds
    v_cvt_pk_bf16_f32 v73, v74, v75
    v_mfma_f32_16x16x32_bf16 v[220:223], a[148:151], a[188:191], v[220:223]
    s_waitcnt vmcnt(13)
    ds_read_b64_tr_b16 a[128:129], v4 offset:0
    v_cvt_pk_bf16_f32 v66, v68, v69
    v_mfma_f32_16x16x32_bf16 v[216:219], a[148:151], a[184:187], v[216:219]
    ds_read_b64_tr_b16 a[130:131], v4 offset:512
    v_cvt_pk_bf16_f32 v74, v76, v77
    v_mfma_f32_16x16x32_bf16 v[212:215], a[148:151], a[180:183], v[212:215]
    v_cvt_pk_bf16_f32 v67, v70, v71
    v_cvt_pk_bf16_f32 v75, v78, v79
    v_mfma_f32_16x16x32_bf16 v[208:211], a[148:151], a[176:179], v[208:211]
    s_waitcnt lgkmcnt(6)
    buffer_load_dwordx4 v13, s[24:27], s60 offen offset:1024 lds
    v_permlane32_swap_b32 v64, v66
    v_mfma_f32_16x16x32_bf16 v[224:227], a[152:155], a[176:179], v[224:227]
    ds_read_b64_tr_b16 a[132:133], v5 offset:0
    v_permlane32_swap_b32 v72, v74
    v_mfma_f32_16x16x32_bf16 v[228:231], a[152:155], a[180:183], v[228:231]
    ds_read_b64_tr_b16 a[134:135], v5 offset:512
    v_permlane32_swap_b32 v65, v67
    v_mfma_f32_16x16x32_bf16 v[232:235], a[152:155], a[184:187], v[232:235]
    v_permlane32_swap_b32 v73, v75
    v_permlane16_swap_b32 v64, v66
    v_mfma_f32_16x16x32_bf16 v[236:239], a[152:155], a[188:191], v[236:239]
    s_waitcnt lgkmcnt(5)
    buffer_load_dwordx4 v14, s[24:27], s60 offen offset:2048 lds
    v_permlane16_swap_b32 v72, v74
    v_mfma_f32_16x16x32_bf16 v[252:255], a[156:159], a[188:191], v[252:255]
    ds_read_b64_tr_b16 a[136:137], v6 offset:0
    v_permlane16_swap_b32 v65, v67
    v_mfma_f32_16x16x32_bf16 v[248:251], a[156:159], a[184:187], v[248:251]
    ds_read_b64_tr_b16 a[138:139], v6 offset:512
    v_permlane16_swap_b32 v73, v75
    v_mfma_f32_16x16x32_bf16 v[244:247], a[156:159], a[180:183], v[244:247]
    v_accvgpr_write_b32 a64, v64
    v_accvgpr_write_b32 a68, v72
    v_mfma_f32_16x16x32_bf16 v[240:243], a[156:159], a[176:179], v[240:243]
    s_waitcnt lgkmcnt(4)
    buffer_load_dwordx4 v15, s[24:27], s60 offen offset:3072 lds
    v_accvgpr_write_b32 a65, v65
    v_mfma_f32_16x16x32_bf16 v[128:131], a[128:131], a[160:163], v[128:131]
    ds_read_b64_tr_b16 a[140:141], v7 offset:0
    v_accvgpr_write_b32 a69, v73
    v_mfma_f32_16x16x32_bf16 v[132:135], a[128:131], a[164:167], v[132:135]
    ds_read_b64_tr_b16 a[142:143], v7 offset:512
    v_accvgpr_write_b32 a66, v66
    v_mfma_f32_16x16x32_bf16 v[136:139], a[128:131], a[168:171], v[136:139]
    s_add_u32 m0, s59, 81920
    s_mov_b32 s60, 1146880
    v_accvgpr_write_b32 a70, v74
    v_accvgpr_write_b32 a67, v67
    v_mfma_f32_16x16x32_bf16 v[140:143], a[128:131], a[172:175], v[140:143]
    s_waitcnt lgkmcnt(4)
    buffer_load_dwordx4 v12, s[28:31], s60 offen offset:0 lds
    v_accvgpr_write_b32 a71, v75
    v_mfma_f32_16x16x32_bf16 v[156:159], a[132:135], a[172:175], v[156:159]
    s_waitcnt vmcnt(13)
    ds_read_b64_tr_b16 a[144:145], v4 offset:16384
    v_accvgpr_read_b32 v80, a72
    v_mfma_f32_16x16x32_bf16 v[152:155], a[132:135], a[168:171], v[152:155]
    ds_read_b64_tr_b16 a[146:147], v4 offset:16896
    v_accvgpr_read_b32 v88, a76
    v_mfma_f32_16x16x32_bf16 v[148:151], a[132:135], a[164:167], v[148:151]
    ds_read_b128 a[176:179], v50 offset:9216
    v_accvgpr_read_b32 v81, a73
    v_mfma_f32_16x16x32_bf16 v[144:147], a[132:135], a[160:163], v[144:147]
    s_waitcnt lgkmcnt(5)
    buffer_load_dwordx4 v13, s[28:31], s60 offen offset:1024 lds
    v_accvgpr_read_b32 v89, a77
    v_mfma_f32_16x16x32_bf16 v[160:163], a[136:139], a[160:163], v[160:163]
    ds_read_b64_tr_b16 a[148:149], v5 offset:16384
    v_accvgpr_read_b32 v82, a74
    v_mfma_f32_16x16x32_bf16 v[164:167], a[136:139], a[164:167], v[164:167]
    ds_read_b64_tr_b16 a[150:151], v5 offset:16896
    v_accvgpr_read_b32 v90, a78
    v_mfma_f32_16x16x32_bf16 v[168:171], a[136:139], a[168:171], v[168:171]
    ds_read_b128 a[180:183], v50 offset:25600
    v_accvgpr_read_b32 v83, a75
    v_mfma_f32_16x16x32_bf16 v[172:175], a[136:139], a[172:175], v[172:175]
    s_waitcnt lgkmcnt(6)
    buffer_load_dwordx4 v14, s[28:31], s60 offen offset:2048 lds
    v_accvgpr_read_b32 v91, a79
    v_mfma_f32_16x16x32_bf16 v[188:191], a[140:143], a[172:175], v[188:191]
    ds_read_b64_tr_b16 a[152:153], v6 offset:16384
    v_accvgpr_read_b32 v84, a88
    v_mfma_f32_16x16x32_bf16 v[184:187], a[140:143], a[168:171], v[184:187]
    ds_read_b64_tr_b16 a[154:155], v6 offset:16896
    v_accvgpr_read_b32 v92, a92
    v_mfma_f32_16x16x32_bf16 v[180:183], a[140:143], a[164:167], v[180:183]
    ds_read_b128 a[184:187], v51 offset:41984
    v_accvgpr_read_b32 v85, a89
    v_mfma_f32_16x16x32_bf16 v[176:179], a[140:143], a[160:163], v[176:179]
    s_waitcnt lgkmcnt(7)
    buffer_load_dwordx4 v15, s[28:31], s60 offen offset:3072 lds
    v_accvgpr_read_b32 v93, a93
    v_mfma_f32_16x16x32_bf16 v[192:195], a[144:147], a[160:163], v[192:195]
    ds_read_b64_tr_b16 a[156:157], v7 offset:16384
    v_accvgpr_read_b32 v86, a90
    v_mfma_f32_16x16x32_bf16 v[196:199], a[144:147], a[164:167], v[196:199]
    ds_read_b64_tr_b16 a[158:159], v7 offset:16896
    v_accvgpr_read_b32 v94, a94
    v_mfma_f32_16x16x32_bf16 v[200:203], a[144:147], a[168:171], v[200:203]
    s_add_u32 m0, s59, 0
    s_mov_b32 s60, 1261568
    ds_read_b128 a[188:191], v51 offset:58368
    v_accvgpr_read_b32 v87, a91
    v_mfma_f32_16x16x32_bf16 v[204:207], a[144:147], a[172:175], v[204:207]
    s_waitcnt lgkmcnt(7)
    buffer_load_dwordx4 v12, s[24:27], s60 offen offset:0 lds
    v_accvgpr_read_b32 v95, a95
    v_mfma_f32_16x16x32_bf16 v[220:223], a[148:151], a[172:175], v[220:223]
    s_waitcnt vmcnt(13)
    ds_read_b64_tr_b16 a[128:129], v4 offset:32768
    v_mul_f32 v80, v42, v80
    v_mfma_f32_16x16x32_bf16 v[216:219], a[148:151], a[168:171], v[216:219]
    ds_read_b64_tr_b16 a[130:131], v4 offset:33280
    v_mul_f32 v88, v42, v88
    v_mfma_f32_16x16x32_bf16 v[212:215], a[148:151], a[164:167], v[212:215]
    v_mul_f32 v81, v42, v81
    v_mul_f32 v89, v42, v89
    v_mfma_f32_16x16x32_bf16 v[208:211], a[148:151], a[160:163], v[208:211]
    s_waitcnt lgkmcnt(6)
    buffer_load_dwordx4 v13, s[24:27], s60 offen offset:1024 lds
    v_mul_f32 v82, v42, v82
    v_mfma_f32_16x16x32_bf16 v[224:227], a[152:155], a[160:163], v[224:227]
    ds_read_b64_tr_b16 a[132:133], v5 offset:32768
    v_mul_f32 v90, v42, v90
    v_mfma_f32_16x16x32_bf16 v[228:231], a[152:155], a[164:167], v[228:231]
    ds_read_b64_tr_b16 a[134:135], v5 offset:33280
    v_mul_f32 v83, v42, v83
    v_mfma_f32_16x16x32_bf16 v[232:235], a[152:155], a[168:171], v[232:235]
    v_mul_f32 v91, v42, v91
    v_mul_f32 v84, v42, v84
    v_mfma_f32_16x16x32_bf16 v[236:239], a[152:155], a[172:175], v[236:239]
    s_waitcnt lgkmcnt(5)
    buffer_load_dwordx4 v14, s[24:27], s60 offen offset:2048 lds
    v_mul_f32 v92, v42, v92
    v_mfma_f32_16x16x32_bf16 v[252:255], a[156:159], a[172:175], v[252:255]
    ds_read_b64_tr_b16 a[136:137], v6 offset:32768
    v_mul_f32 v85, v42, v85
    v_mfma_f32_16x16x32_bf16 v[248:251], a[156:159], a[168:171], v[248:251]
    ds_read_b64_tr_b16 a[138:139], v6 offset:33280
    v_mul_f32 v93, v42, v93
    v_mfma_f32_16x16x32_bf16 v[244:247], a[156:159], a[164:167], v[244:247]
    v_mul_f32 v86, v42, v86
    v_mul_f32 v94, v42, v94
    v_mfma_f32_16x16x32_bf16 v[240:243], a[156:159], a[160:163], v[240:243]
    s_waitcnt lgkmcnt(4)
    buffer_load_dwordx4 v15, s[24:27], s60 offen offset:3072 lds
    v_mul_f32 v87, v42, v87
    v_mfma_f32_16x16x32_bf16 v[128:131], a[128:131], a[176:179], v[128:131]
    ds_read_b64_tr_b16 a[140:141], v7 offset:32768
    v_mul_f32 v95, v42, v95
    v_mfma_f32_16x16x32_bf16 v[132:135], a[128:131], a[180:183], v[132:135]
    ds_read_b64_tr_b16 a[142:143], v7 offset:33280
    v_cvt_pk_bf16_f32 v80, v80, v81
    v_mfma_f32_16x16x32_bf16 v[136:139], a[128:131], a[184:187], v[136:139]
    s_add_u32 m0, s59, 16384
    s_mov_b32 s60, 1261568
    v_cvt_pk_bf16_f32 v88, v88, v89
    v_cvt_pk_bf16_f32 v81, v82, v83
    v_mfma_f32_16x16x32_bf16 v[140:143], a[128:131], a[188:191], v[140:143]
    s_waitcnt lgkmcnt(4)
    buffer_load_dwordx4 v12, s[28:31], s60 offen offset:0 lds
    v_cvt_pk_bf16_f32 v89, v90, v91
    v_mfma_f32_16x16x32_bf16 v[156:159], a[132:135], a[188:191], v[156:159]
    s_waitcnt vmcnt(13)
    ds_read_b64_tr_b16 a[144:145], v8 offset:0
    v_cvt_pk_bf16_f32 v82, v84, v85
    v_mfma_f32_16x16x32_bf16 v[152:155], a[132:135], a[184:187], v[152:155]
    ds_read_b64_tr_b16 a[146:147], v8 offset:512
    v_cvt_pk_bf16_f32 v90, v92, v93
    v_mfma_f32_16x16x32_bf16 v[148:151], a[132:135], a[180:183], v[148:151]
    ds_read_b128 a[160:163], v50 offset:10240
    v_cvt_pk_bf16_f32 v83, v86, v87
    v_mfma_f32_16x16x32_bf16 v[144:147], a[132:135], a[176:179], v[144:147]
    s_waitcnt lgkmcnt(5)
    buffer_load_dwordx4 v13, s[28:31], s60 offen offset:1024 lds
    v_cvt_pk_bf16_f32 v91, v94, v95
    v_mfma_f32_16x16x32_bf16 v[160:163], a[136:139], a[176:179], v[160:163]
    ds_read_b64_tr_b16 a[148:149], v9 offset:0
    v_permlane32_swap_b32 v80, v82
    v_mfma_f32_16x16x32_bf16 v[164:167], a[136:139], a[180:183], v[164:167]
    ds_read_b64_tr_b16 a[150:151], v9 offset:512
    v_permlane32_swap_b32 v88, v90
    v_mfma_f32_16x16x32_bf16 v[168:171], a[136:139], a[184:187], v[168:171]
    ds_read_b128 a[164:167], v50 offset:26624
    v_permlane32_swap_b32 v81, v83
    v_mfma_f32_16x16x32_bf16 v[172:175], a[136:139], a[188:191], v[172:175]
    s_waitcnt lgkmcnt(6)
    buffer_load_dwordx4 v14, s[28:31], s60 offen offset:2048 lds
    v_permlane32_swap_b32 v89, v91
    v_mfma_f32_16x16x32_bf16 v[188:191], a[140:143], a[188:191], v[188:191]
    ds_read_b64_tr_b16 a[152:153], v10 offset:0
    v_permlane16_swap_b32 v80, v82
    v_mfma_f32_16x16x32_bf16 v[184:187], a[140:143], a[184:187], v[184:187]
    ds_read_b64_tr_b16 a[154:155], v10 offset:512
    v_permlane16_swap_b32 v88, v90
    v_mfma_f32_16x16x32_bf16 v[180:183], a[140:143], a[180:183], v[180:183]
    ds_read_b128 a[168:171], v51 offset:43008
    v_permlane16_swap_b32 v81, v83
    v_mfma_f32_16x16x32_bf16 v[176:179], a[140:143], a[176:179], v[176:179]
    s_waitcnt lgkmcnt(7)
    buffer_load_dwordx4 v15, s[28:31], s60 offen offset:3072 lds
    v_permlane16_swap_b32 v89, v91
    v_mfma_f32_16x16x32_bf16 v[192:195], a[144:147], a[176:179], v[192:195]
    ds_read_b64_tr_b16 a[156:157], v11 offset:0
    v_accvgpr_write_b32 a72, v80
    v_mfma_f32_16x16x32_bf16 v[196:199], a[144:147], a[180:183], v[196:199]
    ds_read_b64_tr_b16 a[158:159], v11 offset:512
    v_accvgpr_write_b32 a76, v88
    v_mfma_f32_16x16x32_bf16 v[200:203], a[144:147], a[184:187], v[200:203]
    s_add_u32 m0, s59, 32768
    s_mov_b32 s60, 1376256
    ds_read_b128 a[172:175], v51 offset:59392
    v_accvgpr_write_b32 a73, v81
    v_mfma_f32_16x16x32_bf16 v[204:207], a[144:147], a[188:191], v[204:207]
    s_waitcnt lgkmcnt(7)
    buffer_load_dwordx4 v12, s[24:27], s60 offen offset:0 lds
    v_accvgpr_write_b32 a77, v89
    v_mfma_f32_16x16x32_bf16 v[220:223], a[148:151], a[188:191], v[220:223]
    s_waitcnt vmcnt(13)
    ds_read_b64_tr_b16 a[128:129], v8 offset:16384
    v_accvgpr_write_b32 a74, v82
    v_mfma_f32_16x16x32_bf16 v[216:219], a[148:151], a[184:187], v[216:219]
    ds_read_b64_tr_b16 a[130:131], v8 offset:16896
    v_accvgpr_write_b32 a78, v90
    v_mfma_f32_16x16x32_bf16 v[212:215], a[148:151], a[180:183], v[212:215]
    v_accvgpr_write_b32 a75, v83
    v_accvgpr_write_b32 a79, v91
    v_mfma_f32_16x16x32_bf16 v[208:211], a[148:151], a[176:179], v[208:211]
    s_waitcnt lgkmcnt(6)
    buffer_load_dwordx4 v13, s[24:27], s60 offen offset:1024 lds
    v_accvgpr_read_b32 v64, a96
    v_mfma_f32_16x16x32_bf16 v[224:227], a[152:155], a[176:179], v[224:227]
    ds_read_b64_tr_b16 a[132:133], v9 offset:16384
    v_accvgpr_read_b32 v72, a100
    v_mfma_f32_16x16x32_bf16 v[228:231], a[152:155], a[180:183], v[228:231]
    ds_read_b64_tr_b16 a[134:135], v9 offset:16896
    v_accvgpr_read_b32 v65, a97
    v_mfma_f32_16x16x32_bf16 v[232:235], a[152:155], a[184:187], v[232:235]
    v_accvgpr_read_b32 v73, a101
    v_accvgpr_read_b32 v66, a98
    v_mfma_f32_16x16x32_bf16 v[236:239], a[152:155], a[188:191], v[236:239]
    s_waitcnt lgkmcnt(5)
    buffer_load_dwordx4 v14, s[24:27], s60 offen offset:2048 lds
    v_accvgpr_read_b32 v74, a102
    v_mfma_f32_16x16x32_bf16 v[252:255], a[156:159], a[188:191], v[252:255]
    ds_read_b64_tr_b16 a[136:137], v10 offset:16384
    v_accvgpr_read_b32 v67, a99
    v_mfma_f32_16x16x32_bf16 v[248:251], a[156:159], a[184:187], v[248:251]
    ds_read_b64_tr_b16 a[138:139], v10 offset:16896
    v_accvgpr_read_b32 v75, a103
    v_mfma_f32_16x16x32_bf16 v[244:247], a[156:159], a[180:183], v[244:247]
    v_accvgpr_read_b32 v68, a112
    v_accvgpr_read_b32 v76, a116
    v_mfma_f32_16x16x32_bf16 v[240:243], a[156:159], a[176:179], v[240:243]
    s_waitcnt lgkmcnt(4)
    buffer_load_dwordx4 v15, s[24:27], s60 offen offset:3072 lds
    v_accvgpr_read_b32 v69, a113
    v_mfma_f32_16x16x32_bf16 v[128:131], a[128:131], a[160:163], v[128:131]
    ds_read_b64_tr_b16 a[140:141], v11 offset:16384
    v_accvgpr_read_b32 v77, a117
    v_mfma_f32_16x16x32_bf16 v[132:135], a[128:131], a[164:167], v[132:135]
    ds_read_b64_tr_b16 a[142:143], v11 offset:16896
    v_accvgpr_read_b32 v70, a114
    v_mfma_f32_16x16x32_bf16 v[136:139], a[128:131], a[168:171], v[136:139]
    s_add_u32 m0, s59, 49152
    s_mov_b32 s60, 1376256
    v_accvgpr_read_b32 v78, a118
    v_accvgpr_read_b32 v71, a115
    v_mfma_f32_16x16x32_bf16 v[140:143], a[128:131], a[172:175], v[140:143]
    s_waitcnt lgkmcnt(4)
    buffer_load_dwordx4 v12, s[28:31], s60 offen offset:0 lds
    v_accvgpr_read_b32 v79, a119
    v_mfma_f32_16x16x32_bf16 v[156:159], a[132:135], a[172:175], v[156:159]
    s_waitcnt vmcnt(13)
    ds_read_b64_tr_b16 a[144:145], v8 offset:32768
    v_mul_f32 v64, v42, v64
    v_mfma_f32_16x16x32_bf16 v[152:155], a[132:135], a[168:171], v[152:155]
    ds_read_b64_tr_b16 a[146:147], v8 offset:33280
    v_mul_f32 v72, v42, v72
    v_mfma_f32_16x16x32_bf16 v[148:151], a[132:135], a[164:167], v[148:151]
    ds_read_b128 a[176:179], v50 offset:11264
    v_mul_f32 v65, v42, v65
    v_mfma_f32_16x16x32_bf16 v[144:147], a[132:135], a[160:163], v[144:147]
    s_waitcnt lgkmcnt(5)
    buffer_load_dwordx4 v13, s[28:31], s60 offen offset:1024 lds
    v_mul_f32 v73, v42, v73
    v_mfma_f32_16x16x32_bf16 v[160:163], a[136:139], a[160:163], v[160:163]
    ds_read_b64_tr_b16 a[148:149], v9 offset:32768
    v_mul_f32 v66, v42, v66
    v_mfma_f32_16x16x32_bf16 v[164:167], a[136:139], a[164:167], v[164:167]
    ds_read_b64_tr_b16 a[150:151], v9 offset:33280
    v_mul_f32 v74, v42, v74
    v_mfma_f32_16x16x32_bf16 v[168:171], a[136:139], a[168:171], v[168:171]
    ds_read_b128 a[180:183], v50 offset:27648
    v_mul_f32 v67, v42, v67
    v_mfma_f32_16x16x32_bf16 v[172:175], a[136:139], a[172:175], v[172:175]
    s_waitcnt lgkmcnt(6)
    buffer_load_dwordx4 v14, s[28:31], s60 offen offset:2048 lds
    v_mul_f32 v75, v42, v75
    v_mfma_f32_16x16x32_bf16 v[188:191], a[140:143], a[172:175], v[188:191]
    ds_read_b64_tr_b16 a[152:153], v10 offset:32768
    v_mul_f32 v68, v42, v68
    v_mfma_f32_16x16x32_bf16 v[184:187], a[140:143], a[168:171], v[184:187]
    ds_read_b64_tr_b16 a[154:155], v10 offset:33280
    v_mul_f32 v76, v42, v76
    v_mfma_f32_16x16x32_bf16 v[180:183], a[140:143], a[164:167], v[180:183]
    ds_read_b128 a[184:187], v51 offset:44032
    v_mul_f32 v69, v42, v69
    v_mfma_f32_16x16x32_bf16 v[176:179], a[140:143], a[160:163], v[176:179]
    s_waitcnt lgkmcnt(7)
    buffer_load_dwordx4 v15, s[28:31], s60 offen offset:3072 lds
    v_mul_f32 v77, v42, v77
    v_mfma_f32_16x16x32_bf16 v[192:195], a[144:147], a[160:163], v[192:195]
    ds_read_b64_tr_b16 a[156:157], v11 offset:32768
    v_mul_f32 v70, v42, v70
    v_mfma_f32_16x16x32_bf16 v[196:199], a[144:147], a[164:167], v[196:199]
    ds_read_b64_tr_b16 a[158:159], v11 offset:33280
    v_mul_f32 v78, v42, v78
    v_mfma_f32_16x16x32_bf16 v[200:203], a[144:147], a[168:171], v[200:203]
    s_add_u32 m0, s59, 65536
    s_mov_b32 s60, 1490944
    ds_read_b128 a[188:191], v51 offset:60416
    v_mul_f32 v71, v42, v71
    v_mfma_f32_16x16x32_bf16 v[204:207], a[144:147], a[172:175], v[204:207]
    s_waitcnt lgkmcnt(7)
    buffer_load_dwordx4 v12, s[24:27], s60 offen offset:0 lds
    v_mul_f32 v79, v42, v79
    v_mfma_f32_16x16x32_bf16 v[220:223], a[148:151], a[172:175], v[220:223]
    s_waitcnt vmcnt(13)
    ds_read_b64_tr_b16 a[128:129], v4 offset:0
    v_cvt_pk_bf16_f32 v64, v64, v65
    v_mfma_f32_16x16x32_bf16 v[216:219], a[148:151], a[168:171], v[216:219]
    ds_read_b64_tr_b16 a[130:131], v4 offset:512
    v_cvt_pk_bf16_f32 v72, v72, v73
    v_mfma_f32_16x16x32_bf16 v[212:215], a[148:151], a[164:167], v[212:215]
    v_cvt_pk_bf16_f32 v65, v66, v67
    v_cvt_pk_bf16_f32 v73, v74, v75
    v_mfma_f32_16x16x32_bf16 v[208:211], a[148:151], a[160:163], v[208:211]
    s_waitcnt lgkmcnt(6)
    buffer_load_dwordx4 v13, s[24:27], s60 offen offset:1024 lds
    v_cvt_pk_bf16_f32 v66, v68, v69
    v_mfma_f32_16x16x32_bf16 v[224:227], a[152:155], a[160:163], v[224:227]
    ds_read_b64_tr_b16 a[132:133], v5 offset:0
    v_cvt_pk_bf16_f32 v74, v76, v77
    v_mfma_f32_16x16x32_bf16 v[228:231], a[152:155], a[164:167], v[228:231]
    ds_read_b64_tr_b16 a[134:135], v5 offset:512
    v_cvt_pk_bf16_f32 v67, v70, v71
    v_mfma_f32_16x16x32_bf16 v[232:235], a[152:155], a[168:171], v[232:235]
    v_cvt_pk_bf16_f32 v75, v78, v79
    v_permlane32_swap_b32 v64, v66
    v_mfma_f32_16x16x32_bf16 v[236:239], a[152:155], a[172:175], v[236:239]
    s_waitcnt lgkmcnt(5)
    buffer_load_dwordx4 v14, s[24:27], s60 offen offset:2048 lds
    v_permlane32_swap_b32 v72, v74
    v_mfma_f32_16x16x32_bf16 v[252:255], a[156:159], a[172:175], v[252:255]
    ds_read_b64_tr_b16 a[136:137], v6 offset:0
    v_permlane32_swap_b32 v65, v67
    v_mfma_f32_16x16x32_bf16 v[248:251], a[156:159], a[168:171], v[248:251]
    ds_read_b64_tr_b16 a[138:139], v6 offset:512
    v_permlane32_swap_b32 v73, v75
    v_mfma_f32_16x16x32_bf16 v[244:247], a[156:159], a[164:167], v[244:247]
    v_permlane16_swap_b32 v64, v66
    v_permlane16_swap_b32 v72, v74
    v_mfma_f32_16x16x32_bf16 v[240:243], a[156:159], a[160:163], v[240:243]
    s_waitcnt lgkmcnt(4)
    buffer_load_dwordx4 v15, s[24:27], s60 offen offset:3072 lds
    v_permlane16_swap_b32 v65, v67
    v_mfma_f32_16x16x32_bf16 v[128:131], a[128:131], a[176:179], v[128:131]
    ds_read_b64_tr_b16 a[140:141], v7 offset:0
    v_permlane16_swap_b32 v73, v75
    v_mfma_f32_16x16x32_bf16 v[132:135], a[128:131], a[180:183], v[132:135]
    ds_read_b64_tr_b16 a[142:143], v7 offset:512
    v_accvgpr_write_b32 a96, v64
    v_mfma_f32_16x16x32_bf16 v[136:139], a[128:131], a[184:187], v[136:139]
    s_add_u32 m0, s59, 81920
    s_mov_b32 s60, 1490944
    v_accvgpr_write_b32 a100, v72
    v_accvgpr_write_b32 a97, v65
    v_mfma_f32_16x16x32_bf16 v[140:143], a[128:131], a[188:191], v[140:143]
    s_waitcnt lgkmcnt(4)
    buffer_load_dwordx4 v12, s[28:31], s60 offen offset:0 lds
    v_accvgpr_write_b32 a101, v73
    v_mfma_f32_16x16x32_bf16 v[156:159], a[132:135], a[188:191], v[156:159]
    s_waitcnt vmcnt(13)
    ds_read_b64_tr_b16 a[144:145], v4 offset:16384
    v_accvgpr_write_b32 a98, v66
    v_mfma_f32_16x16x32_bf16 v[152:155], a[132:135], a[184:187], v[152:155]
    ds_read_b64_tr_b16 a[146:147], v4 offset:16896
    v_accvgpr_write_b32 a102, v74
    v_mfma_f32_16x16x32_bf16 v[148:151], a[132:135], a[180:183], v[148:151]
    ds_read_b128 a[160:163], v50 offset:12288
    v_accvgpr_write_b32 a99, v67
    v_mfma_f32_16x16x32_bf16 v[144:147], a[132:135], a[176:179], v[144:147]
    s_waitcnt lgkmcnt(5)
    buffer_load_dwordx4 v13, s[28:31], s60 offen offset:1024 lds
    v_accvgpr_write_b32 a103, v75
    v_mfma_f32_16x16x32_bf16 v[160:163], a[136:139], a[176:179], v[160:163]
    ds_read_b64_tr_b16 a[148:149], v5 offset:16384
    v_accvgpr_read_b32 v80, a104
    v_mfma_f32_16x16x32_bf16 v[164:167], a[136:139], a[180:183], v[164:167]
    ds_read_b64_tr_b16 a[150:151], v5 offset:16896
    v_accvgpr_read_b32 v88, a108
    v_mfma_f32_16x16x32_bf16 v[168:171], a[136:139], a[184:187], v[168:171]
    ds_read_b128 a[164:167], v50 offset:28672
    v_accvgpr_read_b32 v81, a105
    v_mfma_f32_16x16x32_bf16 v[172:175], a[136:139], a[188:191], v[172:175]
    s_waitcnt lgkmcnt(6)
    buffer_load_dwordx4 v14, s[28:31], s60 offen offset:2048 lds
    v_accvgpr_read_b32 v89, a109
    v_mfma_f32_16x16x32_bf16 v[188:191], a[140:143], a[188:191], v[188:191]
    ds_read_b64_tr_b16 a[152:153], v6 offset:16384
    v_accvgpr_read_b32 v82, a106
    v_mfma_f32_16x16x32_bf16 v[184:187], a[140:143], a[184:187], v[184:187]
    ds_read_b64_tr_b16 a[154:155], v6 offset:16896
    v_accvgpr_read_b32 v90, a110
    v_mfma_f32_16x16x32_bf16 v[180:183], a[140:143], a[180:183], v[180:183]
    ds_read_b128 a[168:171], v51 offset:45056
    v_accvgpr_read_b32 v83, a107
    v_mfma_f32_16x16x32_bf16 v[176:179], a[140:143], a[176:179], v[176:179]
    s_waitcnt lgkmcnt(7)
    buffer_load_dwordx4 v15, s[28:31], s60 offen offset:3072 lds
    v_accvgpr_read_b32 v91, a111
    v_mfma_f32_16x16x32_bf16 v[192:195], a[144:147], a[176:179], v[192:195]
    ds_read_b64_tr_b16 a[156:157], v7 offset:16384
    v_accvgpr_read_b32 v84, a120
    v_mfma_f32_16x16x32_bf16 v[196:199], a[144:147], a[180:183], v[196:199]
    ds_read_b64_tr_b16 a[158:159], v7 offset:16896
    v_accvgpr_read_b32 v92, a124
    v_mfma_f32_16x16x32_bf16 v[200:203], a[144:147], a[184:187], v[200:203]
    s_add_u32 m0, s59, 0
    s_mov_b32 s60, 1605632
    ds_read_b128 a[172:175], v51 offset:61440
    v_accvgpr_read_b32 v85, a121
    v_mfma_f32_16x16x32_bf16 v[204:207], a[144:147], a[188:191], v[204:207]
    s_waitcnt lgkmcnt(7)
    buffer_load_dwordx4 v12, s[24:27], s60 offen offset:0 lds
    v_accvgpr_read_b32 v93, a125
    v_mfma_f32_16x16x32_bf16 v[220:223], a[148:151], a[188:191], v[220:223]
    s_waitcnt vmcnt(13)
    ds_read_b64_tr_b16 a[128:129], v4 offset:32768
    v_accvgpr_read_b32 v86, a122
    v_mfma_f32_16x16x32_bf16 v[216:219], a[148:151], a[184:187], v[216:219]
    ds_read_b64_tr_b16 a[130:131], v4 offset:33280
    v_accvgpr_read_b32 v94, a126
    v_mfma_f32_16x16x32_bf16 v[212:215], a[148:151], a[180:183], v[212:215]
    v_accvgpr_read_b32 v87, a123
    v_accvgpr_read_b32 v95, a127
    v_mfma_f32_16x16x32_bf16 v[208:211], a[148:151], a[176:179], v[208:211]
    s_waitcnt lgkmcnt(6)
    buffer_load_dwordx4 v13, s[24:27], s60 offen offset:1024 lds
    v_mul_f32 v80, v42, v80
    v_mfma_f32_16x16x32_bf16 v[224:227], a[152:155], a[176:179], v[224:227]
    ds_read_b64_tr_b16 a[132:133], v5 offset:32768
    v_mul_f32 v88, v42, v88
    v_mfma_f32_16x16x32_bf16 v[228:231], a[152:155], a[180:183], v[228:231]
    ds_read_b64_tr_b16 a[134:135], v5 offset:33280
    v_mul_f32 v81, v42, v81
    v_mfma_f32_16x16x32_bf16 v[232:235], a[152:155], a[184:187], v[232:235]
    v_mul_f32 v89, v42, v89
    v_mul_f32 v82, v42, v82
    v_mfma_f32_16x16x32_bf16 v[236:239], a[152:155], a[188:191], v[236:239]
    s_waitcnt lgkmcnt(5)
    buffer_load_dwordx4 v14, s[24:27], s60 offen offset:2048 lds
    v_mul_f32 v90, v42, v90
    v_mfma_f32_16x16x32_bf16 v[252:255], a[156:159], a[188:191], v[252:255]
    ds_read_b64_tr_b16 a[136:137], v6 offset:32768
    v_mul_f32 v83, v42, v83
    v_mfma_f32_16x16x32_bf16 v[248:251], a[156:159], a[184:187], v[248:251]
    ds_read_b64_tr_b16 a[138:139], v6 offset:33280
    v_mul_f32 v91, v42, v91
    v_mfma_f32_16x16x32_bf16 v[244:247], a[156:159], a[180:183], v[244:247]
    v_mul_f32 v84, v42, v84
    v_mul_f32 v92, v42, v92
    v_mfma_f32_16x16x32_bf16 v[240:243], a[156:159], a[176:179], v[240:243]
    s_waitcnt lgkmcnt(4)
    buffer_load_dwordx4 v15, s[24:27], s60 offen offset:3072 lds
    v_mul_f32 v85, v42, v85
    v_mfma_f32_16x16x32_bf16 v[128:131], a[128:131], a[160:163], v[128:131]
    ds_read_b64_tr_b16 a[140:141], v7 offset:32768
    v_mul_f32 v93, v42, v93
    v_mfma_f32_16x16x32_bf16 v[132:135], a[128:131], a[164:167], v[132:135]
    ds_read_b64_tr_b16 a[142:143], v7 offset:33280
    v_mul_f32 v86, v42, v86
    v_mfma_f32_16x16x32_bf16 v[136:139], a[128:131], a[168:171], v[136:139]
    s_add_u32 m0, s59, 16384
    s_mov_b32 s60, 1605632
    v_mul_f32 v94, v42, v94
    v_mul_f32 v87, v42, v87
    v_mfma_f32_16x16x32_bf16 v[140:143], a[128:131], a[172:175], v[140:143]
    s_waitcnt lgkmcnt(4)
    buffer_load_dwordx4 v12, s[28:31], s60 offen offset:0 lds
    v_mul_f32 v95, v42, v95
    v_mfma_f32_16x16x32_bf16 v[156:159], a[132:135], a[172:175], v[156:159]
    s_waitcnt vmcnt(13)
    ds_read_b64_tr_b16 a[144:145], v8 offset:0
    v_cvt_pk_bf16_f32 v80, v80, v81
    v_mfma_f32_16x16x32_bf16 v[152:155], a[132:135], a[168:171], v[152:155]
    ds_read_b64_tr_b16 a[146:147], v8 offset:512
    v_cvt_pk_bf16_f32 v88, v88, v89
    v_mfma_f32_16x16x32_bf16 v[148:151], a[132:135], a[164:167], v[148:151]
    ds_read_b128 a[176:179], v50 offset:13312
    v_cvt_pk_bf16_f32 v81, v82, v83
    v_mfma_f32_16x16x32_bf16 v[144:147], a[132:135], a[160:163], v[144:147]
    s_waitcnt lgkmcnt(5)
    buffer_load_dwordx4 v13, s[28:31], s60 offen offset:1024 lds
    v_cvt_pk_bf16_f32 v89, v90, v91
    v_mfma_f32_16x16x32_bf16 v[160:163], a[136:139], a[160:163], v[160:163]
    ds_read_b64_tr_b16 a[148:149], v9 offset:0
    v_cvt_pk_bf16_f32 v82, v84, v85
    v_mfma_f32_16x16x32_bf16 v[164:167], a[136:139], a[164:167], v[164:167]
    ds_read_b64_tr_b16 a[150:151], v9 offset:512
    v_cvt_pk_bf16_f32 v90, v92, v93
    v_mfma_f32_16x16x32_bf16 v[168:171], a[136:139], a[168:171], v[168:171]
    ds_read_b128 a[180:183], v50 offset:29696
    v_cvt_pk_bf16_f32 v83, v86, v87
    v_mfma_f32_16x16x32_bf16 v[172:175], a[136:139], a[172:175], v[172:175]
    s_waitcnt lgkmcnt(6)
    buffer_load_dwordx4 v14, s[28:31], s60 offen offset:2048 lds
    v_cvt_pk_bf16_f32 v91, v94, v95
    v_mfma_f32_16x16x32_bf16 v[188:191], a[140:143], a[172:175], v[188:191]
    ds_read_b64_tr_b16 a[152:153], v10 offset:0
    v_permlane32_swap_b32 v80, v82
    v_mfma_f32_16x16x32_bf16 v[184:187], a[140:143], a[168:171], v[184:187]
    ds_read_b64_tr_b16 a[154:155], v10 offset:512
    v_permlane32_swap_b32 v88, v90
    v_mfma_f32_16x16x32_bf16 v[180:183], a[140:143], a[164:167], v[180:183]
    ds_read_b128 a[184:187], v51 offset:46080
    v_permlane32_swap_b32 v81, v83
    v_mfma_f32_16x16x32_bf16 v[176:179], a[140:143], a[160:163], v[176:179]
    s_waitcnt lgkmcnt(7)
    buffer_load_dwordx4 v15, s[28:31], s60 offen offset:3072 lds
    v_permlane32_swap_b32 v89, v91
    v_mfma_f32_16x16x32_bf16 v[192:195], a[144:147], a[160:163], v[192:195]
    ds_read_b64_tr_b16 a[156:157], v11 offset:0
    v_permlane16_swap_b32 v80, v82
    v_mfma_f32_16x16x32_bf16 v[196:199], a[144:147], a[164:167], v[196:199]
    ds_read_b64_tr_b16 a[158:159], v11 offset:512
    v_permlane16_swap_b32 v88, v90
    v_mfma_f32_16x16x32_bf16 v[200:203], a[144:147], a[168:171], v[200:203]
    s_add_u32 m0, s59, 32768
    s_mov_b32 s60, 1720320
    ds_read_b128 a[188:191], v51 offset:62464
    v_permlane16_swap_b32 v81, v83
    v_mfma_f32_16x16x32_bf16 v[204:207], a[144:147], a[172:175], v[204:207]
    s_waitcnt lgkmcnt(7)
    buffer_load_dwordx4 v12, s[24:27], s60 offen offset:0 lds
    v_permlane16_swap_b32 v89, v91
    v_mfma_f32_16x16x32_bf16 v[220:223], a[148:151], a[172:175], v[220:223]
    s_waitcnt vmcnt(13)
    ds_read_b64_tr_b16 a[128:129], v8 offset:16384
    v_accvgpr_write_b32 a104, v80
    v_mfma_f32_16x16x32_bf16 v[216:219], a[148:151], a[168:171], v[216:219]
    ds_read_b64_tr_b16 a[130:131], v8 offset:16896
    v_accvgpr_write_b32 a108, v88
    v_mfma_f32_16x16x32_bf16 v[212:215], a[148:151], a[164:167], v[212:215]
    v_accvgpr_write_b32 a105, v81
    v_accvgpr_write_b32 a109, v89
    v_mfma_f32_16x16x32_bf16 v[208:211], a[148:151], a[160:163], v[208:211]
    s_waitcnt lgkmcnt(6)
    buffer_load_dwordx4 v13, s[24:27], s60 offen offset:1024 lds
    v_accvgpr_write_b32 a106, v82
    v_mfma_f32_16x16x32_bf16 v[224:227], a[152:155], a[160:163], v[224:227]
    ds_read_b64_tr_b16 a[132:133], v9 offset:16384
    v_accvgpr_write_b32 a110, v90
    v_mfma_f32_16x16x32_bf16 v[228:231], a[152:155], a[164:167], v[228:231]
    ds_read_b64_tr_b16 a[134:135], v9 offset:16896
    v_accvgpr_write_b32 a107, v83
    v_mfma_f32_16x16x32_bf16 v[232:235], a[152:155], a[168:171], v[232:235]
    v_accvgpr_write_b32 a111, v91
    v_mfma_f32_16x16x32_bf16 v[236:239], a[152:155], a[172:175], v[236:239]
    s_waitcnt lgkmcnt(5)
    buffer_load_dwordx4 v14, s[24:27], s60 offen offset:2048 lds
    v_mfma_f32_16x16x32_bf16 v[252:255], a[156:159], a[172:175], v[252:255]
    ds_read_b64_tr_b16 a[136:137], v10 offset:16384
    v_mfma_f32_16x16x32_bf16 v[248:251], a[156:159], a[168:171], v[248:251]
    ds_read_b64_tr_b16 a[138:139], v10 offset:16896
    v_mfma_f32_16x16x32_bf16 v[244:247], a[156:159], a[164:167], v[244:247]
    v_mfma_f32_16x16x32_bf16 v[240:243], a[156:159], a[160:163], v[240:243]
    s_waitcnt lgkmcnt(4)
    buffer_load_dwordx4 v15, s[24:27], s60 offen offset:3072 lds
    v_mfma_f32_16x16x32_bf16 v[128:131], a[128:131], a[176:179], v[128:131]
    ds_read_b64_tr_b16 a[140:141], v11 offset:16384
    v_mfma_f32_16x16x32_bf16 v[132:135], a[128:131], a[180:183], v[132:135]
    ds_read_b64_tr_b16 a[142:143], v11 offset:16896
    v_mfma_f32_16x16x32_bf16 v[136:139], a[128:131], a[184:187], v[136:139]
    s_add_u32 m0, s59, 49152
    s_mov_b32 s60, 1720320
    v_mfma_f32_16x16x32_bf16 v[140:143], a[128:131], a[188:191], v[140:143]
    s_waitcnt lgkmcnt(4)
    buffer_load_dwordx4 v12, s[28:31], s60 offen offset:0 lds
    v_mfma_f32_16x16x32_bf16 v[156:159], a[132:135], a[188:191], v[156:159]
    s_waitcnt vmcnt(13)
    ds_read_b64_tr_b16 a[144:145], v8 offset:32768
    v_mfma_f32_16x16x32_bf16 v[152:155], a[132:135], a[184:187], v[152:155]
    ds_read_b64_tr_b16 a[146:147], v8 offset:33280
    v_mfma_f32_16x16x32_bf16 v[148:151], a[132:135], a[180:183], v[148:151]
    ds_read_b128 a[160:163], v50 offset:14336
    v_mfma_f32_16x16x32_bf16 v[144:147], a[132:135], a[176:179], v[144:147]
    s_waitcnt lgkmcnt(5)
    buffer_load_dwordx4 v13, s[28:31], s60 offen offset:1024 lds
    v_mfma_f32_16x16x32_bf16 v[160:163], a[136:139], a[176:179], v[160:163]
    ds_read_b64_tr_b16 a[148:149], v9 offset:32768
    v_mfma_f32_16x16x32_bf16 v[164:167], a[136:139], a[180:183], v[164:167]
    ds_read_b64_tr_b16 a[150:151], v9 offset:33280
    v_mfma_f32_16x16x32_bf16 v[168:171], a[136:139], a[184:187], v[168:171]
    ds_read_b128 a[164:167], v50 offset:30720
    v_mfma_f32_16x16x32_bf16 v[172:175], a[136:139], a[188:191], v[172:175]
    s_waitcnt lgkmcnt(6)
    buffer_load_dwordx4 v14, s[28:31], s60 offen offset:2048 lds
    v_mfma_f32_16x16x32_bf16 v[188:191], a[140:143], a[188:191], v[188:191]
    ds_read_b64_tr_b16 a[152:153], v10 offset:32768
    v_mfma_f32_16x16x32_bf16 v[184:187], a[140:143], a[184:187], v[184:187]
    ds_read_b64_tr_b16 a[154:155], v10 offset:33280
    v_mfma_f32_16x16x32_bf16 v[180:183], a[140:143], a[180:183], v[180:183]
    ds_read_b128 a[168:171], v51 offset:47104
    v_mfma_f32_16x16x32_bf16 v[176:179], a[140:143], a[176:179], v[176:179]
    s_waitcnt lgkmcnt(7)
    buffer_load_dwordx4 v15, s[28:31], s60 offen offset:3072 lds
    v_mfma_f32_16x16x32_bf16 v[192:195], a[144:147], a[176:179], v[192:195]
    ds_read_b64_tr_b16 a[156:157], v11 offset:32768
    v_mfma_f32_16x16x32_bf16 v[196:199], a[144:147], a[180:183], v[196:199]
    ds_read_b64_tr_b16 a[158:159], v11 offset:33280
    v_mfma_f32_16x16x32_bf16 v[200:203], a[144:147], a[184:187], v[200:203]
    s_add_u32 m0, s59, 65536
    s_mov_b32 s60, 0
    ds_read_b128 a[172:175], v51 offset:63488
    v_mfma_f32_16x16x32_bf16 v[204:207], a[144:147], a[188:191], v[204:207]
    s_waitcnt lgkmcnt(7)
    buffer_load_dwordx4 v32, s[8:11], s60 offen offset:0 lds
    v_mfma_f32_16x16x32_bf16 v[220:223], a[148:151], a[188:191], v[220:223]
    s_add_u32 s55, s54, 0
    s_sub_u32 s56, s55, 2
    s_min_u32 s56, s56, 6
    s_lshl_b32 s56, s56, 13
    s_lshr_b32 s57, s2, 3
    s_mul_i32 s57, s57, 57344
    s_add_u32 s56, s56, s57
    s_add_u32 s24, s32, s56
    s_addc_u32 s25, s33, 0
    s_lshr_b32 s56, s2, 3
    s_lshl_b32 s56, s56, 14
    s_lshl_b32 s57, s54, 13
    s_add_u32 s56, s56, s57
    s_add_u32 s26, s20, s56
    s_addc_u32 s27, s21, 0
    s_cmp_lt_u32 s54, 2
    s_cselect_b64 s[24:25], s[26:27], s[24:25]
    s_add_u32 s55, s54, 4
    s_sub_u32 s56, s55, 2
    s_min_u32 s56, s56, 6
    s_lshl_b32 s56, s56, 13
    s_lshr_b32 s57, s2, 3
    s_mul_i32 s57, s57, 57344
    s_add_u32 s56, s56, s57
    s_add_u32 s26, s32, s56
    s_addc_u32 s27, s33, 0
    s_add_u32 s55, s54, 8
    s_sub_u32 s56, s55, 2
    s_min_u32 s56, s56, 6
    s_lshl_b32 s56, s56, 13
    s_lshr_b32 s57, s2, 3
    s_mul_i32 s57, s57, 57344
    s_add_u32 s56, s56, s57
    s_add_u32 s28, s32, s56
    s_addc_u32 s29, s33, 0
    s_getpc_b64 s[30:31]
L_pc1:
    s_lshl_b32 s55, s54, 13
    s_add_u32 s55, s55, L_tail-L_pc1
    s_min_u32 s55, s55, L_code_end-L_pc1-8192
    s_add_u32 s56, s55, 24576
    s_min_u32 s56, s56, L_code_end-L_pc1-8192
    s_add_u32 s94, s30, s56
    s_addc_u32 s95, s31, 0
    s_cmp_lt_u32 s54, 1
    s_cselect_b64 s[28:29], s[28:29], s[94:95]
    s_add_u32 s30, s30, s55
    s_addc_u32 s31, s31, 0
    s_lshl_b32 s55, s77, 2
    s_add_u32 s55, s55, s54
    s_mul_i32 s55, s55, 7168
    s_min_u32 s55, s55, 221184
    s_add_u32 s94, s80, s55
    s_addc_u32 s95, s81, 0
    s_lshl_b32 s3, s76, 3
    s_waitcnt vmcnt(13)
    ds_read_b64_tr_b16 a[128:129], v4 offset:0
    v_mfma_f32_16x16x32_bf16 v[216:219], a[148:151], a[184:187], v[216:219]
    ds_read_b64_tr_b16 a[130:131], v4 offset:512
    v_mfma_f32_16x16x32_bf16 v[212:215], a[148:151], a[180:183], v[212:215]
    v_mfma_f32_16x16x32_bf16 v[208:211], a[148:151], a[176:179], v[208:211]
    s_waitcnt lgkmcnt(6)
    buffer_load_dwordx4 v33, s[8:11], s60 offen offset:1024 lds
    v_mfma_f32_16x16x32_bf16 v[224:227], a[152:155], a[176:179], v[224:227]
    ds_read_b64_tr_b16 a[132:133], v5 offset:0
    v_mfma_f32_16x16x32_bf16 v[228:231], a[152:155], a[180:183], v[228:231]
    ds_read_b64_tr_b16 a[134:135], v5 offset:512
    v_mfma_f32_16x16x32_bf16 v[232:235], a[152:155], a[184:187], v[232:235]
    v_mfma_f32_16x16x32_bf16 v[236:239], a[152:155], a[188:191], v[236:239]
    s_waitcnt lgkmcnt(5)
    buffer_load_dwordx4 v34, s[8:11], s60 offen offset:2048 lds
    v_mfma_f32_16x16x32_bf16 v[252:255], a[156:159], a[188:191], v[252:255]
    ds_read_b64_tr_b16 a[136:137], v6 offset:0
    v_mfma_f32_16x16x32_bf16 v[248:251], a[156:159], a[184:187], v[248:251]
    ds_read_b64_tr_b16 a[138:139], v6 offset:512
    v_mfma_f32_16x16x32_bf16 v[244:247], a[156:159], a[180:183], v[244:247]
    v_mfma_f32_16x16x32_bf16 v[240:243], a[156:159], a[176:179], v[240:243]
    s_waitcnt lgkmcnt(4)
    buffer_load_dwordx4 v35, s[8:11], s60 offen offset:3072 lds
    v_mfma_f32_16x16x32_bf16 v[128:131], a[128:131], a[160:163], v[128:131]
    ds_read_b64_tr_b16 a[140:141], v7 offset:0
    v_mfma_f32_16x16x32_bf16 v[132:135], a[128:131], a[164:167], v[132:135]
    ds_read_b64_tr_b16 a[142:143], v7 offset:512
    v_mfma_f32_16x16x32_bf16 v[136:139], a[128:131], a[168:171], v[136:139]
    s_add_u32 m0, s59, 81920
    s_mov_b32 s60, 8192
    v_mfma_f32_16x16x32_bf16 v[140:143], a[128:131], a[172:175], v[140:143]
    s_waitcnt lgkmcnt(4)
    buffer_load_dwordx4 v32, s[8:11], s60 offen offset:0 lds
    v_mfma_f32_16x16x32_bf16 v[156:159], a[132:135], a[172:175], v[156:159]
    s_waitcnt vmcnt(13)
    ds_read_b64_tr_b16 a[144:145], v4 offset:16384
    v_mfma_f32_16x16x32_bf16 v[152:155], a[132:135], a[168:171], v[152:155]
    ds_read_b64_tr_b16 a[146:147], v4 offset:16896
    v_mfma_f32_16x16x32_bf16 v[148:151], a[132:135], a[164:167], v[148:151]
    ds_read_b128 a[176:179], v50 offset:15360
    v_mfma_f32_16x16x32_bf16 v[144:147], a[132:135], a[160:163], v[144:147]
    s_waitcnt lgkmcnt(5)
    buffer_load_dwordx4 v33, s[8:11], s60 offen offset:1024 lds
    v_mfma_f32_16x16x32_bf16 v[160:163], a[136:139], a[160:163], v[160:163]
    ds_read_b64_tr_b16 a[148:149], v5 offset:16384
    v_mfma_f32_16x16x32_bf16 v[164:167], a[136:139], a[164:167], v[164:167]
    ds_read_b64_tr_b16 a[150:151], v5 offset:16896
    v_mfma_f32_16x16x32_bf16 v[168:171], a[136:139], a[168:171], v[168:171]
    ds_read_b128 a[180:183], v50 offset:31744
    v_mfma_f32_16x16x32_bf16 v[172:175], a[136:139], a[172:175], v[172:175]
    s_waitcnt lgkmcnt(6)
    buffer_load_dwordx4 v34, s[8:11], s60 offen offset:2048 lds
    v_mfma_f32_16x16x32_bf16 v[188:191], a[140:143], a[172:175], v[188:191]
    ds_read_b64_tr_b16 a[152:153], v6 offset:16384
    v_mfma_f32_16x16x32_bf16 v[184:187], a[140:143], a[168:171], v[184:187]
    ds_read_b64_tr_b16 a[154:155], v6 offset:16896
    v_mfma_f32_16x16x32_bf16 v[180:183], a[140:143], a[164:167], v[180:183]
    ds_read_b128 a[184:187], v51 offset:48128
    v_mfma_f32_16x16x32_bf16 v[176:179], a[140:143], a[160:163], v[176:179]
    s_waitcnt lgkmcnt(7)
    buffer_load_dwordx4 v35, s[8:11], s60 offen offset:3072 lds
    v_mfma_f32_16x16x32_bf16 v[192:195], a[144:147], a[160:163], v[192:195]
    ds_read_b64_tr_b16 a[156:157], v7 offset:16384
    v_mfma_f32_16x16x32_bf16 v[196:199], a[144:147], a[164:167], v[196:199]
    ds_read_b64_tr_b16 a[158:159], v7 offset:16896
    v_mfma_f32_16x16x32_bf16 v[200:203], a[144:147], a[168:171], v[200:203]
    s_add_u32 m0, s59, 0
    s_mov_b32 s60, 0
    ds_read_b128 a[188:191], v51 offset:64512
    v_mfma_f32_16x16x32_bf16 v[204:207], a[144:147], a[172:175], v[204:207]
    s_waitcnt lgkmcnt(7)
    buffer_load_dwordx4 v36, s[12:15], s60 offen offset:0 lds
    v_mfma_f32_16x16x32_bf16 v[220:223], a[148:151], a[172:175], v[220:223]
    s_waitcnt vmcnt(13)
    ds_read_b64_tr_b16 a[128:129], v4 offset:32768
    v_mfma_f32_16x16x32_bf16 v[216:219], a[148:151], a[168:171], v[216:219]
    ds_read_b64_tr_b16 a[130:131], v4 offset:33280
    v_mfma_f32_16x16x32_bf16 v[212:215], a[148:151], a[164:167], v[212:215]
    v_mfma_f32_16x16x32_bf16 v[208:211], a[148:151], a[160:163], v[208:211]
    s_waitcnt lgkmcnt(6)
    buffer_load_dwordx4 v37, s[12:15], s60 offen offset:1024 lds
    v_mfma_f32_16x16x32_bf16 v[224:227], a[152:155], a[160:163], v[224:227]
    ds_read_b64_tr_b16 a[132:133], v5 offset:32768
    v_mfma_f32_16x16x32_bf16 v[228:231], a[152:155], a[164:167], v[228:231]
    ds_read_b64_tr_b16 a[134:135], v5 offset:33280
    v_mfma_f32_16x16x32_bf16 v[232:235], a[152:155], a[168:171], v[232:235]
    v_mfma_f32_16x16x32_bf16 v[236:239], a[152:155], a[172:175], v[236:239]
    s_waitcnt lgkmcnt(5)
    buffer_load_dwordx4 v36, s[12:15], s60 offen offset:2048 lds
    v_mfma_f32_16x16x32_bf16 v[252:255], a[156:159], a[172:175], v[252:255]
    ds_read_b64_tr_b16 a[136:137], v6 offset:32768
    v_mfma_f32_16x16x32_bf16 v[248:251], a[156:159], a[168:171], v[248:251]
    ds_read_b64_tr_b16 a[138:139], v6 offset:33280
    v_mfma_f32_16x16x32_bf16 v[244:247], a[156:159], a[164:167], v[244:247]
    v_mfma_f32_16x16x32_bf16 v[240:243], a[156:159], a[160:163], v[240:243]
    s_waitcnt lgkmcnt(4)
    buffer_load_dwordx4 v37, s[12:15], s60 offen offset:3072 lds
    v_mfma_f32_16x16x32_bf16 v[128:131], a[128:131], a[176:179], v[128:131]
    ds_read_b64_tr_b16 a[140:141], v7 offset:32768
    v_mfma_f32_16x16x32_bf16 v[132:135], a[128:131], a[180:183], v[132:135]
    ds_read_b64_tr_b16 a[142:143], v7 offset:33280
    v_mfma_f32_16x16x32_bf16 v[136:139], a[128:131], a[184:187], v[136:139]
    v_mfma_f32_16x16x32_bf16 v[140:143], a[128:131], a[188:191], v[140:143]
    s_waitcnt lgkmcnt(4)
    v_mfma_f32_16x16x32_bf16 v[156:159], a[132:135], a[188:191], v[156:159]
    s_waitcnt vmcnt(12)
    ds_read_b64_tr_b16 a[144:145], v8 offset:0
    v_mfma_f32_16x16x32_bf16 v[152:155], a[132:135], a[184:187], v[152:155]
    ds_read_b64_tr_b16 a[146:147], v8 offset:512
    v_mfma_f32_16x16x32_bf16 v[148:151], a[132:135], a[180:183], v[148:151]
    v_mfma_f32_16x16x32_bf16 v[144:147], a[132:135], a[176:179], v[144:147]
    s_waitcnt lgkmcnt(4)
    v_mfma_f32_16x16x32_bf16 v[160:163], a[136:139], a[176:179], v[160:163]
    ds_read_b64_tr_b16 a[148:149], v9 offset:0
    v_mfma_f32_16x16x32_bf16 v[164:167], a[136:139], a[180:183], v[164:167]
    ds_read_b64_tr_b16 a[150:151], v9 offset:512
    v_mfma_f32_16x16x32_bf16 v[168:171], a[136:139], a[184:187], v[168:171]
    v_mfma_f32_16x16x32_bf16 v[172:175], a[136:139], a[188:191], v[172:175]
    s_waitcnt lgkmcnt(4)
    v_mfma_f32_16x16x32_bf16 v[188:191], a[140:143], a[188:191], v[188:191]
    ds_read_b64_tr_b16 a[152:153], v10 offset:0
    v_mfma_f32_16x16x32_bf16 v[184:187], a[140:143], a[184:187], v[184:187]
    ds_read_b64_tr_b16 a[154:155], v10 offset:512
    v_mfma_f32_16x16x32_bf16 v[180:183], a[140:143], a[180:183], v[180:183]
    v_mfma_f32_16x16x32_bf16 v[176:179], a[140:143], a[176:179], v[176:179]
    s_waitcnt lgkmcnt(4)
    v_mfma_f32_16x16x32_bf16 v[192:195], a[144:147], a[176:179], v[192:195]
    ds_read_b64_tr_b16 a[156:157], v11 offset:0
    v_mfma_f32_16x16x32_bf16 v[196:199], a[144:147], a[180:183], v[196:199]
    ds_read_b64_tr_b16 a[158:159], v11 offset:512
    v_mfma_f32_16x16x32_bf16 v[200:203], a[144:147], a[184:187], v[200:203]
    v_mfma_f32_16x16x32_bf16 v[204:207], a[144:147], a[188:191], v[204:207]
    s_waitcnt lgkmcnt(4)
    v_mfma_f32_16x16x32_bf16 v[220:223], a[148:151], a[188:191], v[220:223]
    v_mfma_f32_16x16x32_bf16 v[216:219], a[148:151], a[184:187], v[216:219]
    v_mfma_f32_16x16x32_bf16 v[212:215], a[148:151], a[180:183], v[212:215]
    v_mfma_f32_16x16x32_bf16 v[208:211], a[148:151], a[176:179], v[208:211]
    s_waitcnt lgkmcnt(2)
    v_mfma_f32_16x16x32_bf16 v[224:227], a[152:155], a[176:179], v[224:227]
    v_mfma_f32_16x16x32_bf16 v[228:231], a[152:155], a[180:183], v[228:231]
    v_mfma_f32_16x16x32_bf16 v[232:235], a[152:155], a[184:187], v[232:235]
    v_mfma_f32_16x16x32_bf16 v[236:239], a[152:155], a[188:191], v[236:239]
    s_waitcnt lgkmcnt(0)
    v_mfma_f32_16x16x32_bf16 v[252:255], a[156:159], a[188:191], v[252:255]
    v_mfma_f32_16x16x32_bf16 v[248:251], a[156:159], a[184:187], v[248:251]
    v_mfma_f32_16x16x32_bf16 v[244:247], a[156:159], a[180:183], v[244:247]
    v_mfma_f32_16x16x32_bf16 v[240:243], a[156:159], a[176:179], v[240:243]
    v_mov_b32 v40, 0xc0135761
    v_mov_b32 v41, 0xbdd2d3e8
    v_mov_b32 v44, 1.0
    s_nop 4
    v_pk_mul_f32 v[64:65], v[128:129], v[128:129]
    v_pk_mul_f32 v[66:67], v[130:131], v[130:131]
    v_pk_mul_f32 v[68:69], v[144:145], v[144:145]
    v_pk_mul_f32 v[70:71], v[146:147], v[146:147]
    v_pk_mul_f32 v[72:73], v[132:133], v[132:133]
    v_pk_mul_f32 v[74:75], v[134:135], v[134:135]
    v_pk_mul_f32 v[76:77], v[148:149], v[148:149]
    v_pk_fma_f32 v[64:65], v[64:65], v[40:41], v[40:41] op_sel:[0,1,0] op_sel_hi:[1,1,0]
    v_pk_fma_f32 v[66:67], v[66:67], v[40:41], v[40:41] op_sel:[0,1,0] op_sel_hi:[1,1,0]
    v_pk_fma_f32 v[68:69], v[68:69], v[40:41], v[40:41] op_sel:[0,1,0] op_sel_hi:[1,1,0]
    v_pk_fma_f32 v[70:71], v[70:71], v[40:41], v[40:41] op_sel:[0,1,0] op_sel_hi:[1,1,0]
    v_pk_mul_f32 v[78:79], v[150:151], v[150:151]
    v_pk_fma_f32 v[72:73], v[72:73], v[40:41], v[40:41] op_sel:[0,1,0] op_sel_hi:[1,1,0]
    v_pk_fma_f32 v[74:75], v[74:75], v[40:41], v[40:41] op_sel:[0,1,0] op_sel_hi:[1,1,0]
    v_pk_mul_f32 v[64:65], v[64:65], v[128:129]
    v_pk_mul_f32 v[66:67], v[66:67], v[130:131]
    v_pk_mul_f32 v[68:69], v[68:69], v[144:145]
    v_pk_mul_f32 v[70:71], v[70:71], v[146:147]
    v_pk_mul_f32 v[128:129], v[128:129], v[192:193]
    v_pk_mul_f32 v[130:131], v[130:131], v[194:195]
    v_pk_mul_f32 v[144:145], v[144:145], v[208:209]
    v_exp_f32 v64, v64
    v_pk_mul_f32 v[146:147], v[146:147], v[210:211]
    v_exp_f32 v65, v65
    v_mov_b64 v[192:193], 0
    v_exp_f32 v66, v66
    v_mov_b64 v[194:195], 0
    v_exp_f32 v67, v67
    v_mov_b64 v[208:209], 0
    v_exp_f32 v68, v68
    v_pk_add_f32 v[64:65], v[64:65], v[44:45] op_sel_hi:[1,0]
    v_exp_f32 v69, v69
    v_mov_b64 v[210:211], 0
    v_exp_f32 v70, v70
    v_pk_add_f32 v[66:67], v[66:67], v[44:45] op_sel_hi:[1,0]
    v_exp_f32 v71, v71
    v_pk_fma_f32 v[76:77], v[76:77], v[40:41], v[40:41] op_sel:[0,1,0] op_sel_hi:[1,1,0]
    v_rcp_f32 v64, v64
    v_pk_add_f32 v[68:69], v[68:69], v[44:45] op_sel_hi:[1,0]
    v_rcp_f32 v65, v65
    v_pk_fma_f32 v[78:79], v[78:79], v[40:41], v[40:41] op_sel:[0,1,0] op_sel_hi:[1,1,0]
    v_rcp_f32 v66, v66
    v_pk_add_f32 v[70:71], v[70:71], v[44:45] op_sel_hi:[1,0]
    v_rcp_f32 v67, v67
    v_pk_mul_f32 v[72:73], v[72:73], v[132:133]
    v_rcp_f32 v68, v68
    v_pk_mul_f32 v[128:129], v[128:129], v[64:65]
    v_rcp_f32 v69, v69
    v_pk_mul_f32 v[74:75], v[74:75], v[134:135]
    v_rcp_f32 v70, v70
    v_pk_mul_f32 v[130:131], v[130:131], v[66:67]
    v_rcp_f32 v71, v71
    v_pk_mul_f32 v[76:77], v[76:77], v[148:149]
    v_exp_f32 v72, v72
    v_pk_mul_f32 v[144:145], v[144:145], v[68:69]
    v_exp_f32 v73, v73
    v_cvt_pk_bf16_f32 v96, v128, v129
    v_exp_f32 v74, v74
    v_pk_mul_f32 v[146:147], v[146:147], v[70:71]
    v_exp_f32 v75, v75
    v_cvt_pk_bf16_f32 v97, v130, v131
    v_exp_f32 v76, v76
    v_cvt_pk_bf16_f32 v98, v144, v145
    v_exp_f32 v77, v77
    v_pk_mul_f32 v[78:79], v[78:79], v[150:151]
    v_cvt_pk_bf16_f32 v99, v146, v147
    v_pk_mul_f32 v[132:133], v[132:133], v[196:197]
    v_pk_mul_f32 v[134:135], v[134:135], v[198:199]
    v_pk_mul_f32 v[148:149], v[148:149], v[212:213]
    v_pk_mul_f32 v[150:151], v[150:151], v[214:215]
    v_pk_add_f32 v[72:73], v[72:73], v[44:45] op_sel_hi:[1,0]
    v_exp_f32 v78, v78
    v_pk_add_f32 v[74:75], v[74:75], v[44:45] op_sel_hi:[1,0]
    v_exp_f32 v79, v79
    v_pk_add_f32 v[76:77], v[76:77], v[44:45] op_sel_hi:[1,0]
    v_mov_b64 v[196:197], 0
    v_mov_b64 v[198:199], 0
    v_rcp_f32 v72, v72
    v_mov_b64 v[212:213], 0
    v_rcp_f32 v73, v73
    v_pk_add_f32 v[78:79], v[78:79], v[44:45] op_sel_hi:[1,0]
    v_rcp_f32 v74, v74
    v_mov_b64 v[214:215], 0
    v_rcp_f32 v75, v75
    v_pk_mul_f32 v[80:81], v[136:137], v[136:137]
    v_rcp_f32 v76, v76
    v_pk_mul_f32 v[132:133], v[132:133], v[72:73]
    v_rcp_f32 v77, v77
    v_pk_mul_f32 v[82:83], v[138:139], v[138:139]
    v_rcp_f32 v78, v78
    v_pk_mul_f32 v[134:135], v[134:135], v[74:75]
    v_rcp_f32 v79, v79
    v_pk_mul_f32 v[84:85], v[152:153], v[152:153]
    v_cvt_pk_bf16_f32 v100, v132, v133
    v_pk_mul_f32 v[148:149], v[148:149], v[76:77]
    v_pk_mul_f32 v[86:87], v[154:155], v[154:155]
    v_pk_fma_f32 v[80:81], v[80:81], v[40:41], v[40:41] op_sel:[0,1,0] op_sel_hi:[1,1,0]
    v_cvt_pk_bf16_f32 v101, v134, v135
    v_pk_mul_f32 v[150:151], v[150:151], v[78:79]
    v_pk_fma_f32 v[82:83], v[82:83], v[40:41], v[40:41] op_sel:[0,1,0] op_sel_hi:[1,1,0]
    v_pk_fma_f32 v[84:85], v[84:85], v[40:41], v[40:41] op_sel:[0,1,0] op_sel_hi:[1,1,0]
    v_cvt_pk_bf16_f32 v102, v148, v149
    v_pk_fma_f32 v[86:87], v[86:87], v[40:41], v[40:41] op_sel:[0,1,0] op_sel_hi:[1,1,0]
    v_pk_mul_f32 v[80:81], v[80:81], v[136:137]
    v_pk_mul_f32 v[136:137], v[136:137], v[200:201]
    v_cvt_pk_bf16_f32 v103, v150, v151
    v_pk_mul_f32 v[82:83], v[82:83], v[138:139]
    v_pk_mul_f32 v[84:85], v[84:85], v[152:153]
    v_pk_mul_f32 v[138:139], v[138:139], v[202:203]
    v_pk_mul_f32 v[86:87], v[86:87], v[154:155]
    v_exp_f32 v80, v80
    v_pk_mul_f32 v[152:153], v[152:153], v[216:217]
    v_exp_f32 v81, v81
    v_pk_mul_f32 v[154:155], v[154:155], v[218:219]
    v_exp_f32 v82, v82
    v_mov_b64 v[200:201], 0
    v_exp_f32 v83, v83
    v_mov_b64 v[202:203], 0
    v_exp_f32 v84, v84
    v_pk_add_f32 v[80:81], v[80:81], v[44:45] op_sel_hi:[1,0]
    v_exp_f32 v85, v85
    v_mov_b64 v[216:217], 0
    v_exp_f32 v86, v86
    v_pk_add_f32 v[82:83], v[82:83], v[44:45] op_sel_hi:[1,0]
    v_exp_f32 v87, v87
    v_mov_b64 v[218:219], 0
    v_rcp_f32 v80, v80
    v_pk_add_f32 v[84:85], v[84:85], v[44:45] op_sel_hi:[1,0]
    v_rcp_f32 v81, v81
    v_pk_mul_f32 v[88:89], v[140:141], v[140:141]
    v_rcp_f32 v82, v82
    v_pk_add_f32 v[86:87], v[86:87], v[44:45] op_sel_hi:[1,0]
    v_rcp_f32 v83, v83
    v_pk_mul_f32 v[90:91], v[142:143], v[142:143]
    v_rcp_f32 v84, v84
    v_pk_mul_f32 v[136:137], v[136:137], v[80:81]
    v_rcp_f32 v85, v85
    v_pk_mul_f32 v[92:93], v[156:157], v[156:157]
    v_rcp_f32 v86, v86
    v_pk_mul_f32 v[138:139], v[138:139], v[82:83]
    v_rcp_f32 v87, v87
    v_pk_mul_f32 v[94:95], v[158:159], v[158:159]
    v_cvt_pk_bf16_f32 v104, v136, v137
    v_pk_mul_f32 v[152:153], v[152:153], v[84:85]
    v_pk_fma_f32 v[88:89], v[88:89], v[40:41], v[40:41] op_sel:[0,1,0] op_sel_hi:[1,1,0]
    v_pk_fma_f32 v[90:91], v[90:91], v[40:41], v[40:41] op_sel:[0,1,0] op_sel_hi:[1,1,0]
    v_cvt_pk_bf16_f32 v105, v138, v139
    v_pk_mul_f32 v[154:155], v[154:155], v[86:87]
    v_pk_fma_f32 v[92:93], v[92:93], v[40:41], v[40:41] op_sel:[0,1,0] op_sel_hi:[1,1,0]
    v_pk_fma_f32 v[94:95], v[94:95], v[40:41], v[40:41] op_sel:[0,1,0] op_sel_hi:[1,1,0]
    v_cvt_pk_bf16_f32 v106, v152, v153
    v_pk_mul_f32 v[88:89], v[88:89], v[140:141]
    v_pk_mul_f32 v[90:91], v[90:91], v[142:143]
    v_pk_mul_f32 v[140:141], v[140:141], v[204:205]
    v_cvt_pk_bf16_f32 v107, v154, v155
    v_pk_mul_f32 v[92:93], v[92:93], v[156:157]
    v_pk_mul_f32 v[94:95], v[94:95], v[158:159]
    v_pk_mul_f32 v[142:143], v[142:143], v[206:207]
    v_exp_f32 v88, v88
    v_pk_mul_f32 v[156:157], v[156:157], v[220:221]
    v_exp_f32 v89, v89
    v_pk_mul_f32 v[158:159], v[158:159], v[222:223]
    v_exp_f32 v90, v90
    v_mov_b64 v[204:205], 0
    v_exp_f32 v91, v91
    v_mov_b64 v[206:207], 0
    v_exp_f32 v92, v92
    v_pk_add_f32 v[88:89], v[88:89], v[44:45] op_sel_hi:[1,0]
    v_exp_f32 v93, v93
    v_mov_b64 v[220:221], 0
    v_exp_f32 v94, v94
    v_pk_add_f32 v[90:91], v[90:91], v[44:45] op_sel_hi:[1,0]
    v_exp_f32 v95, v95
    v_mov_b64 v[222:223], 0
    v_rcp_f32 v88, v88
    v_pk_add_f32 v[92:93], v[92:93], v[44:45] op_sel_hi:[1,0]
    v_rcp_f32 v89, v89
    v_pk_mul_f32 v[64:65], v[160:161], v[160:161]
    v_rcp_f32 v90, v90
    v_pk_add_f32 v[94:95], v[94:95], v[44:45] op_sel_hi:[1,0]
    v_rcp_f32 v91, v91
    v_pk_mul_f32 v[66:67], v[162:163], v[162:163]
    v_rcp_f32 v92, v92
    v_pk_mul_f32 v[140:141], v[140:141], v[88:89]
    v_rcp_f32 v93, v93
    v_pk_mul_f32 v[68:69], v[176:177], v[176:177]
    v_rcp_f32 v94, v94
    v_pk_mul_f32 v[142:143], v[142:143], v[90:91]
    v_rcp_f32 v95, v95
    v_pk_mul_f32 v[70:71], v[178:179], v[178:179]
    v_cvt_pk_bf16_f32 v108, v140, v141
    v_pk_mul_f32 v[156:157], v[156:157], v[92:93]
    v_pk_fma_f32 v[64:65], v[64:65], v[40:41], v[40:41] op_sel:[0,1,0] op_sel_hi:[1,1,0]
    v_pk_fma_f32 v[66:67], v[66:67], v[40:41], v[40:41] op_sel:[0,1,0] op_sel_hi:[1,1,0]
    v_cvt_pk_bf16_f32 v109, v142, v143
    v_pk_mul_f32 v[158:159], v[158:159], v[94:95]
    v_pk_fma_f32 v[68:69], v[68:69], v[40:41], v[40:41] op_sel:[0,1,0] op_sel_hi:[1,1,0]
    v_pk_fma_f32 v[70:71], v[70:71], v[40:41], v[40:41] op_sel:[0,1,0] op_sel_hi:[1,1,0]
    v_cvt_pk_bf16_f32 v110, v156, v157
    v_pk_mul_f32 v[64:65], v[64:65], v[160:161]
    v_pk_mul_f32 v[66:67], v[66:67], v[162:163]
    v_pk_mul_f32 v[160:161], v[160:161], v[224:225]
    v_cvt_pk_bf16_f32 v111, v158, v159
    v_pk_mul_f32 v[68:69], v[68:69], v[176:177]
    v_pk_mul_f32 v[70:71], v[70:71], v[178:179]
    v_pk_mul_f32 v[162:163], v[162:163], v[226:227]
    v_exp_f32 v64, v64
    v_pk_mul_f32 v[176:177], v[176:177], v[240:241]
    v_exp_f32 v65, v65
    v_pk_mul_f32 v[178:179], v[178:179], v[242:243]
    v_exp_f32 v66, v66
    v_mov_b64 v[224:225], 0
    v_exp_f32 v67, v67
    v_mov_b64 v[226:227], 0
    v_exp_f32 v68, v68
    v_pk_add_f32 v[64:65], v[64:65], v[44:45] op_sel_hi:[1,0]
    v_exp_f32 v69, v69
    v_mov_b64 v[240:241], 0
    v_exp_f32 v70, v70
    v_pk_add_f32 v[66:67], v[66:67], v[44:45] op_sel_hi:[1,0]
    v_exp_f32 v71, v71
    v_mov_b64 v[242:243], 0
    v_rcp_f32 v64, v64
    v_pk_add_f32 v[68:69], v[68:69], v[44:45] op_sel_hi:[1,0]
    v_rcp_f32 v65, v65
    v_pk_mul_f32 v[72:73], v[164:165], v[164:165]
    v_rcp_f32 v66, v66
    v_pk_add_f32 v[70:71], v[70:71], v[44:45] op_sel_hi:[1,0]
    v_rcp_f32 v67, v67
    v_pk_mul_f32 v[74:75], v[166:167], v[166:167]
    v_rcp_f32 v68, v68
    v_pk_mul_f32 v[160:161], v[160:161], v[64:65]
    v_rcp_f32 v69, v69
    v_pk_mul_f32 v[76:77], v[180:181], v[180:181]
    v_rcp_f32 v70, v70
    v_pk_mul_f32 v[162:163], v[162:163], v[66:67]
    v_rcp_f32 v71, v71
    v_pk_mul_f32 v[78:79], v[182:183], v[182:183]
    v_cvt_pk_bf16_f32 v112, v160, v161
    v_pk_mul_f32 v[176:177], v[176:177], v[68:69]
    v_pk_fma_f32 v[72:73], v[72:73], v[40:41], v[40:41] op_sel:[0,1,0] op_sel_hi:[1,1,0]
    v_pk_fma_f32 v[74:75], v[74:75], v[40:41], v[40:41] op_sel:[0,1,0] op_sel_hi:[1,1,0]
    v_cvt_pk_bf16_f32 v113, v162, v163
    v_pk_mul_f32 v[178:179], v[178:179], v[70:71]
    v_pk_fma_f32 v[76:77], v[76:77], v[40:41], v[40:41] op_sel:[0,1,0] op_sel_hi:[1,1,0]
    v_pk_fma_f32 v[78:79], v[78:79], v[40:41], v[40:41] op_sel:[0,1,0] op_sel_hi:[1,1,0]
    v_cvt_pk_bf16_f32 v114, v176, v177
    v_pk_mul_f32 v[72:73], v[72:73], v[164:165]
    v_pk_mul_f32 v[74:75], v[74:75], v[166:167]
    v_pk_mul_f32 v[164:165], v[164:165], v[228:229]
    v_cvt_pk_bf16_f32 v115, v178, v179
    v_pk_mul_f32 v[76:77], v[76:77], v[180:181]
    v_pk_mul_f32 v[78:79], v[78:79], v[182:183]
    v_pk_mul_f32 v[166:167], v[166:167], v[230:231]
    v_exp_f32 v72, v72
    v_pk_mul_f32 v[180:181], v[180:181], v[244:245]
    v_exp_f32 v73, v73
    v_pk_mul_f32 v[182:183], v[182:183], v[246:247]
    v_exp_f32 v74, v74
    v_mov_b64 v[228:229], 0
    v_exp_f32 v75, v75
    v_mov_b64 v[230:231], 0
    v_exp_f32 v76, v76
    v_pk_add_f32 v[72:73], v[72:73], v[44:45] op_sel_hi:[1,0]
    v_exp_f32 v77, v77
    v_mov_b64 v[244:245], 0
    v_exp_f32 v78, v78
    v_pk_add_f32 v[74:75], v[74:75], v[44:45] op_sel_hi:[1,0]
    v_exp_f32 v79, v79
    v_mov_b64 v[246:247], 0
    v_rcp_f32 v72, v72
    v_pk_add_f32 v[76:77], v[76:77], v[44:45] op_sel_hi:[1,0]
    v_rcp_f32 v73, v73
    v_pk_mul_f32 v[80:81], v[168:169], v[168:169]
    v_rcp_f32 v74, v74
    v_pk_add_f32 v[78:79], v[78:79], v[44:45] op_sel_hi:[1,0]
    v_rcp_f32 v75, v75
    v_pk_mul_f32 v[82:83], v[170:171], v[170:171]
    v_rcp_f32 v76, v76
    v_pk_mul_f32 v[164:165], v[164:165], v[72:73]
    v_rcp_f32 v77, v77
    v_pk_mul_f32 v[84:85], v[184:185], v[184:185]
    v_rcp_f32 v78, v78
    v_pk_mul_f32 v[166:167], v[166:167], v[74:75]
    v_rcp_f32 v79, v79
    v_pk_mul_f32 v[86:87], v[186:187], v[186:187]
    v_cvt_pk_bf16_f32 v116, v164, v165
    v_pk_mul_f32 v[180:181], v[180:181], v[76:77]
    v_pk_fma_f32 v[80:81], v[80:81], v[40:41], v[40:41] op_sel:[0,1,0] op_sel_hi:[1,1,0]
    v_pk_fma_f32 v[82:83], v[82:83], v[40:41], v[40:41] op_sel:[0,1,0] op_sel_hi:[1,1,0]
    v_cvt_pk_bf16_f32 v117, v166, v167
    v_pk_mul_f32 v[182:183], v[182:183], v[78:79]
    v_pk_fma_f32 v[84:85], v[84:85], v[40:41], v[40:41] op_sel:[0,1,0] op_sel_hi:[1,1,0]
    v_pk_fma_f32 v[86:87], v[86:87], v[40:41], v[40:41] op_sel:[0,1,0] op_sel_hi:[1,1,0]
    v_cvt_pk_bf16_f32 v118, v180, v181
    v_pk_mul_f32 v[80:81], v[80:81], v[168:169]
    v_pk_mul_f32 v[82:83], v[82:83], v[170:171]
    v_pk_mul_f32 v[168:169], v[168:169], v[232:233]
    v_cvt_pk_bf16_f32 v119, v182, v183
    v_pk_mul_f32 v[84:85], v[84:85], v[184:185]
    v_pk_mul_f32 v[86:87], v[86:87], v[186:187]
    v_pk_mul_f32 v[170:171], v[170:171], v[234:235]
    v_exp_f32 v80, v80
    v_pk_mul_f32 v[184:185], v[184:185], v[248:249]
    v_exp_f32 v81, v81
    v_pk_mul_f32 v[186:187], v[186:187], v[250:251]
    v_exp_f32 v82, v82
    v_mov_b64 v[232:233], 0
    v_exp_f32 v83, v83
    v_mov_b64 v[234:235], 0
    v_exp_f32 v84, v84
    v_pk_add_f32 v[80:81], v[80:81], v[44:45] op_sel_hi:[1,0]
    v_exp_f32 v85, v85
    v_mov_b64 v[248:249], 0
    v_exp_f32 v86, v86
    v_pk_add_f32 v[82:83], v[82:83], v[44:45] op_sel_hi:[1,0]
    v_exp_f32 v87, v87
    v_mov_b64 v[250:251], 0
    v_rcp_f32 v80, v80
    v_pk_add_f32 v[84:85], v[84:85], v[44:45] op_sel_hi:[1,0]
    v_rcp_f32 v81, v81
    v_pk_mul_f32 v[88:89], v[172:173], v[172:173]
    v_rcp_f32 v82, v82
    v_pk_add_f32 v[86:87], v[86:87], v[44:45] op_sel_hi:[1,0]
    v_rcp_f32 v83, v83
    v_pk_mul_f32 v[90:91], v[174:175], v[174:175]
    v_rcp_f32 v84, v84
    v_pk_mul_f32 v[168:169], v[168:169], v[80:81]
    v_rcp_f32 v85, v85
    v_pk_mul_f32 v[92:93], v[188:189], v[188:189]
    v_rcp_f32 v86, v86
    v_pk_mul_f32 v[170:171], v[170:171], v[82:83]
    v_rcp_f32 v87, v87
    v_pk_mul_f32 v[94:95], v[190:191], v[190:191]
    v_cvt_pk_bf16_f32 v120, v168, v169
    v_pk_mul_f32 v[184:185], v[184:185], v[84:85]
    v_pk_fma_f32 v[88:89], v[88:89], v[40:41], v[40:41] op_sel:[0,1,0] op_sel_hi:[1,1,0]
    v_pk_fma_f32 v[90:91], v[90:91], v[40:41], v[40:41] op_sel:[0,1,0] op_sel_hi:[1,1,0]
    v_cvt_pk_bf16_f32 v121, v170, v171
    v_pk_mul_f32 v[186:187], v[186:187], v[86:87]
    v_pk_fma_f32 v[92:93], v[92:93], v[40:41], v[40:41] op_sel:[0,1,0] op_sel_hi:[1,1,0]
    v_pk_fma_f32 v[94:95], v[94:95], v[40:41], v[40:41] op_sel:[0,1,0] op_sel_hi:[1,1,0]
    v_cvt_pk_bf16_f32 v122, v184, v185
    v_pk_mul_f32 v[88:89], v[88:89], v[172:173]
    v_pk_mul_f32 v[90:91], v[90:91], v[174:175]
    v_pk_mul_f32 v[172:173], v[172:173], v[236:237]
    v_cvt_pk_bf16_f32 v123, v186, v187
    v_pk_mul_f32 v[92:93], v[92:93], v[188:189]
    v_pk_mul_f32 v[94:95], v[94:95], v[190:191]
    v_pk_mul_f32 v[174:175], v[174:175], v[238:239]
    v_exp_f32 v88, v88
    v_pk_mul_f32 v[188:189], v[188:189], v[252:253]
    v_exp_f32 v89, v89
    v_pk_mul_f32 v[190:191], v[190:191], v[254:255]
    v_exp_f32 v90, v90
    v_mov_b64 v[236:237], 0
    v_exp_f32 v91, v91
    v_mov_b64 v[238:239], 0
    v_exp_f32 v92, v92
    v_pk_add_f32 v[88:89], v[88:89], v[44:45] op_sel_hi:[1,0]
    v_exp_f32 v93, v93
    v_mov_b64 v[252:253], 0
    v_exp_f32 v94, v94
    v_pk_add_f32 v[90:91], v[90:91], v[44:45] op_sel_hi:[1,0]
    v_exp_f32 v95, v95
    v_mov_b64 v[254:255], 0
    v_rcp_f32 v88, v88
    v_pk_add_f32 v[92:93], v[92:93], v[44:45] op_sel_hi:[1,0]
    v_rcp_f32 v89, v89
    v_rcp_f32 v90, v90
    v_rcp_f32 v91, v91
    v_pk_add_f32 v[94:95], v[94:95], v[44:45] op_sel_hi:[1,0]
    v_rcp_f32 v92, v92
    v_rcp_f32 v93, v93
    v_pk_mul_f32 v[172:173], v[172:173], v[88:89]
    v_pk_mul_f32 v[174:175], v[174:175], v[90:91]
    v_rcp_f32 v94, v94
    v_rcp_f32 v95, v95
    v_pk_mul_f32 v[188:189], v[188:189], v[92:93]
    v_cvt_pk_bf16_f32 v124, v172, v173
    v_cvt_pk_bf16_f32 v125, v174, v175
    v_pk_mul_f32 v[190:191], v[190:191], v[94:95]
    v_cvt_pk_bf16_f32 v126, v188, v189
    v_cvt_pk_bf16_f32 v127, v190, v191
    v_add_u32 v12, s67, v16
    v_add_u32 v13, s67, v17
    v_add_u32 v14, s67, v18
    v_add_u32 v15, s67, v19
    s_cmp_eq_u32 s64, 1
    s_cbranch_scc1 L_maxpass
L_att_start:
    v_mov_b64 v[128:129], 0
    v_lshlrev_b32 v3, 7, v1
    v_and_b32 v38, 7, v1
    v_mov_b32 v0, 0
    s_waitcnt vmcnt(0) lgkmcnt(0)
    s_barrier
    ds_read_b128 a[128:131], v20 offset:0
    ds_read_b128 a[132:135], v21 offset:0
    ds_read_b128 a[136:139], v22 offset:0
    ds_read_b128 a[140:143], v23 offset:0
    ds_read_b128 a[144:147], v20 offset:4096
    ds_read_b128 a[148:151], v21 offset:4096
    ds_read_b128 a[152:155], v22 offset:4096
    ds_read_b128 a[156:159], v23 offset:4096
    s_waitcnt lgkmcnt(7)
    v_mfma_f32_16x16x32_bf16 v[64:67], a[128:131], a[0:3], 0
    buffer_store_dwordx4 v[96:99], v50, s[44:47], s65 offen offset:0 sc1
    v_mov_b32 v130, 0
    v_mov_b32 v131, 0
    v_mfma_f32_16x16x32_bf16 v[72:75], a[128:131], a[4:7], 0
    v_mov_b32 v132, 0
    v_mov_b32 v133, 0
    v_mfma_f32_16x16x32_bf16 v[80:83], a[128:131], a[8:11], 0
    s_mov_b64 exec, 3
    buffer_store_dword v128, v3, s[4:7], s79 offen offset:0 sc1
    s_mov_b64 exec, -1
    v_mov_b32 v134, 0
    v_mov_b32 v135, 0
    v_mfma_f32_16x16x32_bf16 v[88:91], a[128:131], a[12:15], 0
    v_mov_b32 v136, 0
    v_mov_b32 v137, 0
    s_waitcnt lgkmcnt(6)
    v_mfma_f32_16x16x32_bf16 v[64:67], a[132:135], a[32:35], v[64:67]
    buffer_store_dwordx4 v[100:103], v50, s[44:47], s65 offen offset:1024 sc1
    v_mov_b32 v138, 0
    v_mov_b32 v139, 0
    v_mfma_f32_16x16x32_bf16 v[72:75], a[132:135], a[36:39], v[72:75]
    v_mov_b32 v140, 0
    v_mov_b32 v141, 0
    v_mfma_f32_16x16x32_bf16 v[80:83], a[132:135], a[40:43], v[80:83]
    v_mov_b32 v142, 0
    v_mov_b32 v143, 0
    v_mfma_f32_16x16x32_bf16 v[88:91], a[132:135], a[44:47], v[88:91]
    v_mov_b32 v144, 0
    v_mov_b32 v145, 0
    s_waitcnt lgkmcnt(5)
    v_mfma_f32_16x16x32_bf16 v[64:67], a[136:139], a[64:67], v[64:67]
    buffer_store_dwordx4 v[104:107], v51, s[44:47], s65 offen offset:2048 sc1
    v_mov_b32 v146, 0
    v_mov_b32 v147, 0
    v_mfma_f32_16x16x32_bf16 v[72:75], a[136:139], a[68:71], v[72:75]
    v_mov_b32 v148, 0
    v_mov_b32 v149, 0
    v_mfma_f32_16x16x32_bf16 v[80:83], a[136:139], a[72:75], v[80:83]
    v_mov_b32 v150, 0
    v_mov_b32 v151, 0
    v_mfma_f32_16x16x32_bf16 v[88:91], a[136:139], a[76:79], v[88:91]
    v_mov_b32 v152, 0
    v_mov_b32 v153, 0
    s_waitcnt lgkmcnt(4)
    v_mfma_f32_16x16x32_bf16 v[64:67], a[140:143], a[96:99], v[64:67]
    buffer_store_dwordx4 v[108:111], v51, s[44:47], s65 offen offset:3072 sc1
    v_mov_b32 v154, 0
    v_mov_b32 v155, 0
    v_mfma_f32_16x16x32_bf16 v[72:75], a[140:143], a[100:103], v[72:75]
    v_mov_b32 v156, 0
    v_mov_b32 v157, 0
    v_mfma_f32_16x16x32_bf16 v[80:83], a[140:143], a[104:107], v[80:83]
    v_mov_b32 v158, 0
    v_mov_b32 v159, 0
    v_mfma_f32_16x16x32_bf16 v[88:91], a[140:143], a[108:111], v[88:91]
    v_mov_b32 v160, 0
    v_mov_b32 v161, 0
    s_waitcnt lgkmcnt(3)
    v_mfma_f32_16x16x32_bf16 v[68:71], a[144:147], a[0:3], 0
    buffer_store_dwordx4 v[112:115], v50, s[44:47], s66 offen offset:0 sc1
    v_mov_b32 v162, 0
    v_mov_b32 v163, 0
    v_mfma_f32_16x16x32_bf16 v[76:79], a[144:147], a[4:7], 0
    v_mov_b32 v164, 0
    v_mov_b32 v165, 0
    v_mfma_f32_16x16x32_bf16 v[84:87], a[144:147], a[8:11], 0
    v_mov_b32 v166, 0
    v_mov_b32 v167, 0
    v_mfma_f32_16x16x32_bf16 v[92:95], a[144:147], a[12:15], 0
    v_mov_b32 v168, 0
    v_mov_b32 v169, 0
    s_waitcnt lgkmcnt(2)
    v_mfma_f32_16x16x32_bf16 v[68:71], a[148:151], a[32:35], v[68:71]
    buffer_store_dwordx4 v[116:119], v50, s[44:47], s66 offen offset:1024 sc1
    v_mov_b32 v170, 0
    v_mov_b32 v171, 0
    v_mfma_f32_16x16x32_bf16 v[76:79], a[148:151], a[36:39], v[76:79]
    v_mov_b32 v172, 0
    v_mov_b32 v173, 0
    v_mfma_f32_16x16x32_bf16 v[84:87], a[148:151], a[40:43], v[84:87]
    v_mov_b32 v174, 0
    v_mov_b32 v175, 0
    v_mfma_f32_16x16x32_bf16 v[92:95], a[148:151], a[44:47], v[92:95]
    v_mov_b32 v176, 0
    v_mov_b32 v177, 0
    s_waitcnt lgkmcnt(1)
    v_mfma_f32_16x16x32_bf16 v[68:71], a[152:155], a[64:67], v[68:71]
    buffer_store_dwordx4 v[120:123], v51, s[44:47], s66 offen offset:2048 sc1
    v_mov_b32 v178, 0
    v_mov_b32 v179, 0
    v_mfma_f32_16x16x32_bf16 v[76:79], a[152:155], a[68:71], v[76:79]
    v_mov_b32 v180, 0
    v_mov_b32 v181, 0
    v_mfma_f32_16x16x32_bf16 v[84:87], a[152:155], a[72:75], v[84:87]
    v_mov_b32 v182, 0
    v_mov_b32 v183, 0
    v_mfma_f32_16x16x32_bf16 v[92:95], a[152:155], a[76:79], v[92:95]
    v_mov_b32 v184, 0
    v_mov_b32 v185, 0
    s_waitcnt lgkmcnt(0)
    v_mfma_f32_16x16x32_bf16 v[68:71], a[156:159], a[96:99], v[68:71]
    buffer_store_dwordx4 v[124:127], v51, s[44:47], s66 offen offset:3072 sc1
    v_mov_b32 v186, 0
    v_mov_b32 v187, 0
    v_mfma_f32_16x16x32_bf16 v[76:79], a[156:159], a[100:103], v[76:79]
    v_mov_b32 v188, 0
    v_mov_b32 v189, 0
    v_mfma_f32_16x16x32_bf16 v[84:87], a[156:159], a[104:107], v[84:87]
    v_mov_b32 v190, 0
    v_mov_b32 v191, 0
    v_mfma_f32_16x16x32_bf16 v[92:95], a[156:159], a[108:111], v[92:95]
    s_mov_b32 s62, 24576
    s_mov_b32 s63, 16384
    s_mov_b32 s61, 14
    s_cmp_lg_u32 s64, 0
    s_cbranch_scc1 L_have_max2
    s_nop 3
    v_max3_f32 v97, v64, v65, v66
    v_max3_f32 v101, v72, v73, v74
    v_max3_f32 v105, v80, v81, v82
    v_max3_f32 v109, v88, v89, v90
    v_max3_f32 v97, v97, v67, v68
    v_max3_f32 v101, v101, v75, v76
    v_max3_f32 v105, v105, v83, v84
    v_max3_f32 v109, v109, v91, v92
    v_max3_f32 v97, v97, v69, v70
    v_max3_f32 v101, v101, v77, v78
    v_max3_f32 v105, v105, v85, v86
    v_max3_f32 v109, v109, v93, v94
    v_max_f32 v97, v97, v71
    v_max_f32 v101, v101, v79
    v_max_f32 v105, v105, v87
    v_max_f32 v109, v109, v95
    v_mov_b32 v98, v97
    v_mov_b32 v102, v101
    v_mov_b32 v106, v105
    v_mov_b32 v110, v109
    v_permlane32_swap_b32 v97, v98
    v_permlane32_swap_b32 v101, v102
    v_permlane32_swap_b32 v105, v106
    v_permlane32_swap_b32 v109, v110
    v_max_f32 v97, v97, v98
    v_max_f32 v101, v101, v102
    v_max_f32 v105, v105, v106
    v_max_f32 v109, v109, v110
    v_mov_b32 v98, v97
    v_mov_b32 v102, v101
    v_mov_b32 v106, v105
    v_mov_b32 v110, v109
    v_permlane16_swap_b32 v97, v98
    v_permlane16_swap_b32 v101, v102
    v_permlane16_swap_b32 v105, v106
    v_permlane16_swap_b32 v109, v110
    v_max_f32 v97, v97, v98
    v_max_f32 v101, v101, v102
    v_max_f32 v105, v105, v106
    v_max_f32 v109, v109, v110
    v_sub_f32 v48, 0, v97
    v_sub_f32 v49, 0, v97
    v_sub_f32 v50, 0, v97
    v_sub_f32 v51, 0, v97
    v_sub_f32 v52, 0, v101
    v_sub_f32 v53, 0, v101
    v_sub_f32 v54, 0, v101
    v_sub_f32 v55, 0, v101
    v_sub_f32 v56, 0, v105
    v_sub_f32 v57, 0, v105
    v_sub_f32 v58, 0, v105
    v_sub_f32 v59, 0, v105
    v_sub_f32 v60, 0, v109
    v_sub_f32 v61, 0, v109
    v_sub_f32 v62, 0, v109
    v_sub_f32 v63, 0, v109
L_have_max2:
    s_nop 3
    v_add_f32 v64, v64, v48
    v_add_f32 v65, v65, v48
    v_add_f32 v66, v66, v48
    v_add_f32 v67, v67, v48
    v_add_f32 v68, v68, v48
    v_add_f32 v69, v69, v48
    v_add_f32 v70, v70, v48
    v_add_f32 v71, v71, v48
    v_add_f32 v72, v72, v52
    v_add_f32 v73, v73, v52
    v_add_f32 v74, v74, v52
    v_add_f32 v75, v75, v52
    v_add_f32 v76, v76, v52
    v_add_f32 v77, v77, v52
    v_add_f32 v78, v78, v52
    v_add_f32 v79, v79, v52
    v_add_f32 v80, v80, v56
    v_add_f32 v81, v81, v56
    v_add_f32 v82, v82, v56
    v_add_f32 v83, v83, v56
    v_add_f32 v84, v84, v56
    v_add_f32 v85, v85, v56
    v_add_f32 v86, v86, v56
    v_add_f32 v87, v87, v56
    v_add_f32 v88, v88, v60
    v_add_f32 v89, v89, v60
    v_add_f32 v90, v90, v60
    v_add_f32 v91, v91, v60
    v_add_f32 v92, v92, v60
    v_add_f32 v93, v93, v60
    v_add_f32 v94, v94, v60
    v_add_f32 v95, v95, v60
    v_exp_f32 v64, v64
    s_nop 0
    v_exp_f32 v65, v65
    s_nop 0
    v_exp_f32 v66, v66
    s_nop 0
    v_cvt_pk_bf16_f32 v64, v64, v65
    v_exp_f32 v67, v67
    s_nop 0
    v_exp_f32 v72, v72
    s_nop 0
    v_cvt_pk_bf16_f32 v65, v66, v67
    v_exp_f32 v73, v73
    s_nop 0
    v_exp_f32 v74, v74
    s_nop 0
    v_cvt_pk_bf16_f32 v72, v72, v73
    v_exp_f32 v75, v75
    s_nop 0
    v_exp_f32 v80, v80
    s_nop 0
    v_cvt_pk_bf16_f32 v73, v74, v75
    v_exp_f32 v81, v81
    s_nop 0
    v_exp_f32 v82, v82
    s_nop 0
    v_cvt_pk_bf16_f32 v80, v80, v81
    v_exp_f32 v83, v83
    s_nop 0
    s_and_b32 s55, s53, 3
    s_sub_u32 s55, 13, s55
    s_cmp_eq_u32 s54, 0
    s_cselect_b32 s78, s55, -1
    s_cmp_eq_u32 s64, 0
    s_cselect_b32 s78, s78, -1
    s_mov_b64 s[16:17], s[8:9]
    s_cmp_lt_u32 s54, 2
    s_cselect_b64 s[18:19], s[8:9], s[12:13]
    s_and_b32 s55, s54, 1
    s_lshr_b32 s56, s2, 3
    s_lshl_b32 s56, s56, 1
    s_add_u32 s55, s55, s56
    s_lshl_b32 s55, s55, 13
    s_add_u32 s18, s18, s55
    s_addc_u32 s19, s19, 0
    s_waitcnt lgkmcnt(0)
    s_barrier
    s_add_u32 m0, s59, 65536
    v_exp_f32 v88, v88
    ds_read_b128 a[128:131], v20 offset:16384
    v_cvt_pk_bf16_f32 v81, v82, v83
    v_exp_f32 v89, v89
    buffer_load_dwordx4 v32, s[8:11], s62 offen offset:0 lds
    v_exp_f32 v90, v90
    ds_read_b128 a[132:135], v21 offset:16384
    v_cvt_pk_bf16_f32 v88, v88, v89
    v_exp_f32 v91, v91
    buffer_load_dwordx4 v33, s[8:11], s62 offen offset:1024 lds
    v_exp_f32 v68, v68
    ds_read_b128 a[136:139], v22 offset:16384
    v_cvt_pk_bf16_f32 v89, v90, v91
    s_waitcnt lgkmcnt(2)
    v_exp_f32 v69, v69
    buffer_load_dwordx4 v34, s[8:11], s62 offen offset:2048 lds
.p2align 6
L_att_loop:
    v_mfma_f32_16x16x32_bf16 v[96:99], a[128:131], a[0:3], v[48:51]
    v_exp_f32 v70, v70
    v_mfma_f32_16x16x32_bf16 v[104:107], a[128:131], a[4:7], v[52:55]
    ds_read_b128 a[140:143], v23 offset:16384
    v_cmp_eq_u32 vcc, 1, v0
    v_mfma_f32_16x16x32_bf16 v[112:115], a[128:131], a[8:11], v[56:59]
    s_waitcnt lgkmcnt(2)
    v_exp_f32 v71, v71
    v_mfma_f32_16x16x32_bf16 v[120:123], a[128:131], a[12:15], v[60:63]
    buffer_load_dwordx4 v35, s[8:11], s62 offen offset:3072 lds
    v_cvt_pk_bf16_f32 v66, v68, v69
    v_mfma_f32_16x16x32_bf16 v[96:99], a[132:135], a[32:35], v[96:99]
    s_add_u32 m0, s59, 16384
    v_exp_f32 v76, v76
    v_mfma_f32_16x16x32_bf16 v[104:107], a[132:135], a[36:39], v[104:107]
    ds_read_b128 a[144:147], v20 offset:20480
    v_cvt_pk_bf16_f32 v67, v70, v71
    v_mfma_f32_16x16x32_bf16 v[112:115], a[132:135], a[40:43], v[112:115]
    s_waitcnt lgkmcnt(2)
    v_exp_f32 v77, v77
    v_mfma_f32_16x16x32_bf16 v[120:123], a[132:135], a[44:47], v[120:123]
    buffer_load_dwordx4 v36, s[12:15], s63 offen offset:0 lds
    v_mfma_f32_16x16x32_bf16 v[96:99], a[136:139], a[64:67], v[96:99]
    s_cmp_eq_u32 vcc_lo, -1
    v_exp_f32 v78, v78
    v_mfma_f32_16x16x32_bf16 v[104:107], a[136:139], a[68:71], v[104:107]
    ds_read_b128 a[148:151], v21 offset:20480
    v_cvt_pk_bf16_f32 v74, v76, v77
    v_mfma_f32_16x16x32_bf16 v[112:115], a[136:139], a[72:75], v[112:115]
    s_waitcnt lgkmcnt(2)
    v_exp_f32 v79, v79
    v_mfma_f32_16x16x32_bf16 v[120:123], a[136:139], a[76:79], v[120:123]
    buffer_load_dwordx4 v37, s[12:15], s63 offen offset:1024 lds
    v_mfma_f32_16x16x32_bf16 v[96:99], a[140:143], a[96:99], v[96:99]
    s_cselect_b32 s55, s61, -1
    v_exp_f32 v84, v84
    v_mfma_f32_16x16x32_bf16 v[104:107], a[140:143], a[100:103], v[104:107]
    ds_read_b128 a[152:155], v22 offset:20480
    v_cvt_pk_bf16_f32 v75, v78, v79
    v_mfma_f32_16x16x32_bf16 v[112:115], a[140:143], a[104:107], v[112:115]
    s_waitcnt lgkmcnt(2)
    v_exp_f32 v85, v85
    v_mfma_f32_16x16x32_bf16 v[120:123], a[140:143], a[108:111], v[120:123]
    buffer_load_dwordx4 v36, s[12:15], s63 offen offset:2048 lds
    v_mfma_f32_16x16x32_bf16 v[100:103], a[144:147], a[0:3], v[48:51]
    s_cmp_eq_u32 s55, 7
    v_exp_f32 v86, v86
    v_mfma_f32_16x16x32_bf16 v[108:111], a[144:147], a[4:7], v[52:55]
    ds_read_b128 a[156:159], v23 offset:20480
    v_cvt_pk_bf16_f32 v82, v84, v85
    v_mfma_f32_16x16x32_bf16 v[116:119], a[144:147], a[8:11], v[56:59]
    s_waitcnt lgkmcnt(2)
    v_exp_f32 v87, v87
    v_mfma_f32_16x16x32_bf16 v[124:127], a[144:147], a[12:15], v[60:63]
    buffer_load_dwordx4 v37, s[12:15], s63 offen offset:3072 lds
    v_mfma_f32_16x16x32_bf16 v[100:103], a[148:151], a[32:35], v[100:103]
    s_cselect_b64 s[30:31], s[94:95], s[30:31]
    v_exp_f32 v92, v92
    v_mfma_f32_16x16x32_bf16 v[108:111], a[148:151], a[36:39], v[108:111]
    ds_read_b64_tr_b16 a[128:129], v24 offset:0
    v_cvt_pk_bf16_f32 v83, v86, v87
    v_mfma_f32_16x16x32_bf16 v[116:119], a[148:151], a[40:43], v[116:119]
    s_waitcnt lgkmcnt(2)
    v_exp_f32 v93, v93
    v_mfma_f32_16x16x32_bf16 v[124:127], a[148:151], a[44:47], v[124:127]
    ds_read_b64_tr_b16 a[130:131], v24 offset:4096
    v_mfma_f32_16x16x32_bf16 v[100:103], a[152:155], a[64:67], v[100:103]
    s_add_u32 s62, s62, 16384
    v_exp_f32 v94, v94
    v_mfma_f32_16x16x32_bf16 v[108:111], a[152:155], a[68:71], v[108:111]
    ds_read_b64_tr_b16 a[132:133], v25 offset:0
    v_cvt_pk_bf16_f32 v90, v92, v93
    v_mfma_f32_16x16x32_bf16 v[116:119], a[152:155], a[72:75], v[116:119]
    s_waitcnt lgkmcnt(3)
    v_exp_f32 v95, v95
    v_mfma_f32_16x16x32_bf16 v[124:127], a[152:155], a[76:79], v[124:127]
    ds_read_b64_tr_b16 a[134:135], v25 offset:4096
    v_mfma_f32_16x16x32_bf16 v[100:103], a[156:159], a[96:99], v[100:103]
    s_add_u32 s63, s63, 16384
    v_exp_f32 v96, v96
    v_mfma_f32_16x16x32_bf16 v[108:111], a[156:159], a[100:103], v[108:111]
    ds_read_b64_tr_b16 a[136:137], v26 offset:0
    v_cvt_pk_bf16_f32 v91, v94, v95
    v_mfma_f32_16x16x32_bf16 v[116:119], a[156:159], a[104:107], v[116:119]
    s_waitcnt lgkmcnt(3)
    v_exp_f32 v97, v97
    v_mfma_f32_16x16x32_bf16 v[124:127], a[156:159], a[108:111], v[124:127]
    ds_read_b64_tr_b16 a[138:139], v26 offset:4096
    v_mfma_f32_16x16x32_bf16 v[128:131], v[64:67], a[128:131], v[128:131]
    s_cmp_le_u32 s61, 8
    v_exp_f32 v98, v98
    v_mfma_f32_16x16x32_bf16 v[132:135], v[72:75], a[128:131], v[132:135]
    ds_read_b64_tr_b16 a[140:141], v27 offset:0
    v_cvt_pk_bf16_f32 v96, v96, v97
    v_mfma_f32_16x16x32_bf16 v[136:139], v[80:83], a[128:131], v[136:139]
    s_waitcnt lgkmcnt(3)
    v_exp_f32 v99, v99
    v_mfma_f32_16x16x32_bf16 v[140:143], v[88:91], a[128:131], v[140:143]
    ds_read_b64_tr_b16 a[142:143], v27 offset:4096
    v_mfma_f32_16x16x32_bf16 v[156:159], v[88:91], a[132:135], v[156:159]
    s_cselect_b64 s[16:17], s[24:25], s[16:17]
    v_exp_f32 v104, v104
    v_mfma_f32_16x16x32_bf16 v[152:155], v[80:83], a[132:135], v[152:155]
    ds_read_b64_tr_b16 a[144:145], v28 offset:0
    v_cvt_pk_bf16_f32 v97, v98, v99
    v_mfma_f32_16x16x32_bf16 v[148:151], v[72:75], a[132:135], v[148:151]
    s_waitcnt lgkmcnt(3)
    v_exp_f32 v105, v105
    v_mfma_f32_16x16x32_bf16 v[144:147], v[64:67], a[132:135], v[144:147]
    ds_read_b64_tr_b16 a[146:147], v28 offset:4096
    v_mfma_f32_16x16x32_bf16 a[224:227], a[240:243], v[64:67], a[224:227]
    v_mfma_f32_16x16x32_bf16 v[160:163], v[64:67], a[136:139], v[160:163]
    s_cselect_b64 s[24:25], s[26:27], s[24:25]
    v_exp_f32 v106, v106
    v_mfma_f32_16x16x32_bf16 v[164:167], v[72:75], a[136:139], v[164:167]
    ds_read_b64_tr_b16 a[148:149], v29 offset:0
    v_cvt_pk_bf16_f32 v104, v104, v105
    v_mfma_f32_16x16x32_bf16 v[168:171], v[80:83], a[136:139], v[168:171]
    s_waitcnt lgkmcnt(3)
    v_exp_f32 v107, v107
    v_mfma_f32_16x16x32_bf16 v[172:175], v[88:91], a[136:139], v[172:175]
    ds_read_b64_tr_b16 a[150:151], v29 offset:4096
    v_mfma_f32_16x16x32_bf16 v[188:191], v[88:91], a[140:143], v[188:191]
    s_cselect_b64 s[26:27], s[28:29], s[26:27]
    v_exp_f32 v112, v112
    v_mfma_f32_16x16x32_bf16 v[184:187], v[80:83], a[140:143], v[184:187]
    ds_read_b64_tr_b16 a[152:153], v30 offset:0
    v_cvt_pk_bf16_f32 v105, v106, v107
    v_mfma_f32_16x16x32_bf16 v[180:183], v[72:75], a[140:143], v[180:183]
    s_waitcnt lgkmcnt(3)
    v_exp_f32 v113, v113
    v_mfma_f32_16x16x32_bf16 v[176:179], v[64:67], a[140:143], v[176:179]
    ds_read_b64_tr_b16 a[154:155], v30 offset:4096
    v_mfma_f32_16x16x32_bf16 a[228:231], a[240:243], v[72:75], a[228:231]
    v_mfma_f32_16x16x32_bf16 v[192:195], v[64:67], a[144:147], v[192:195]
    s_cselect_b64 s[28:29], s[30:31], s[28:29]
    v_exp_f32 v114, v114
    v_mfma_f32_16x16x32_bf16 v[196:199], v[72:75], a[144:147], v[196:199]
    ds_read_b64_tr_b16 a[156:157], v31 offset:0
    v_cvt_pk_bf16_f32 v112, v112, v113
    v_mfma_f32_16x16x32_bf16 v[200:203], v[80:83], a[144:147], v[200:203]
    s_waitcnt lgkmcnt(3)
    v_exp_f32 v115, v115
    v_mfma_f32_16x16x32_bf16 v[204:207], v[88:91], a[144:147], v[204:207]
    ds_read_b64_tr_b16 a[158:159], v31 offset:4096
    v_mfma_f32_16x16x32_bf16 v[220:223], v[88:91], a[148:151], v[220:223]
    s_cselect_b32 s57, s3, 256
    v_exp_f32 v120, v120
    v_mfma_f32_16x16x32_bf16 v[216:219], v[80:83], a[148:151], v[216:219]
    ds_read_b128 a[128:131], v20 offset:24576
    v_cvt_pk_bf16_f32 v113, v114, v115
    v_mfma_f32_16x16x32_bf16 v[212:215], v[72:75], a[148:151], v[212:215]
    s_waitcnt lgkmcnt(3)
    v_exp_f32 v121, v121
    v_mfma_f32_16x16x32_bf16 v[208:211], v[64:67], a[148:151], v[208:211]
    buffer_load_ubyte v0, v38, s[40:43], s57 offen sc1
    v_mfma_f32_16x16x32_bf16 a[232:235], a[240:243], v[80:83], a[232:235]
    v_mfma_f32_16x16x32_bf16 v[224:227], v[64:67], a[152:155], v[224:227]
    v_exp_f32 v122, v122
    v_mfma_f32_16x16x32_bf16 v[228:231], v[72:75], a[152:155], v[228:231]
    ds_read_b128 a[132:135], v21 offset:24576
    v_cvt_pk_bf16_f32 v120, v120, v121
    v_mfma_f32_16x16x32_bf16 v[232:235], v[80:83], a[152:155], v[232:235]
    s_waitcnt lgkmcnt(2)
    v_exp_f32 v123, v123
    v_mfma_f32_16x16x32_bf16 v[236:239], v[88:91], a[152:155], v[236:239]
    global_load_dword v39, v3, s[16:17]
    v_mfma_f32_16x16x32_bf16 v[252:255], v[88:91], a[156:159], v[252:255]
    s_cselect_b64 s[30:31], s[8:9], s[30:31]
    v_exp_f32 v100, v100
    v_mfma_f32_16x16x32_bf16 v[248:251], v[80:83], a[156:159], v[248:251]
    ds_read_b128 a[136:139], v22 offset:24576
    v_cvt_pk_bf16_f32 v121, v122, v123
    v_mfma_f32_16x16x32_bf16 v[244:247], v[72:75], a[156:159], v[244:247]
    s_waitcnt lgkmcnt(2)
    v_exp_f32 v101, v101
    v_mfma_f32_16x16x32_bf16 v[240:243], v[64:67], a[156:159], v[240:243]
    v_mfma_f32_16x16x32_bf16 a[236:239], a[240:243], v[88:91], a[236:239]
    v_mfma_f32_16x16x32_bf16 v[64:67], a[128:131], a[0:3], v[48:51]
    v_exp_f32 v102, v102
    v_mfma_f32_16x16x32_bf16 v[72:75], a[128:131], a[4:7], v[52:55]
    ds_read_b128 a[140:143], v23 offset:24576
    v_cvt_pk_bf16_f32 v98, v100, v101
    v_mfma_f32_16x16x32_bf16 v[80:83], a[128:131], a[8:11], v[56:59]
    s_waitcnt lgkmcnt(2)
    v_exp_f32 v103, v103
    v_mfma_f32_16x16x32_bf16 v[88:91], a[128:131], a[12:15], v[60:63]
    v_mfma_f32_16x16x32_bf16 v[64:67], a[132:135], a[32:35], v[64:67]
    v_exp_f32 v108, v108
    v_mfma_f32_16x16x32_bf16 v[72:75], a[132:135], a[36:39], v[72:75]
    ds_read_b128 a[144:147], v20 offset:28672
    v_cvt_pk_bf16_f32 v99, v102, v103
    v_mfma_f32_16x16x32_bf16 v[80:83], a[132:135], a[40:43], v[80:83]
    s_waitcnt lgkmcnt(2)
    v_exp_f32 v109, v109
    v_mfma_f32_16x16x32_bf16 v[88:91], a[132:135], a[44:47], v[88:91]
    v_mfma_f32_16x16x32_bf16 v[64:67], a[136:139], a[64:67], v[64:67]
    s_cmp_eq_u32 s61, s78
    v_exp_f32 v110, v110
    v_mfma_f32_16x16x32_bf16 v[72:75], a[136:139], a[68:71], v[72:75]
    ds_read_b128 a[148:151], v21 offset:28672
    v_cvt_pk_bf16_f32 v106, v108, v109
    v_mfma_f32_16x16x32_bf16 v[80:83], a[136:139], a[72:75], v[80:83]
    s_waitcnt lgkmcnt(2)
    v_exp_f32 v111, v111
    v_mfma_f32_16x16x32_bf16 v[88:91], a[136:139], a[76:79], v[88:91]
    v_mfma_f32_16x16x32_bf16 v[64:67], a[140:143], a[96:99], v[64:67]
    s_cbranch_scc1 L_sigH_side
L_sigH_ret:
    v_exp_f32 v116, v116
    v_mfma_f32_16x16x32_bf16 v[72:75], a[140:143], a[100:103], v[72:75]
    ds_read_b128 a[152:155], v22 offset:28672
    ds_read_b64_tr_b16 a[128:129], v24 offset:8192
    v_mfma_f32_16x16x32_bf16 v[80:83], a[140:143], a[104:107], v[80:83]
    s_waitcnt lgkmcnt(3)
    v_exp_f32 v117, v117
    v_mfma_f32_16x16x32_bf16 v[88:91], a[140:143], a[108:111], v[88:91]
    ds_read_b64_tr_b16 a[130:131], v24 offset:12288
    v_cvt_pk_bf16_f32 v107, v110, v111
    v_mfma_f32_16x16x32_bf16 v[68:71], a[144:147], a[0:3], v[48:51]
    s_cmp_eq_u32 s61, 13
    v_exp_f32 v118, v118
    v_mfma_f32_16x16x32_bf16 v[76:79], a[144:147], a[4:7], v[52:55]
    ds_read_b128 a[156:159], v23 offset:28672
    ds_read_b64_tr_b16 a[132:133], v25 offset:8192
    v_mfma_f32_16x16x32_bf16 v[84:87], a[144:147], a[8:11], v[56:59]
    s_waitcnt lgkmcnt(5)
    v_exp_f32 v119, v119
    v_mfma_f32_16x16x32_bf16 v[92:95], a[144:147], a[12:15], v[60:63]
    ds_read_b64_tr_b16 a[134:135], v25 offset:12288
    v_cvt_pk_bf16_f32 v114, v116, v117
    v_mfma_f32_16x16x32_bf16 v[68:71], a[148:151], a[32:35], v[68:71]
    s_cselect_b64 s[16:17], s[18:19], s[8:9]
    v_exp_f32 v124, v124
    v_mfma_f32_16x16x32_bf16 v[76:79], a[148:151], a[36:39], v[76:79]
    ds_read_b64_tr_b16 a[136:137], v26 offset:8192
    v_cvt_pk_bf16_f32 v115, v118, v119
    v_mfma_f32_16x16x32_bf16 v[84:87], a[148:151], a[40:43], v[84:87]
    s_waitcnt lgkmcnt(6)
    v_exp_f32 v125, v125
    v_mfma_f32_16x16x32_bf16 v[92:95], a[148:151], a[44:47], v[92:95]
    ds_read_b64_tr_b16 a[138:139], v26 offset:12288
    v_mfma_f32_16x16x32_bf16 v[68:71], a[152:155], a[64:67], v[68:71]
    v_exp_f32 v126, v126
    v_mfma_f32_16x16x32_bf16 v[76:79], a[152:155], a[68:71], v[76:79]
    ds_read_b64_tr_b16 a[140:141], v27 offset:8192
    v_cvt_pk_bf16_f32 v122, v124, v125
    v_mfma_f32_16x16x32_bf16 v[84:87], a[152:155], a[72:75], v[84:87]
    s_waitcnt lgkmcnt(5)
    v_exp_f32 v127, v127
    v_mfma_f32_16x16x32_bf16 v[92:95], a[152:155], a[76:79], v[92:95]
    ds_read_b64_tr_b16 a[142:143], v27 offset:12288
    v_mfma_f32_16x16x32_bf16 v[68:71], a[156:159], a[96:99], v[68:71]
    v_exp_f32 v64, v64
    v_mfma_f32_16x16x32_bf16 v[76:79], a[156:159], a[100:103], v[76:79]
    ds_read_b64_tr_b16 a[144:145], v28 offset:8192
    v_cvt_pk_bf16_f32 v123, v126, v127
    v_mfma_f32_16x16x32_bf16 v[84:87], a[156:159], a[104:107], v[84:87]
    v_exp_f32 v65, v65
    v_mfma_f32_16x16x32_bf16 v[92:95], a[156:159], a[108:111], v[92:95]
    ds_read_b64_tr_b16 a[146:147], v28 offset:12288
    v_mfma_f32_16x16x32_bf16 v[128:131], v[96:99], a[128:131], v[128:131]
    v_exp_f32 v66, v66
    v_mfma_f32_16x16x32_bf16 v[132:135], v[104:107], a[128:131], v[132:135]
    ds_read_b64_tr_b16 a[148:149], v29 offset:8192
    v_cvt_pk_bf16_f32 v64, v64, v65
    v_mfma_f32_16x16x32_bf16 v[136:139], v[112:115], a[128:131], v[136:139]
    s_waitcnt lgkmcnt(7)
    v_exp_f32 v67, v67
    v_mfma_f32_16x16x32_bf16 v[140:143], v[120:123], a[128:131], v[140:143]
    ds_read_b64_tr_b16 a[150:151], v29 offset:12288
    v_mfma_f32_16x16x32_bf16 v[156:159], v[120:123], a[132:135], v[156:159]
    v_exp_f32 v72, v72
    v_mfma_f32_16x16x32_bf16 v[152:155], v[112:115], a[132:135], v[152:155]
    ds_read_b64_tr_b16 a[152:153], v30 offset:8192
    v_cvt_pk_bf16_f32 v65, v66, v67
    v_mfma_f32_16x16x32_bf16 v[148:151], v[104:107], a[132:135], v[148:151]
    s_waitcnt lgkmcnt(7)
    v_exp_f32 v73, v73
    v_mfma_f32_16x16x32_bf16 v[144:147], v[96:99], a[132:135], v[144:147]
    ds_read_b64_tr_b16 a[154:155], v30 offset:12288
    v_mfma_f32_16x16x32_bf16 a[224:227], a[240:243], v[96:99], a[224:227]
    v_mfma_f32_16x16x32_bf16 v[160:163], v[96:99], a[136:139], v[160:163]
    v_exp_f32 v74, v74
    v_mfma_f32_16x16x32_bf16 v[164:167], v[104:107], a[136:139], v[164:167]
    ds_read_b64_tr_b16 a[156:157], v31 offset:8192
    v_cvt_pk_bf16_f32 v72, v72, v73
    v_mfma_f32_16x16x32_bf16 v[168:171], v[112:115], a[136:139], v[168:171]
    s_waitcnt lgkmcnt(7)
    v_exp_f32 v75, v75
    v_mfma_f32_16x16x32_bf16 v[172:175], v[120:123], a[136:139], v[172:175]
    ds_read_b64_tr_b16 a[158:159], v31 offset:12288
    v_mfma_f32_16x16x32_bf16 v[188:191], v[120:123], a[140:143], v[188:191]
    v_exp_f32 v80, v80
    v_mfma_f32_16x16x32_bf16 v[184:187], v[112:115], a[140:143], v[184:187]
    v_cvt_pk_bf16_f32 v73, v74, v75
    v_mfma_f32_16x16x32_bf16 v[180:183], v[104:107], a[140:143], v[180:183]
    s_waitcnt lgkmcnt(6)
    v_exp_f32 v81, v81
    v_mfma_f32_16x16x32_bf16 v[176:179], v[96:99], a[140:143], v[176:179]
    v_mfma_f32_16x16x32_bf16 a[228:231], a[240:243], v[104:107], a[228:231]
    v_mfma_f32_16x16x32_bf16 v[192:195], v[96:99], a[144:147], v[192:195]
    v_exp_f32 v82, v82
    v_mfma_f32_16x16x32_bf16 v[196:199], v[104:107], a[144:147], v[196:199]
    v_cvt_pk_bf16_f32 v80, v80, v81
    v_mfma_f32_16x16x32_bf16 v[200:203], v[112:115], a[144:147], v[200:203]
    s_waitcnt lgkmcnt(4)
    v_exp_f32 v83, v83
    v_mfma_f32_16x16x32_bf16 v[204:207], v[120:123], a[144:147], v[204:207]
    v_mfma_f32_16x16x32_bf16 v[220:223], v[120:123], a[148:151], v[220:223]
    s_waitcnt vmcnt(2) lgkmcnt(0)
    s_barrier
    s_add_u32 m0, s59, 81920
    v_exp_f32 v88, v88
    v_mfma_f32_16x16x32_bf16 v[216:219], v[112:115], a[148:151], v[216:219]
    ds_read_b128 a[128:131], v20 offset:0
    v_cvt_pk_bf16_f32 v81, v82, v83
    v_mfma_f32_16x16x32_bf16 v[212:215], v[104:107], a[148:151], v[212:215]
    v_exp_f32 v89, v89
    v_mfma_f32_16x16x32_bf16 v[208:211], v[96:99], a[148:151], v[208:211]
    buffer_load_dwordx4 v32, s[8:11], s62 offen offset:0 lds
    v_mfma_f32_16x16x32_bf16 a[232:235], a[240:243], v[112:115], a[232:235]
    v_mfma_f32_16x16x32_bf16 v[224:227], v[96:99], a[152:155], v[224:227]
    v_exp_f32 v90, v90
    v_mfma_f32_16x16x32_bf16 v[228:231], v[104:107], a[152:155], v[228:231]
    ds_read_b128 a[132:135], v21 offset:0
    v_cvt_pk_bf16_f32 v88, v88, v89
    v_mfma_f32_16x16x32_bf16 v[232:235], v[112:115], a[152:155], v[232:235]
    v_exp_f32 v91, v91
    v_mfma_f32_16x16x32_bf16 v[236:239], v[120:123], a[152:155], v[236:239]
    buffer_load_dwordx4 v33, s[8:11], s62 offen offset:1024 lds
    v_mfma_f32_16x16x32_bf16 v[252:255], v[120:123], a[156:159], v[252:255]
    v_exp_f32 v68, v68
    v_mfma_f32_16x16x32_bf16 v[248:251], v[112:115], a[156:159], v[248:251]
    ds_read_b128 a[136:139], v22 offset:0
    v_cvt_pk_bf16_f32 v89, v90, v91
    v_mfma_f32_16x16x32_bf16 v[244:247], v[104:107], a[156:159], v[244:247]
    s_waitcnt lgkmcnt(2)
    v_exp_f32 v69, v69
    v_mfma_f32_16x16x32_bf16 v[240:243], v[96:99], a[156:159], v[240:243]
    buffer_load_dwordx4 v34, s[8:11], s62 offen offset:2048 lds
    v_mfma_f32_16x16x32_bf16 a[236:239], a[240:243], v[120:123], a[236:239]
    v_mfma_f32_16x16x32_bf16 v[96:99], a[128:131], a[0:3], v[48:51]
    v_exp_f32 v70, v70
    v_mfma_f32_16x16x32_bf16 v[104:107], a[128:131], a[4:7], v[52:55]
    ds_read_b128 a[140:143], v23 offset:0
    v_cvt_pk_bf16_f32 v66, v68, v69
    v_mfma_f32_16x16x32_bf16 v[112:115], a[128:131], a[8:11], v[56:59]
    s_waitcnt lgkmcnt(2)
    v_exp_f32 v71, v71
    v_mfma_f32_16x16x32_bf16 v[120:123], a[128:131], a[12:15], v[60:63]
    buffer_load_dwordx4 v35, s[8:11], s62 offen offset:3072 lds
    v_mfma_f32_16x16x32_bf16 v[96:99], a[132:135], a[32:35], v[96:99]
    s_add_u32 m0, s59, 0
    v_exp_f32 v76, v76
    v_mfma_f32_16x16x32_bf16 v[104:107], a[132:135], a[36:39], v[104:107]
    ds_read_b128 a[144:147], v20 offset:4096
    v_cvt_pk_bf16_f32 v67, v70, v71
    v_mfma_f32_16x16x32_bf16 v[112:115], a[132:135], a[40:43], v[112:115]
    s_waitcnt lgkmcnt(2)
    v_exp_f32 v77, v77
    v_mfma_f32_16x16x32_bf16 v[120:123], a[132:135], a[44:47], v[120:123]
    buffer_load_dwordx4 v36, s[12:15], s63 offen offset:0 lds
    v_mfma_f32_16x16x32_bf16 v[96:99], a[136:139], a[64:67], v[96:99]
    v_exp_f32 v78, v78
    v_mfma_f32_16x16x32_bf16 v[104:107], a[136:139], a[68:71], v[104:107]
    ds_read_b128 a[148:151], v21 offset:4096
    v_cvt_pk_bf16_f32 v74, v76, v77
    v_mfma_f32_16x16x32_bf16 v[112:115], a[136:139], a[72:75], v[112:115]
    s_waitcnt lgkmcnt(2)
    v_exp_f32 v79, v79
    v_mfma_f32_16x16x32_bf16 v[120:123], a[136:139], a[76:79], v[120:123]
    buffer_load_dwordx4 v37, s[12:15], s63 offen offset:1024 lds
    v_mfma_f32_16x16x32_bf16 v[96:99], a[140:143], a[96:99], v[96:99]
    v_exp_f32 v84, v84
    v_mfma_f32_16x16x32_bf16 v[104:107], a[140:143], a[100:103], v[104:107]
    ds_read_b128 a[152:155], v22 offset:4096
    v_cvt_pk_bf16_f32 v75, v78, v79
    v_mfma_f32_16x16x32_bf16 v[112:115], a[140:143], a[104:107], v[112:115]
    s_waitcnt lgkmcnt(2)
    v_exp_f32 v85, v85
    v_mfma_f32_16x16x32_bf16 v[120:123], a[140:143], a[108:111], v[120:123]
    buffer_load_dwordx4 v36, s[12:15], s63 offen offset:2048 lds
    v_mfma_f32_16x16x32_bf16 v[100:103], a[144:147], a[0:3], v[48:51]
    v_exp_f32 v86, v86
    v_mfma_f32_16x16x32_bf16 v[108:111], a[144:147], a[4:7], v[52:55]
    ds_read_b128 a[156:159], v23 offset:4096
    v_cvt_pk_bf16_f32 v82, v84, v85
    v_mfma_f32_16x16x32_bf16 v[116:119], a[144:147], a[8:11], v[56:59]
    s_waitcnt lgkmcnt(2)
    v_exp_f32 v87, v87
    v_mfma_f32_16x16x32_bf16 v[124:127], a[144:147], a[12:15], v[60:63]
    buffer_load_dwordx4 v37, s[12:15], s63 offen offset:3072 lds
    v_mfma_f32_16x16x32_bf16 v[100:103], a[148:151], a[32:35], v[100:103]
    v_exp_f32 v92, v92
    v_mfma_f32_16x16x32_bf16 v[108:111], a[148:151], a[36:39], v[108:111]
    ds_read_b64_tr_b16 a[128:129], v24 offset:16384
    v_cvt_pk_bf16_f32 v83, v86, v87
    v_mfma_f32_16x16x32_bf16 v[116:119], a[148:151], a[40:43], v[116:119]
    s_waitcnt lgkmcnt(2)
    v_exp_f32 v93, v93
    v_mfma_f32_16x16x32_bf16 v[124:127], a[148:151], a[44:47], v[124:127]
    ds_read_b64_tr_b16 a[130:131], v24 offset:20480
    v_mfma_f32_16x16x32_bf16 v[100:103], a[152:155], a[64:67], v[100:103]
    s_add_u32 s62, s62, 16384
    v_exp_f32 v94, v94
    v_mfma_f32_16x16x32_bf16 v[108:111], a[152:155], a[68:71], v[108:111]
    ds_read_b64_tr_b16 a[132:133], v25 offset:16384
    v_cvt_pk_bf16_f32 v90, v92, v93
    v_mfma_f32_16x16x32_bf16 v[116:119], a[152:155], a[72:75], v[116:119]
    s_waitcnt lgkmcnt(3)
    v_exp_f32 v95, v95
    v_mfma_f32_16x16x32_bf16 v[124:127], a[152:155], a[76:79], v[124:127]
    ds_read_b64_tr_b16 a[134:135], v25 offset:20480
    v_mfma_f32_16x16x32_bf16 v[100:103], a[156:159], a[96:99], v[100:103]
    s_add_u32 s63, s63, 16384
    v_exp_f32 v96, v96
    v_mfma_f32_16x16x32_bf16 v[108:111], a[156:159], a[100:103], v[108:111]
    ds_read_b64_tr_b16 a[136:137], v26 offset:16384
    v_cvt_pk_bf16_f32 v91, v94, v95
    v_mfma_f32_16x16x32_bf16 v[116:119], a[156:159], a[104:107], v[116:119]
    s_waitcnt lgkmcnt(3)
    v_exp_f32 v97, v97
    v_mfma_f32_16x16x32_bf16 v[124:127], a[156:159], a[108:111], v[124:127]
    ds_read_b64_tr_b16 a[138:139], v26 offset:20480
    v_mfma_f32_16x16x32_bf16 v[128:131], v[64:67], a[128:131], v[128:131]
    v_exp_f32 v98, v98
    v_mfma_f32_16x16x32_bf16 v[132:135], v[72:75], a[128:131], v[132:135]
    ds_read_b64_tr_b16 a[140:141], v27 offset:16384
    v_cvt_pk_bf16_f32 v96, v96, v97
    v_mfma_f32_16x16x32_bf16 v[136:139], v[80:83], a[128:131], v[136:139]
    s_waitcnt lgkmcnt(3)
    v_exp_f32 v99, v99
    v_mfma_f32_16x16x32_bf16 v[140:143], v[88:91], a[128:131], v[140:143]
    ds_read_b64_tr_b16 a[142:143], v27 offset:20480
    v_mfma_f32_16x16x32_bf16 v[156:159], v[88:91], a[132:135], v[156:159]
    v_exp_f32 v104, v104
    v_mfma_f32_16x16x32_bf16 v[152:155], v[80:83], a[132:135], v[152:155]
    ds_read_b64_tr_b16 a[144:145], v28 offset:16384
    v_cvt_pk_bf16_f32 v97, v98, v99
    v_mfma_f32_16x16x32_bf16 v[148:151], v[72:75], a[132:135], v[148:151]
    s_waitcnt lgkmcnt(3)
    v_exp_f32 v105, v105
    v_mfma_f32_16x16x32_bf16 v[144:147], v[64:67], a[132:135], v[144:147]
    ds_read_b64_tr_b16 a[146:147], v28 offset:20480
    v_mfma_f32_16x16x32_bf16 a[224:227], a[240:243], v[64:67], a[224:227]
    v_mfma_f32_16x16x32_bf16 v[160:163], v[64:67], a[136:139], v[160:163]
    v_exp_f32 v106, v106
    v_mfma_f32_16x16x32_bf16 v[164:167], v[72:75], a[136:139], v[164:167]
    ds_read_b64_tr_b16 a[148:149], v29 offset:16384
    v_cvt_pk_bf16_f32 v104, v104, v105
    v_mfma_f32_16x16x32_bf16 v[168:171], v[80:83], a[136:139], v[168:171]
    s_waitcnt lgkmcnt(3)
    v_exp_f32 v107, v107
    v_mfma_f32_16x16x32_bf16 v[172:175], v[88:91], a[136:139], v[172:175]
    ds_read_b64_tr_b16 a[150:151], v29 offset:20480
    v_mfma_f32_16x16x32_bf16 v[188:191], v[88:91], a[140:143], v[188:191]
    v_exp_f32 v112, v112
    v_mfma_f32_16x16x32_bf16 v[184:187], v[80:83], a[140:143], v[184:187]
    ds_read_b64_tr_b16 a[152:153], v30 offset:16384
    v_cvt_pk_bf16_f32 v105, v106, v107
    v_mfma_f32_16x16x32_bf16 v[180:183], v[72:75], a[140:143], v[180:183]
    s_waitcnt lgkmcnt(3)
    v_exp_f32 v113, v113
    v_mfma_f32_16x16x32_bf16 v[176:179], v[64:67], a[140:143], v[176:179]
    ds_read_b64_tr_b16 a[154:155], v30 offset:20480
    v_mfma_f32_16x16x32_bf16 a[228:231], a[240:243], v[72:75], a[228:231]
    v_mfma_f32_16x16x32_bf16 v[192:195], v[64:67], a[144:147], v[192:195]
    v_exp_f32 v114, v114
    v_mfma_f32_16x16x32_bf16 v[196:199], v[72:75], a[144:147], v[196:199]
    ds_read_b64_tr_b16 a[156:157], v31 offset:16384
    v_cvt_pk_bf16_f32 v112, v112, v113
    v_mfma_f32_16x16x32_bf16 v[200:203], v[80:83], a[144:147], v[200:203]
    s_waitcnt lgkmcnt(3)
    v_exp_f32 v115, v115
    v_mfma_f32_16x16x32_bf16 v[204:207], v[88:91], a[144:147], v[204:207]
    ds_read_b64_tr_b16 a[158:159], v31 offset:20480
    v_mfma_f32_16x16x32_bf16 v[220:223], v[88:91], a[148:151], v[220:223]
    v_exp_f32 v120, v120
    v_mfma_f32_16x16x32_bf16 v[216:219], v[80:83], a[148:151], v[216:219]
    ds_read_b128 a[128:131], v20 offset:8192
    v_cvt_pk_bf16_f32 v113, v114, v115
    v_mfma_f32_16x16x32_bf16 v[212:215], v[72:75], a[148:151], v[212:215]
    s_waitcnt lgkmcnt(3)
    v_exp_f32 v121, v121
    v_mfma_f32_16x16x32_bf16 v[208:211], v[64:67], a[148:151], v[208:211]
    v_mfma_f32_16x16x32_bf16 a[232:235], a[240:243], v[80:83], a[232:235]
    v_mfma_f32_16x16x32_bf16 v[224:227], v[64:67], a[152:155], v[224:227]
    v_exp_f32 v122, v122
    v_mfma_f32_16x16x32_bf16 v[228:231], v[72:75], a[152:155], v[228:231]
    ds_read_b128 a[132:135], v21 offset:8192
    v_cvt_pk_bf16_f32 v120, v120, v121
    v_mfma_f32_16x16x32_bf16 v[232:235], v[80:83], a[152:155], v[232:235]
    s_waitcnt lgkmcnt(2)
    v_exp_f32 v123, v123
    v_mfma_f32_16x16x32_bf16 v[236:239], v[88:91], a[152:155], v[236:239]
    v_mfma_f32_16x16x32_bf16 v[252:255], v[88:91], a[156:159], v[252:255]
    v_exp_f32 v100, v100
    v_mfma_f32_16x16x32_bf16 v[248:251], v[80:83], a[156:159], v[248:251]
    ds_read_b128 a[136:139], v22 offset:8192
    v_cvt_pk_bf16_f32 v121, v122, v123
    v_mfma_f32_16x16x32_bf16 v[244:247], v[72:75], a[156:159], v[244:247]
    s_waitcnt lgkmcnt(2)
    v_exp_f32 v101, v101
    v_mfma_f32_16x16x32_bf16 v[240:243], v[64:67], a[156:159], v[240:243]
    v_mfma_f32_16x16x32_bf16 a[236:239], a[240:243], v[88:91], a[236:239]
    v_mfma_f32_16x16x32_bf16 v[64:67], a[128:131], a[0:3], v[48:51]
    v_exp_f32 v102, v102
    v_mfma_f32_16x16x32_bf16 v[72:75], a[128:131], a[4:7], v[52:55]
    ds_read_b128 a[140:143], v23 offset:8192
    v_cvt_pk_bf16_f32 v98, v100, v101
    v_mfma_f32_16x16x32_bf16 v[80:83], a[128:131], a[8:11], v[56:59]
    s_waitcnt lgkmcnt(2)
    v_exp_f32 v103, v103
    v_mfma_f32_16x16x32_bf16 v[88:91], a[128:131], a[12:15], v[60:63]
    v_mfma_f32_16x16x32_bf16 v[64:67], a[132:135], a[32:35], v[64:67]
    v_exp_f32 v108, v108
    v_mfma_f32_16x16x32_bf16 v[72:75], a[132:135], a[36:39], v[72:75]
    ds_read_b128 a[144:147], v20 offset:12288
    v_cvt_pk_bf16_f32 v99, v102, v103
    v_mfma_f32_16x16x32_bf16 v[80:83], a[132:135], a[40:43], v[80:83]
    s_waitcnt lgkmcnt(2)
    v_exp_f32 v109, v109
    v_mfma_f32_16x16x32_bf16 v[88:91], a[132:135], a[44:47], v[88:91]
    v_mfma_f32_16x16x32_bf16 v[64:67], a[136:139], a[64:67], v[64:67]
    v_exp_f32 v110, v110
    v_mfma_f32_16x16x32_bf16 v[72:75], a[136:139], a[68:71], v[72:75]
    ds_read_b128 a[148:151], v21 offset:12288
    v_cvt_pk_bf16_f32 v106, v108, v109
    v_mfma_f32_16x16x32_bf16 v[80:83], a[136:139], a[72:75], v[80:83]
    s_waitcnt lgkmcnt(2)
    v_exp_f32 v111, v111
    v_mfma_f32_16x16x32_bf16 v[88:91], a[136:139], a[76:79], v[88:91]
    v_mfma_f32_16x16x32_bf16 v[64:67], a[140:143], a[96:99], v[64:67]
    v_exp_f32 v116, v116
    v_mfma_f32_16x16x32_bf16 v[72:75], a[140:143], a[100:103], v[72:75]
    ds_read_b128 a[152:155], v22 offset:12288
    ds_read_b64_tr_b16 a[128:129], v24 offset:24576
    v_mfma_f32_16x16x32_bf16 v[80:83], a[140:143], a[104:107], v[80:83]
    s_waitcnt lgkmcnt(3)
    v_exp_f32 v117, v117
    v_mfma_f32_16x16x32_bf16 v[88:91], a[140:143], a[108:111], v[88:91]
    ds_read_b64_tr_b16 a[130:131], v24 offset:28672
    v_cvt_pk_bf16_f32 v107, v110, v111
    v_mfma_f32_16x16x32_bf16 v[68:71], a[144:147], a[0:3], v[48:51]
    v_exp_f32 v118, v118
    v_mfma_f32_16x16x32_bf16 v[76:79], a[144:147], a[4:7], v[52:55]
    ds_read_b128 a[156:159], v23 offset:12288
    ds_read_b64_tr_b16 a[132:133], v25 offset:24576
    v_mfma_f32_16x16x32_bf16 v[84:87], a[144:147], a[8:11], v[56:59]
    s_waitcnt lgkmcnt(5)
    v_exp_f32 v119, v119
    v_mfma_f32_16x16x32_bf16 v[92:95], a[144:147], a[12:15], v[60:63]
    ds_read_b64_tr_b16 a[134:135], v25 offset:28672
    v_cvt_pk_bf16_f32 v114, v116, v117
    v_mfma_f32_16x16x32_bf16 v[68:71], a[148:151], a[32:35], v[68:71]
    v_exp_f32 v124, v124
    v_mfma_f32_16x16x32_bf16 v[76:79], a[148:151], a[36:39], v[76:79]
    ds_read_b64_tr_b16 a[136:137], v26 offset:24576
    v_cvt_pk_bf16_f32 v115, v118, v119
    v_mfma_f32_16x16x32_bf16 v[84:87], a[148:151], a[40:43], v[84:87]
    s_waitcnt lgkmcnt(6)
    v_exp_f32 v125, v125
    v_mfma_f32_16x16x32_bf16 v[92:95], a[148:151], a[44:47], v[92:95]
    ds_read_b64_tr_b16 a[138:139], v26 offset:28672
    v_mfma_f32_16x16x32_bf16 v[68:71], a[152:155], a[64:67], v[68:71]
    v_exp_f32 v126, v126
    v_mfma_f32_16x16x32_bf16 v[76:79], a[152:155], a[68:71], v[76:79]
    ds_read_b64_tr_b16 a[140:141], v27 offset:24576
    v_cvt_pk_bf16_f32 v122, v124, v125
    v_mfma_f32_16x16x32_bf16 v[84:87], a[152:155], a[72:75], v[84:87]
    s_waitcnt lgkmcnt(5)
    v_exp_f32 v127, v127
    v_mfma_f32_16x16x32_bf16 v[92:95], a[152:155], a[76:79], v[92:95]
    ds_read_b64_tr_b16 a[142:143], v27 offset:28672
    v_mfma_f32_16x16x32_bf16 v[68:71], a[156:159], a[96:99], v[68:71]
    v_exp_f32 v64, v64
    v_mfma_f32_16x16x32_bf16 v[76:79], a[156:159], a[100:103], v[76:79]
    ds_read_b64_tr_b16 a[144:145], v28 offset:24576
    v_cvt_pk_bf16_f32 v123, v126, v127
    v_mfma_f32_16x16x32_bf16 v[84:87], a[156:159], a[104:107], v[84:87]
    v_exp_f32 v65, v65
    v_mfma_f32_16x16x32_bf16 v[92:95], a[156:159], a[108:111], v[92:95]
    ds_read_b64_tr_b16 a[146:147], v28 offset:28672
    v_mfma_f32_16x16x32_bf16 v[128:131], v[96:99], a[128:131], v[128:131]
    v_exp_f32 v66, v66
    v_mfma_f32_16x16x32_bf16 v[132:135], v[104:107], a[128:131], v[132:135]
    ds_read_b64_tr_b16 a[148:149], v29 offset:24576
    v_cvt_pk_bf16_f32 v64, v64, v65
    v_mfma_f32_16x16x32_bf16 v[136:139], v[112:115], a[128:131], v[136:139]
    s_waitcnt lgkmcnt(7)
    v_exp_f32 v67, v67
    v_mfma_f32_16x16x32_bf16 v[140:143], v[120:123], a[128:131], v[140:143]
    ds_read_b64_tr_b16 a[150:151], v29 offset:28672
    v_mfma_f32_16x16x32_bf16 v[156:159], v[120:123], a[132:135], v[156:159]
    v_exp_f32 v72, v72
    v_mfma_f32_16x16x32_bf16 v[152:155], v[112:115], a[132:135], v[152:155]
    ds_read_b64_tr_b16 a[152:153], v30 offset:24576
    v_cvt_pk_bf16_f32 v65, v66, v67
    v_mfma_f32_16x16x32_bf16 v[148:151], v[104:107], a[132:135], v[148:151]
    s_waitcnt lgkmcnt(7)
    v_exp_f32 v73, v73
    v_mfma_f32_16x16x32_bf16 v[144:147], v[96:99], a[132:135], v[144:147]
    ds_read_b64_tr_b16 a[154:155], v30 offset:28672
    v_mfma_f32_16x16x32_bf16 a[224:227], a[240:243], v[96:99], a[224:227]
    v_mfma_f32_16x16x32_bf16 v[160:163], v[96:99], a[136:139], v[160:163]
    v_exp_f32 v74, v74
    v_mfma_f32_16x16x32_bf16 v[164:167], v[104:107], a[136:139], v[164:167]
    ds_read_b64_tr_b16 a[156:157], v31 offset:24576
    v_cvt_pk_bf16_f32 v72, v72, v73
    v_mfma_f32_16x16x32_bf16 v[168:171], v[112:115], a[136:139], v[168:171]
    s_waitcnt lgkmcnt(7)
    v_exp_f32 v75, v75
    v_mfma_f32_16x16x32_bf16 v[172:175], v[120:123], a[136:139], v[172:175]
    ds_read_b64_tr_b16 a[158:159], v31 offset:28672
    v_mfma_f32_16x16x32_bf16 v[188:191], v[120:123], a[140:143], v[188:191]
    v_exp_f32 v80, v80
    v_mfma_f32_16x16x32_bf16 v[184:187], v[112:115], a[140:143], v[184:187]
    v_cvt_pk_bf16_f32 v73, v74, v75
    v_mfma_f32_16x16x32_bf16 v[180:183], v[104:107], a[140:143], v[180:183]
    s_waitcnt lgkmcnt(6)
    v_exp_f32 v81, v81
    v_mfma_f32_16x16x32_bf16 v[176:179], v[96:99], a[140:143], v[176:179]
    v_mfma_f32_16x16x32_bf16 a[228:231], a[240:243], v[104:107], a[228:231]
    v_mfma_f32_16x16x32_bf16 v[192:195], v[96:99], a[144:147], v[192:195]
    v_exp_f32 v82, v82
    v_mfma_f32_16x16x32_bf16 v[196:199], v[104:107], a[144:147], v[196:199]
    v_cvt_pk_bf16_f32 v80, v80, v81
    v_mfma_f32_16x16x32_bf16 v[200:203], v[112:115], a[144:147], v[200:203]
    s_waitcnt lgkmcnt(4)
    v_exp_f32 v83, v83
    v_mfma_f32_16x16x32_bf16 v[204:207], v[120:123], a[144:147], v[204:207]
    v_mfma_f32_16x16x32_bf16 v[220:223], v[120:123], a[148:151], v[220:223]
    s_waitcnt vmcnt(0) lgkmcnt(0)
    s_barrier
    s_add_u32 m0, s59, 65536
    v_exp_f32 v88, v88
    v_mfma_f32_16x16x32_bf16 v[216:219], v[112:115], a[148:151], v[216:219]
    ds_read_b128 a[128:131], v20 offset:16384
    v_cvt_pk_bf16_f32 v81, v82, v83
    v_mfma_f32_16x16x32_bf16 v[212:215], v[104:107], a[148:151], v[212:215]
    v_exp_f32 v89, v89
    v_mfma_f32_16x16x32_bf16 v[208:211], v[96:99], a[148:151], v[208:211]
    buffer_load_dwordx4 v32, s[8:11], s62 offen offset:0 lds
    v_mfma_f32_16x16x32_bf16 a[232:235], a[240:243], v[112:115], a[232:235]
    v_mfma_f32_16x16x32_bf16 v[224:227], v[96:99], a[152:155], v[224:227]
    v_exp_f32 v90, v90
    v_mfma_f32_16x16x32_bf16 v[228:231], v[104:107], a[152:155], v[228:231]
    ds_read_b128 a[132:135], v21 offset:16384
    v_cvt_pk_bf16_f32 v88, v88, v89
    v_mfma_f32_16x16x32_bf16 v[232:235], v[112:115], a[152:155], v[232:235]
    s_sub_u32 s61, s61, 1
    v_exp_f32 v91, v91
    v_mfma_f32_16x16x32_bf16 v[236:239], v[120:123], a[152:155], v[236:239]
    buffer_load_dwordx4 v33, s[8:11], s62 offen offset:1024 lds
    v_mfma_f32_16x16x32_bf16 v[252:255], v[120:123], a[156:159], v[252:255]
    v_exp_f32 v68, v68
    v_mfma_f32_16x16x32_bf16 v[248:251], v[112:115], a[156:159], v[248:251]
    ds_read_b128 a[136:139], v22 offset:16384
    v_cvt_pk_bf16_f32 v89, v90, v91
    v_mfma_f32_16x16x32_bf16 v[244:247], v[104:107], a[156:159], v[244:247]
    s_waitcnt lgkmcnt(2)
    v_exp_f32 v69, v69
    v_mfma_f32_16x16x32_bf16 v[240:243], v[96:99], a[156:159], v[240:243]
    buffer_load_dwordx4 v34, s[8:11], s62 offen offset:2048 lds
    v_mfma_f32_16x16x32_bf16 a[236:239], a[240:243], v[120:123], a[236:239]
    s_cmp_lg_u32 s61, 0
    s_cbranch_scc1 L_att_loop
L_tail:
    s_mov_b32 s61, 0
L_pollH:
    v_cmp_ne_u32 vcc, 1, v0
    s_mul_i32 s78, s54, 57344
    s_nop 1
    s_cbranch_vccz L_pollH_done
    s_add_u32 s61, s61, 1
    s_cmp_ge_u32 s61, 50000
    s_cbranch_scc1 L_pollH_done
    s_sleep 4
    buffer_load_ubyte v0, v38, s[40:43], s3 offen sc1
    s_waitcnt vmcnt(0)
    s_branch L_pollH
L_pollH_done:
    v_and_b32 v39, 15, v1
    s_lshl_b32 s55, s54, 4
    v_add_u32 v39, s55, v39
    v_lshlrev_b32 v39, 10, v39
    v_lshrrev_b32 v0, 4, v1
    v_lshl_add_u32 v39, v0, 3, v39
    s_lshl_b32 s55, s77, 7
    v_add_u32 v39, s55, v39
    v_mfma_f32_16x16x32_bf16 v[96:99], a[128:131], a[0:3], v[48:51]
    v_exp_f32 v70, v70
    v_mfma_f32_16x16x32_bf16 v[104:107], a[128:131], a[4:7], v[52:55]
    ds_read_b128 a[140:143], v23 offset:16384
    v_cvt_pk_bf16_f32 v66, v68, v69
    v_mfma_f32_16x16x32_bf16 v[112:115], a[128:131], a[8:11], v[56:59]
    s_waitcnt lgkmcnt(2)
    v_exp_f32 v71, v71
    v_mfma_f32_16x16x32_bf16 v[120:123], a[128:131], a[12:15], v[60:63]
    buffer_load_dwordx4 v35, s[8:11], s62 offen offset:3072 lds
    v_mfma_f32_16x16x32_bf16 v[96:99], a[132:135], a[32:35], v[96:99]
    s_add_u32 m0, s59, 16384
    v_exp_f32 v76, v76
    v_mfma_f32_16x16x32_bf16 v[104:107], a[132:135], a[36:39], v[104:107]
    ds_read_b128 a[144:147], v20 offset:20480
    v_cvt_pk_bf16_f32 v67, v70, v71
    v_mfma_f32_16x16x32_bf16 v[112:115], a[132:135], a[40:43], v[112:115]
    s_waitcnt lgkmcnt(2)
    v_exp_f32 v77, v77
    v_mfma_f32_16x16x32_bf16 v[120:123], a[132:135], a[44:47], v[120:123]
    buffer_load_dwordx4 v36, s[12:15], s63 offen offset:0 lds
    v_mfma_f32_16x16x32_bf16 v[96:99], a[136:139], a[64:67], v[96:99]
    v_exp_f32 v78, v78
    v_mfma_f32_16x16x32_bf16 v[104:107], a[136:139], a[68:71], v[104:107]
    ds_read_b128 a[148:151], v21 offset:20480
    v_cvt_pk_bf16_f32 v74, v76, v77
    v_mfma_f32_16x16x32_bf16 v[112:115], a[136:139], a[72:75], v[112:115]
    s_waitcnt lgkmcnt(2)
    v_exp_f32 v79, v79
    v_mfma_f32_16x16x32_bf16 v[120:123], a[136:139], a[76:79], v[120:123]
    buffer_load_dwordx4 v37, s[12:15], s63 offen offset:1024 lds
    v_mfma_f32_16x16x32_bf16 v[96:99], a[140:143], a[96:99], v[96:99]
    v_exp_f32 v84, v84
    v_mfma_f32_16x16x32_bf16 v[104:107], a[140:143], a[100:103], v[104:107]
    ds_read_b128 a[152:155], v22 offset:20480
    v_cvt_pk_bf16_f32 v75, v78, v79
    v_mfma_f32_16x16x32_bf16 v[112:115], a[140:143], a[104:107], v[112:115]
    s_waitcnt lgkmcnt(2)
    v_exp_f32 v85, v85
    v_mfma_f32_16x16x32_bf16 v[120:123], a[140:143], a[108:111], v[120:123]
    buffer_load_dwordx4 v36, s[12:15], s63 offen offset:2048 lds
    v_mfma_f32_16x16x32_bf16 v[100:103], a[144:147], a[0:3], v[48:51]
    v_exp_f32 v86, v86
    v_mfma_f32_16x16x32_bf16 v[108:111], a[144:147], a[4:7], v[52:55]
    ds_read_b128 a[156:159], v23 offset:20480
    v_cvt_pk_bf16_f32 v82, v84, v85
    v_mfma_f32_16x16x32_bf16 v[116:119], a[144:147], a[8:11], v[56:59]
    s_waitcnt lgkmcnt(2)
    v_exp_f32 v87, v87
    v_mfma_f32_16x16x32_bf16 v[124:127], a[144:147], a[12:15], v[60:63]
    buffer_load_dwordx4 v37, s[12:15], s63 offen offset:3072 lds
    v_mfma_f32_16x16x32_bf16 v[100:103], a[148:151], a[32:35], v[100:103]
    s_add_u32 s67, s78, 0
    v_exp_f32 v92, v92
    v_mfma_f32_16x16x32_bf16 v[108:111], a[148:151], a[36:39], v[108:111]
    ds_read_b64_tr_b16 a[128:129], v24 offset:0
    ds_read_b64_tr_b16 a[130:131], v24 offset:4096
    v_mfma_f32_16x16x32_bf16 v[116:119], a[148:151], a[40:43], v[116:119]
    s_waitcnt lgkmcnt(3)
    v_exp_f32 v93, v93
    v_mfma_f32_16x16x32_bf16 v[124:127], a[148:151], a[44:47], v[124:127]
    buffer_load_dwordx4 a[16:19], v2, s[80:83], s67 offen offset:0 sc1
    v_cvt_pk_bf16_f32 v83, v86, v87
    v_mfma_f32_16x16x32_bf16 v[100:103], a[152:155], a[64:67], v[100:103]
    s_sub_u32 m0, s59, 65536
    s_mov_b32 s60, 0
    s_add_u32 s62, s62, 16384
    v_exp_f32 v94, v94
    v_mfma_f32_16x16x32_bf16 v[108:111], a[152:155], a[68:71], v[108:111]
    ds_read_b64_tr_b16 a[132:133], v25 offset:0
    ds_read_b64_tr_b16 a[134:135], v25 offset:4096
    v_mfma_f32_16x16x32_bf16 v[116:119], a[152:155], a[72:75], v[116:119]
    s_waitcnt lgkmcnt(4)
    v_exp_f32 v95, v95
    v_mfma_f32_16x16x32_bf16 v[124:127], a[152:155], a[76:79], v[124:127]
    buffer_load_dwordx4 v12, s[32:35], s60 offen offset:0 lds
    v_cvt_pk_bf16_f32 v90, v92, v93
    v_mfma_f32_16x16x32_bf16 v[100:103], a[156:159], a[96:99], v[100:103]
    s_add_u32 s63, s63, 16384
    v_exp_f32 v96, v96
    v_mfma_f32_16x16x32_bf16 v[108:111], a[156:159], a[100:103], v[108:111]
    ds_read_b64_tr_b16 a[136:137], v26 offset:0
    ds_read_b64_tr_b16 a[138:139], v26 offset:4096
    v_mfma_f32_16x16x32_bf16 v[116:119], a[156:159], a[104:107], v[116:119]
    s_waitcnt lgkmcnt(4)
    v_exp_f32 v97, v97
    v_mfma_f32_16x16x32_bf16 v[124:127], a[156:159], a[108:111], v[124:127]
    buffer_load_dwordx4 v13, s[32:35], s60 offen offset:1024 lds
    v_cvt_pk_bf16_f32 v91, v94, v95
    v_mfma_f32_16x16x32_bf16 v[128:131], v[64:67], a[128:131], v[128:131]
    v_exp_f32 v98, v98
    v_mfma_f32_16x16x32_bf16 v[132:135], v[72:75], a[128:131], v[132:135]
    ds_read_b64_tr_b16 a[140:141], v27 offset:0
    ds_read_b64_tr_b16 a[142:143], v27 offset:4096
    v_mfma_f32_16x16x32_bf16 v[136:139], v[80:83], a[128:131], v[136:139]
    s_waitcnt lgkmcnt(4)
    v_exp_f32 v99, v99
    v_mfma_f32_16x16x32_bf16 v[140:143], v[88:91], a[128:131], v[140:143]
    buffer_load_dwordx4 v14, s[32:35], s60 offen offset:2048 lds
    v_cvt_pk_bf16_f32 v96, v96, v97
    v_mfma_f32_16x16x32_bf16 v[156:159], v[88:91], a[132:135], v[156:159]
    v_exp_f32 v104, v104
    v_mfma_f32_16x16x32_bf16 v[152:155], v[80:83], a[132:135], v[152:155]
    ds_read_b64_tr_b16 a[144:145], v28 offset:0
    ds_read_b64_tr_b16 a[146:147], v28 offset:4096
    v_mfma_f32_16x16x32_bf16 v[148:151], v[72:75], a[132:135], v[148:151]
    s_waitcnt lgkmcnt(4)
    v_exp_f32 v105, v105
    v_mfma_f32_16x16x32_bf16 v[144:147], v[64:67], a[132:135], v[144:147]
    buffer_load_dwordx4 a[20:23], v2, s[80:83], s67 offen offset:1024 sc1
    v_cvt_pk_bf16_f32 v97, v98, v99
    v_mfma_f32_16x16x32_bf16 a[224:227], a[240:243], v[64:67], a[224:227]
    v_mfma_f32_16x16x32_bf16 v[160:163], v[64:67], a[136:139], v[160:163]
    v_exp_f32 v106, v106
    v_mfma_f32_16x16x32_bf16 v[164:167], v[72:75], a[136:139], v[164:167]
    ds_read_b64_tr_b16 a[148:149], v29 offset:0
    ds_read_b64_tr_b16 a[150:151], v29 offset:4096
    v_mfma_f32_16x16x32_bf16 v[168:171], v[80:83], a[136:139], v[168:171]
    s_waitcnt lgkmcnt(4)
    v_exp_f32 v107, v107
    v_mfma_f32_16x16x32_bf16 v[172:175], v[88:91], a[136:139], v[172:175]
    buffer_load_dwordx4 v15, s[32:35], s60 offen offset:3072 lds
    v_cvt_pk_bf16_f32 v104, v104, v105
    v_mfma_f32_16x16x32_bf16 v[188:191], v[88:91], a[140:143], v[188:191]
    v_exp_f32 v112, v112
    v_mfma_f32_16x16x32_bf16 v[184:187], v[80:83], a[140:143], v[184:187]
    ds_read_b64_tr_b16 a[152:153], v30 offset:0
    ds_read_b64_tr_b16 a[154:155], v30 offset:4096
    v_mfma_f32_16x16x32_bf16 v[180:183], v[72:75], a[140:143], v[180:183]
    s_waitcnt lgkmcnt(4)
    v_exp_f32 v113, v113
    v_mfma_f32_16x16x32_bf16 v[176:179], v[64:67], a[140:143], v[176:179]
    buffer_load_dwordx4 a[24:27], v2, s[80:83], s67 offen offset:2048 sc1
    v_cvt_pk_bf16_f32 v105, v106, v107
    v_mfma_f32_16x16x32_bf16 a[228:231], a[240:243], v[72:75], a[228:231]
    v_mfma_f32_16x16x32_bf16 v[192:195], v[64:67], a[144:147], v[192:195]
    s_sub_u32 m0, s59, 49152
    s_mov_b32 s60, 32768
    v_exp_f32 v114, v114
    v_mfma_f32_16x16x32_bf16 v[196:199], v[72:75], a[144:147], v[196:199]
    ds_read_b64_tr_b16 a[156:157], v31 offset:0
    ds_read_b64_tr_b16 a[158:159], v31 offset:4096
    v_mfma_f32_16x16x32_bf16 v[200:203], v[80:83], a[144:147], v[200:203]
    s_waitcnt lgkmcnt(4)
    v_exp_f32 v115, v115
    v_mfma_f32_16x16x32_bf16 v[204:207], v[88:91], a[144:147], v[204:207]
    buffer_load_dwordx4 v12, s[32:35], s60 offen offset:0 lds
    v_cvt_pk_bf16_f32 v112, v112, v113
    v_mfma_f32_16x16x32_bf16 v[220:223], v[88:91], a[148:151], v[220:223]
    v_exp_f32 v120, v120
    v_mfma_f32_16x16x32_bf16 v[216:219], v[80:83], a[148:151], v[216:219]
    ds_read_b128 a[128:131], v20 offset:24576
    v_cvt_pk_bf16_f32 v113, v114, v115
    v_mfma_f32_16x16x32_bf16 v[212:215], v[72:75], a[148:151], v[212:215]
    s_waitcnt lgkmcnt(3)
    v_exp_f32 v121, v121
    v_mfma_f32_16x16x32_bf16 v[208:211], v[64:67], a[148:151], v[208:211]
    buffer_load_dwordx4 a[28:31], v2, s[80:83], s67 offen offset:3072 sc1
    v_mfma_f32_16x16x32_bf16 a[232:235], a[240:243], v[80:83], a[232:235]
    v_mfma_f32_16x16x32_bf16 v[224:227], v[64:67], a[152:155], v[224:227]
    s_add_u32 s67, s78, 4096
    v_exp_f32 v122, v122
    v_mfma_f32_16x16x32_bf16 v[228:231], v[72:75], a[152:155], v[228:231]
    ds_read_b128 a[132:135], v21 offset:24576
    v_cvt_pk_bf16_f32 v120, v120, v121
    v_mfma_f32_16x16x32_bf16 v[232:235], v[80:83], a[152:155], v[232:235]
    s_waitcnt lgkmcnt(2)
    v_exp_f32 v123, v123
    v_mfma_f32_16x16x32_bf16 v[236:239], v[88:91], a[152:155], v[236:239]
    buffer_load_dwordx4 a[48:51], v2, s[80:83], s67 offen offset:0 sc1
    v_mfma_f32_16x16x32_bf16 v[252:255], v[88:91], a[156:159], v[252:255]
    v_exp_f32 v100, v100
    v_mfma_f32_16x16x32_bf16 v[248:251], v[80:83], a[156:159], v[248:251]
    ds_read_b128 a[136:139], v22 offset:24576
    v_cvt_pk_bf16_f32 v121, v122, v123
    v_mfma_f32_16x16x32_bf16 v[244:247], v[72:75], a[156:159], v[244:247]
    s_waitcnt lgkmcnt(2)
    v_exp_f32 v101, v101
    v_mfma_f32_16x16x32_bf16 v[240:243], v[64:67], a[156:159], v[240:243]
    buffer_load_dwordx4 a[52:55], v2, s[80:83], s67 offen offset:1024 sc1
    v_mfma_f32_16x16x32_bf16 a[236:239], a[240:243], v[88:91], a[236:239]
    v_mfma_f32_16x16x32_bf16 v[64:67], a[128:131], a[0:3], v[48:51]
    v_exp_f32 v102, v102
    v_mfma_f32_16x16x32_bf16 v[72:75], a[128:131], a[4:7], v[52:55]
    ds_read_b128 a[140:143], v23 offset:24576
    v_cvt_pk_bf16_f32 v98, v100, v101
    v_mfma_f32_16x16x32_bf16 v[80:83], a[128:131], a[8:11], v[56:59]
    s_waitcnt lgkmcnt(2)
    v_exp_f32 v103, v103
    v_mfma_f32_16x16x32_bf16 v[88:91], a[128:131], a[12:15], v[60:63]
    buffer_load_dwordx4 a[56:59], v2, s[80:83], s67 offen offset:2048 sc1
    v_mfma_f32_16x16x32_bf16 v[64:67], a[132:135], a[32:35], v[64:67]
    v_exp_f32 v108, v108
    v_mfma_f32_16x16x32_bf16 v[72:75], a[132:135], a[36:39], v[72:75]
    ds_read_b128 a[144:147], v20 offset:28672
    v_cvt_pk_bf16_f32 v99, v102, v103
    v_mfma_f32_16x16x32_bf16 v[80:83], a[132:135], a[40:43], v[80:83]
    s_waitcnt lgkmcnt(2)
    v_exp_f32 v109, v109
    v_mfma_f32_16x16x32_bf16 v[88:91], a[132:135], a[44:47], v[88:91]
    buffer_load_dwordx4 a[60:63], v2, s[80:83], s67 offen offset:3072 sc1
    v_mfma_f32_16x16x32_bf16 v[64:67], a[136:139], a[64:67], v[64:67]
    s_add_u32 s67, s78, 8192
    v_exp_f32 v110, v110
    v_mfma_f32_16x16x32_bf16 v[72:75], a[136:139], a[68:71], v[72:75]
    ds_read_b128 a[148:151], v21 offset:28672
    v_cvt_pk_bf16_f32 v106, v108, v109
    v_mfma_f32_16x16x32_bf16 v[80:83], a[136:139], a[72:75], v[80:83]
    s_waitcnt lgkmcnt(2)
    v_exp_f32 v111, v111
    v_mfma_f32_16x16x32_bf16 v[88:91], a[136:139], a[76:79], v[88:91]
    buffer_load_dwordx4 a[80:83], v2, s[80:83], s67 offen offset:0 sc1
    v_mfma_f32_16x16x32_bf16 v[64:67], a[140:143], a[96:99], v[64:67]
    v_exp_f32 v116, v116
    v_mfma_f32_16x16x32_bf16 v[72:75], a[140:143], a[100:103], v[72:75]
    ds_read_b128 a[152:155], v22 offset:28672
    ds_read_b64_tr_b16 a[128:129], v24 offset:8192
    v_mfma_f32_16x16x32_bf16 v[80:83], a[140:143], a[104:107], v[80:83]
    s_waitcnt lgkmcnt(3)
    v_exp_f32 v117, v117
    v_mfma_f32_16x16x32_bf16 v[88:91], a[140:143], a[108:111], v[88:91]
    ds_read_b64_tr_b16 a[130:131], v24 offset:12288
    v_cvt_pk_bf16_f32 v107, v110, v111
    v_mfma_f32_16x16x32_bf16 v[68:71], a[144:147], a[0:3], v[48:51]
    v_exp_f32 v118, v118
    v_mfma_f32_16x16x32_bf16 v[76:79], a[144:147], a[4:7], v[52:55]
    ds_read_b128 a[156:159], v23 offset:28672
    ds_read_b64_tr_b16 a[132:133], v25 offset:8192
    v_mfma_f32_16x16x32_bf16 v[84:87], a[144:147], a[8:11], v[56:59]
    s_waitcnt lgkmcnt(5)
    v_exp_f32 v119, v119
    v_mfma_f32_16x16x32_bf16 v[92:95], a[144:147], a[12:15], v[60:63]
    ds_read_b64_tr_b16 a[134:135], v25 offset:12288
    v_cvt_pk_bf16_f32 v114, v116, v117
    v_mfma_f32_16x16x32_bf16 v[68:71], a[148:151], a[32:35], v[68:71]
    v_exp_f32 v124, v124
    v_mfma_f32_16x16x32_bf16 v[76:79], a[148:151], a[36:39], v[76:79]
    ds_read_b64_tr_b16 a[136:137], v26 offset:8192
    ds_read_b64_tr_b16 a[138:139], v26 offset:12288
    v_mfma_f32_16x16x32_bf16 v[84:87], a[148:151], a[40:43], v[84:87]
    s_waitcnt lgkmcnt(7)
    v_exp_f32 v125, v125
    v_mfma_f32_16x16x32_bf16 v[92:95], a[148:151], a[44:47], v[92:95]
    buffer_load_dwordx4 v13, s[32:35], s60 offen offset:1024 lds
    v_cvt_pk_bf16_f32 v115, v118, v119
    v_mfma_f32_16x16x32_bf16 v[68:71], a[152:155], a[64:67], v[68:71]
    v_exp_f32 v126, v126
    v_mfma_f32_16x16x32_bf16 v[76:79], a[152:155], a[68:71], v[76:79]
    ds_read_b64_tr_b16 a[140:141], v27 offset:8192
    ds_read_b64_tr_b16 a[142:143], v27 offset:12288
    v_mfma_f32_16x16x32_bf16 v[84:87], a[152:155], a[72:75], v[84:87]
    s_waitcnt lgkmcnt(6)
    v_exp_f32 v127, v127
    v_mfma_f32_16x16x32_bf16 v[92:95], a[152:155], a[76:79], v[92:95]
    buffer_load_dwordx4 v14, s[32:35], s60 offen offset:2048 lds
    v_cvt_pk_bf16_f32 v122, v124, v125
    v_mfma_f32_16x16x32_bf16 v[68:71], a[156:159], a[96:99], v[68:71]
    v_exp_f32 v64, v64
    v_mfma_f32_16x16x32_bf16 v[76:79], a[156:159], a[100:103], v[76:79]
    ds_read_b64_tr_b16 a[144:145], v28 offset:8192
    ds_read_b64_tr_b16 a[146:147], v28 offset:12288
    v_mfma_f32_16x16x32_bf16 v[84:87], a[156:159], a[104:107], v[84:87]
    v_exp_f32 v65, v65
    v_mfma_f32_16x16x32_bf16 v[92:95], a[156:159], a[108:111], v[92:95]
    buffer_load_dwordx4 v15, s[32:35], s60 offen offset:3072 lds
    v_cvt_pk_bf16_f32 v123, v126, v127
    v_mfma_f32_16x16x32_bf16 v[128:131], v[96:99], a[128:131], v[128:131]
    v_exp_f32 v66, v66
    v_mfma_f32_16x16x32_bf16 v[132:135], v[104:107], a[128:131], v[132:135]
    ds_read_b64_tr_b16 a[148:149], v29 offset:8192
    v_cvt_pk_bf16_f32 v64, v64, v65
    v_mfma_f32_16x16x32_bf16 v[136:139], v[112:115], a[128:131], v[136:139]
    s_waitcnt lgkmcnt(7)
    v_exp_f32 v67, v67
    v_mfma_f32_16x16x32_bf16 v[140:143], v[120:123], a[128:131], v[140:143]
    ds_read_b64_tr_b16 a[150:151], v29 offset:12288
    v_mfma_f32_16x16x32_bf16 v[156:159], v[120:123], a[132:135], v[156:159]
    v_exp_f32 v72, v72
    v_mfma_f32_16x16x32_bf16 v[152:155], v[112:115], a[132:135], v[152:155]
    ds_read_b64_tr_b16 a[152:153], v30 offset:8192
    v_cvt_pk_bf16_f32 v65, v66, v67
    v_mfma_f32_16x16x32_bf16 v[148:151], v[104:107], a[132:135], v[148:151]
    s_waitcnt lgkmcnt(7)
    v_exp_f32 v73, v73
    v_mfma_f32_16x16x32_bf16 v[144:147], v[96:99], a[132:135], v[144:147]
    ds_read_b64_tr_b16 a[154:155], v30 offset:12288
    v_mfma_f32_16x16x32_bf16 a[224:227], a[240:243], v[96:99], a[224:227]
    v_mfma_f32_16x16x32_bf16 v[160:163], v[96:99], a[136:139], v[160:163]
    v_exp_f32 v74, v74
    v_mfma_f32_16x16x32_bf16 v[164:167], v[104:107], a[136:139], v[164:167]
    ds_read_b64_tr_b16 a[156:157], v31 offset:8192
    v_cvt_pk_bf16_f32 v72, v72, v73
    v_mfma_f32_16x16x32_bf16 v[168:171], v[112:115], a[136:139], v[168:171]
    s_waitcnt lgkmcnt(7)
    v_exp_f32 v75, v75
    v_mfma_f32_16x16x32_bf16 v[172:175], v[120:123], a[136:139], v[172:175]
    ds_read_b64_tr_b16 a[158:159], v31 offset:12288
    v_mfma_f32_16x16x32_bf16 v[188:191], v[120:123], a[140:143], v[188:191]
    v_exp_f32 v80, v80
    v_mfma_f32_16x16x32_bf16 v[184:187], v[112:115], a[140:143], v[184:187]
    buffer_load_dwordx4 a[84:87], v2, s[80:83], s67 offen offset:1024 sc1
    v_cvt_pk_bf16_f32 v73, v74, v75
    v_mfma_f32_16x16x32_bf16 v[180:183], v[104:107], a[140:143], v[180:183]
    s_waitcnt lgkmcnt(6)
    v_exp_f32 v81, v81
    v_mfma_f32_16x16x32_bf16 v[176:179], v[96:99], a[140:143], v[176:179]
    v_mfma_f32_16x16x32_bf16 a[228:231], a[240:243], v[104:107], a[228:231]
    v_mfma_f32_16x16x32_bf16 v[192:195], v[96:99], a[144:147], v[192:195]
    v_exp_f32 v82, v82
    v_mfma_f32_16x16x32_bf16 v[196:199], v[104:107], a[144:147], v[196:199]
    buffer_load_dwordx4 a[88:91], v2, s[80:83], s67 offen offset:2048 sc1
    v_cvt_pk_bf16_f32 v80, v80, v81
    v_mfma_f32_16x16x32_bf16 v[200:203], v[112:115], a[144:147], v[200:203]
    s_waitcnt lgkmcnt(4)
    v_exp_f32 v83, v83
    v_mfma_f32_16x16x32_bf16 v[204:207], v[120:123], a[144:147], v[204:207]
    v_mfma_f32_16x16x32_bf16 v[220:223], v[120:123], a[148:151], v[220:223]
    s_waitcnt vmcnt(19) lgkmcnt(0)
    s_barrier
    s_add_u32 m0, s59, 81920
    v_exp_f32 v88, v88
    v_mfma_f32_16x16x32_bf16 v[216:219], v[112:115], a[148:151], v[216:219]
    ds_read_b128 a[128:131], v20 offset:0
    v_cvt_pk_bf16_f32 v81, v82, v83
    v_mfma_f32_16x16x32_bf16 v[212:215], v[104:107], a[148:151], v[212:215]
    v_exp_f32 v89, v89
    v_mfma_f32_16x16x32_bf16 v[208:211], v[96:99], a[148:151], v[208:211]
    buffer_load_dwordx4 v32, s[8:11], s62 offen offset:0 lds
    v_mfma_f32_16x16x32_bf16 a[232:235], a[240:243], v[112:115], a[232:235]
    v_mfma_f32_16x16x32_bf16 v[224:227], v[96:99], a[152:155], v[224:227]
    v_exp_f32 v90, v90
    v_mfma_f32_16x16x32_bf16 v[228:231], v[104:107], a[152:155], v[228:231]
    ds_read_b128 a[132:135], v21 offset:0
    v_cvt_pk_bf16_f32 v88, v88, v89
    v_mfma_f32_16x16x32_bf16 v[232:235], v[112:115], a[152:155], v[232:235]
    v_exp_f32 v91, v91
    v_mfma_f32_16x16x32_bf16 v[236:239], v[120:123], a[152:155], v[236:239]
    buffer_load_dwordx4 v33, s[8:11], s62 offen offset:1024 lds
    v_mfma_f32_16x16x32_bf16 v[252:255], v[120:123], a[156:159], v[252:255]
    v_exp_f32 v68, v68
    v_mfma_f32_16x16x32_bf16 v[248:251], v[112:115], a[156:159], v[248:251]
    ds_read_b128 a[136:139], v22 offset:0
    v_cvt_pk_bf16_f32 v89, v90, v91
    v_mfma_f32_16x16x32_bf16 v[244:247], v[104:107], a[156:159], v[244:247]
    s_waitcnt lgkmcnt(2)
    v_exp_f32 v69, v69
    v_mfma_f32_16x16x32_bf16 v[240:243], v[96:99], a[156:159], v[240:243]
    buffer_load_dwordx4 v34, s[8:11], s62 offen offset:2048 lds
    v_mfma_f32_16x16x32_bf16 a[236:239], a[240:243], v[120:123], a[236:239]
    v_mfma_f32_16x16x32_bf16 v[96:99], a[128:131], a[0:3], v[48:51]
    v_exp_f32 v70, v70
    v_mfma_f32_16x16x32_bf16 v[104:107], a[128:131], a[4:7], v[52:55]
    ds_read_b128 a[140:143], v23 offset:0
    v_cvt_pk_bf16_f32 v66, v68, v69
    v_mfma_f32_16x16x32_bf16 v[112:115], a[128:131], a[8:11], v[56:59]
    s_waitcnt lgkmcnt(2)
    v_exp_f32 v71, v71
    v_mfma_f32_16x16x32_bf16 v[120:123], a[128:131], a[12:15], v[60:63]
    buffer_load_dwordx4 v35, s[8:11], s62 offen offset:3072 lds
    v_mfma_f32_16x16x32_bf16 v[96:99], a[132:135], a[32:35], v[96:99]
    s_add_u32 m0, s59, 0
    v_exp_f32 v76, v76
    v_mfma_f32_16x16x32_bf16 v[104:107], a[132:135], a[36:39], v[104:107]
    ds_read_b128 a[144:147], v20 offset:4096
    v_cvt_pk_bf16_f32 v67, v70, v71
    v_mfma_f32_16x16x32_bf16 v[112:115], a[132:135], a[40:43], v[112:115]
    s_waitcnt lgkmcnt(2)
    v_exp_f32 v77, v77
    v_mfma_f32_16x16x32_bf16 v[120:123], a[132:135], a[44:47], v[120:123]
    buffer_load_dwordx4 v36, s[12:15], s63 offen offset:0 lds
    v_mfma_f32_16x16x32_bf16 v[96:99], a[136:139], a[64:67], v[96:99]
    v_exp_f32 v78, v78
    v_mfma_f32_16x16x32_bf16 v[104:107], a[136:139], a[68:71], v[104:107]
    ds_read_b128 a[148:151], v21 offset:4096
    v_cvt_pk_bf16_f32 v74, v76, v77
    v_mfma_f32_16x16x32_bf16 v[112:115], a[136:139], a[72:75], v[112:115]
    s_waitcnt lgkmcnt(2)
    v_exp_f32 v79, v79
    v_mfma_f32_16x16x32_bf16 v[120:123], a[136:139], a[76:79], v[120:123]
    buffer_load_dwordx4 v37, s[12:15], s63 offen offset:1024 lds
    v_mfma_f32_16x16x32_bf16 v[96:99], a[140:143], a[96:99], v[96:99]
    v_exp_f32 v84, v84
    v_mfma_f32_16x16x32_bf16 v[104:107], a[140:143], a[100:103], v[104:107]
    ds_read_b128 a[152:155], v22 offset:4096
    v_cvt_pk_bf16_f32 v75, v78, v79
    v_mfma_f32_16x16x32_bf16 v[112:115], a[140:143], a[104:107], v[112:115]
    s_waitcnt lgkmcnt(2)
    v_exp_f32 v85, v85
    v_mfma_f32_16x16x32_bf16 v[120:123], a[140:143], a[108:111], v[120:123]
    buffer_load_dwordx4 v36, s[12:15], s63 offen offset:2048 lds
    v_mfma_f32_16x16x32_bf16 v[100:103], a[144:147], a[0:3], v[48:51]
    v_exp_f32 v86, v86
    v_mfma_f32_16x16x32_bf16 v[108:111], a[144:147], a[4:7], v[52:55]
    ds_read_b128 a[156:159], v23 offset:4096
    v_cvt_pk_bf16_f32 v82, v84, v85
    v_mfma_f32_16x16x32_bf16 v[116:119], a[144:147], a[8:11], v[56:59]
    s_waitcnt lgkmcnt(2)
    v_exp_f32 v87, v87
    v_mfma_f32_16x16x32_bf16 v[124:127], a[144:147], a[12:15], v[60:63]
    buffer_load_dwordx4 v37, s[12:15], s63 offen offset:3072 lds
    v_mfma_f32_16x16x32_bf16 v[100:103], a[148:151], a[32:35], v[100:103]
    v_exp_f32 v92, v92
    v_mfma_f32_16x16x32_bf16 v[108:111], a[148:151], a[36:39], v[108:111]
    ds_read_b64_tr_b16 a[128:129], v24 offset:16384
    ds_read_b64_tr_b16 a[130:131], v24 offset:20480
    v_mfma_f32_16x16x32_bf16 v[116:119], a[148:151], a[40:43], v[116:119]
    s_waitcnt lgkmcnt(3)
    v_exp_f32 v93, v93
    v_mfma_f32_16x16x32_bf16 v[124:127], a[148:151], a[44:47], v[124:127]
    buffer_load_dwordx4 a[92:95], v2, s[80:83], s67 offen offset:3072 sc1
    v_cvt_pk_bf16_f32 v83, v86, v87
    v_mfma_f32_16x16x32_bf16 v[100:103], a[152:155], a[64:67], v[100:103]
    s_sub_u32 m0, s59, 32768
    s_mov_b32 s60, 65536
    s_add_u32 s62, s62, 16384
    v_exp_f32 v94, v94
    v_mfma_f32_16x16x32_bf16 v[108:111], a[152:155], a[68:71], v[108:111]
    ds_read_b64_tr_b16 a[132:133], v25 offset:16384
    ds_read_b64_tr_b16 a[134:135], v25 offset:20480
    v_mfma_f32_16x16x32_bf16 v[116:119], a[152:155], a[72:75], v[116:119]
    s_waitcnt lgkmcnt(4)
    v_exp_f32 v95, v95
    v_mfma_f32_16x16x32_bf16 v[124:127], a[152:155], a[76:79], v[124:127]
    buffer_load_dwordx4 v12, s[32:35], s60 offen offset:0 lds
    v_cvt_pk_bf16_f32 v90, v92, v93
    v_mfma_f32_16x16x32_bf16 v[100:103], a[156:159], a[96:99], v[100:103]
    s_add_u32 s63, s63, 16384
    v_exp_f32 v96, v96
    v_mfma_f32_16x16x32_bf16 v[108:111], a[156:159], a[100:103], v[108:111]
    ds_read_b64_tr_b16 a[136:137], v26 offset:16384
    ds_read_b64_tr_b16 a[138:139], v26 offset:20480
    v_mfma_f32_16x16x32_bf16 v[116:119], a[156:159], a[104:107], v[116:119]
    s_waitcnt lgkmcnt(4)
    v_exp_f32 v97, v97
    v_mfma_f32_16x16x32_bf16 v[124:127], a[156:159], a[108:111], v[124:127]
    buffer_load_dwordx4 v13, s[32:35], s60 offen offset:1024 lds
    v_cvt_pk_bf16_f32 v91, v94, v95
    v_mfma_f32_16x16x32_bf16 v[128:131], v[64:67], a[128:131], v[128:131]
    v_exp_f32 v98, v98
    v_mfma_f32_16x16x32_bf16 v[132:135], v[72:75], a[128:131], v[132:135]
    ds_read_b64_tr_b16 a[140:141], v27 offset:16384
    ds_read_b64_tr_b16 a[142:143], v27 offset:20480
    v_mfma_f32_16x16x32_bf16 v[136:139], v[80:83], a[128:131], v[136:139]
    s_waitcnt lgkmcnt(4)
    v_exp_f32 v99, v99
    v_mfma_f32_16x16x32_bf16 v[140:143], v[88:91], a[128:131], v[140:143]
    buffer_load_dwordx4 v14, s[32:35], s60 offen offset:2048 lds
    v_cvt_pk_bf16_f32 v96, v96, v97
    v_mfma_f32_16x16x32_bf16 v[156:159], v[88:91], a[132:135], v[156:159]
    s_add_u32 s67, s78, 12288
    v_exp_f32 v104, v104
    v_mfma_f32_16x16x32_bf16 v[152:155], v[80:83], a[132:135], v[152:155]
    ds_read_b64_tr_b16 a[144:145], v28 offset:16384
    ds_read_b64_tr_b16 a[146:147], v28 offset:20480
    v_mfma_f32_16x16x32_bf16 v[148:151], v[72:75], a[132:135], v[148:151]
    s_waitcnt lgkmcnt(4)
    v_exp_f32 v105, v105
    v_mfma_f32_16x16x32_bf16 v[144:147], v[64:67], a[132:135], v[144:147]
    buffer_load_dwordx4 a[112:115], v2, s[80:83], s67 offen offset:0 sc1
    v_cvt_pk_bf16_f32 v97, v98, v99
    v_mfma_f32_16x16x32_bf16 a[224:227], a[240:243], v[64:67], a[224:227]
    v_mfma_f32_16x16x32_bf16 v[160:163], v[64:67], a[136:139], v[160:163]
    v_exp_f32 v106, v106
    v_mfma_f32_16x16x32_bf16 v[164:167], v[72:75], a[136:139], v[164:167]
    ds_read_b64_tr_b16 a[148:149], v29 offset:16384
    ds_read_b64_tr_b16 a[150:151], v29 offset:20480
    v_mfma_f32_16x16x32_bf16 v[168:171], v[80:83], a[136:139], v[168:171]
    s_waitcnt lgkmcnt(4)
    v_exp_f32 v107, v107
    v_mfma_f32_16x16x32_bf16 v[172:175], v[88:91], a[136:139], v[172:175]
    buffer_load_dwordx4 v15, s[32:35], s60 offen offset:3072 lds
    v_cvt_pk_bf16_f32 v104, v104, v105
    v_mfma_f32_16x16x32_bf16 v[188:191], v[88:91], a[140:143], v[188:191]
    v_exp_f32 v112, v112
    v_mfma_f32_16x16x32_bf16 v[184:187], v[80:83], a[140:143], v[184:187]
    ds_read_b64_tr_b16 a[152:153], v30 offset:16384
    ds_read_b64_tr_b16 a[154:155], v30 offset:20480
    v_mfma_f32_16x16x32_bf16 v[180:183], v[72:75], a[140:143], v[180:183]
    s_waitcnt lgkmcnt(4)
    v_exp_f32 v113, v113
    v_mfma_f32_16x16x32_bf16 v[176:179], v[64:67], a[140:143], v[176:179]
    buffer_load_dwordx4 a[116:119], v2, s[80:83], s67 offen offset:1024 sc1
    v_cvt_pk_bf16_f32 v105, v106, v107
    v_mfma_f32_16x16x32_bf16 a[228:231], a[240:243], v[72:75], a[228:231]
    v_mfma_f32_16x16x32_bf16 v[192:195], v[64:67], a[144:147], v[192:195]
    s_sub_u32 m0, s59, 16384
    s_mov_b32 s60, 98304
    v_exp_f32 v114, v114
    v_mfma_f32_16x16x32_bf16 v[196:199], v[72:75], a[144:147], v[196:199]
    ds_read_b64_tr_b16 a[156:157], v31 offset:16384
    ds_read_b64_tr_b16 a[158:159], v31 offset:20480
    v_mfma_f32_16x16x32_bf16 v[200:203], v[80:83], a[144:147], v[200:203]
    s_waitcnt lgkmcnt(4)
    v_exp_f32 v115, v115
    v_mfma_f32_16x16x32_bf16 v[204:207], v[88:91], a[144:147], v[204:207]
    buffer_load_dwordx4 v12, s[32:35], s60 offen offset:0 lds
    v_cvt_pk_bf16_f32 v112, v112, v113
    v_mfma_f32_16x16x32_bf16 v[220:223], v[88:91], a[148:151], v[220:223]
    v_exp_f32 v120, v120
    v_mfma_f32_16x16x32_bf16 v[216:219], v[80:83], a[148:151], v[216:219]
    ds_read_b128 a[128:131], v20 offset:8192
    v_cvt_pk_bf16_f32 v113, v114, v115
    v_mfma_f32_16x16x32_bf16 v[212:215], v[72:75], a[148:151], v[212:215]
    s_waitcnt lgkmcnt(3)
    v_exp_f32 v121, v121
    v_mfma_f32_16x16x32_bf16 v[208:211], v[64:67], a[148:151], v[208:211]
    buffer_load_dwordx4 a[120:123], v2, s[80:83], s67 offen offset:2048 sc1
    v_mfma_f32_16x16x32_bf16 a[232:235], a[240:243], v[80:83], a[232:235]
    v_mfma_f32_16x16x32_bf16 v[224:227], v[64:67], a[152:155], v[224:227]
    v_exp_f32 v122, v122
    v_mfma_f32_16x16x32_bf16 v[228:231], v[72:75], a[152:155], v[228:231]
    ds_read_b128 a[132:135], v21 offset:8192
    v_cvt_pk_bf16_f32 v120, v120, v121
    v_mfma_f32_16x16x32_bf16 v[232:235], v[80:83], a[152:155], v[232:235]
    s_waitcnt lgkmcnt(2)
    v_exp_f32 v123, v123
    v_mfma_f32_16x16x32_bf16 v[236:239], v[88:91], a[152:155], v[236:239]
    buffer_load_dwordx4 a[124:127], v2, s[80:83], s67 offen offset:3072 sc1
    v_mfma_f32_16x16x32_bf16 v[252:255], v[88:91], a[156:159], v[252:255]
    s_add_u32 s67, s78, 16384
    v_exp_f32 v100, v100
    v_mfma_f32_16x16x32_bf16 v[248:251], v[80:83], a[156:159], v[248:251]
    ds_read_b128 a[136:139], v22 offset:8192
    v_cvt_pk_bf16_f32 v121, v122, v123
    v_mfma_f32_16x16x32_bf16 v[244:247], v[72:75], a[156:159], v[244:247]
    s_waitcnt lgkmcnt(2)
    v_exp_f32 v101, v101
    v_mfma_f32_16x16x32_bf16 v[240:243], v[64:67], a[156:159], v[240:243]
    buffer_load_dwordx4 a[160:163], v2, s[80:83], s67 offen offset:0 sc1
    v_mfma_f32_16x16x32_bf16 a[236:239], a[240:243], v[88:91], a[236:239]
    v_mfma_f32_16x16x32_bf16 v[64:67], a[128:131], a[0:3], v[48:51]
    v_exp_f32 v102, v102
    v_mfma_f32_16x16x32_bf16 v[72:75], a[128:131], a[4:7], v[52:55]
    ds_read_b128 a[140:143], v23 offset:8192
    v_cvt_pk_bf16_f32 v98, v100, v101
    v_mfma_f32_16x16x32_bf16 v[80:83], a[128:131], a[8:11], v[56:59]
    s_waitcnt lgkmcnt(2)
    v_exp_f32 v103, v103
    v_mfma_f32_16x16x32_bf16 v[88:91], a[128:131], a[12:15], v[60:63]
    buffer_load_dwordx4 a[164:167], v2, s[80:83], s67 offen offset:1024 sc1
    v_mfma_f32_16x16x32_bf16 v[64:67], a[132:135], a[32:35], v[64:67]
    v_exp_f32 v108, v108
    v_mfma_f32_16x16x32_bf16 v[72:75], a[132:135], a[36:39], v[72:75]
    ds_read_b128 a[144:147], v20 offset:12288
    v_cvt_pk_bf16_f32 v99, v102, v103
    v_mfma_f32_16x16x32_bf16 v[80:83], a[132:135], a[40:43], v[80:83]
    s_waitcnt lgkmcnt(2)
    v_exp_f32 v109, v109
    v_mfma_f32_16x16x32_bf16 v[88:91], a[132:135], a[44:47], v[88:91]
    buffer_load_dwordx4 a[168:171], v2, s[80:83], s67 offen offset:2048 sc1
    v_mfma_f32_16x16x32_bf16 v[64:67], a[136:139], a[64:67], v[64:67]
    v_exp_f32 v110, v110
    v_mfma_f32_16x16x32_bf16 v[72:75], a[136:139], a[68:71], v[72:75]
    ds_read_b128 a[148:151], v21 offset:12288
    v_cvt_pk_bf16_f32 v106, v108, v109
    v_mfma_f32_16x16x32_bf16 v[80:83], a[136:139], a[72:75], v[80:83]
    s_waitcnt lgkmcnt(2)
    v_exp_f32 v111, v111
    v_mfma_f32_16x16x32_bf16 v[88:91], a[136:139], a[76:79], v[88:91]
    buffer_load_dwordx4 a[172:175], v2, s[80:83], s67 offen offset:3072 sc1
    v_mfma_f32_16x16x32_bf16 v[64:67], a[140:143], a[96:99], v[64:67]
    v_exp_f32 v116, v116
    v_mfma_f32_16x16x32_bf16 v[72:75], a[140:143], a[100:103], v[72:75]
    ds_read_b128 a[152:155], v22 offset:12288
    ds_read_b64_tr_b16 a[128:129], v24 offset:24576
    v_mfma_f32_16x16x32_bf16 v[80:83], a[140:143], a[104:107], v[80:83]
    s_waitcnt lgkmcnt(3)
    v_exp_f32 v117, v117
    v_mfma_f32_16x16x32_bf16 v[88:91], a[140:143], a[108:111], v[88:91]
    ds_read_b64_tr_b16 a[130:131], v24 offset:28672
    v_cvt_pk_bf16_f32 v107, v110, v111
    v_mfma_f32_16x16x32_bf16 v[68:71], a[144:147], a[0:3], v[48:51]
    v_exp_f32 v118, v118
    v_mfma_f32_16x16x32_bf16 v[76:79], a[144:147], a[4:7], v[52:55]
    ds_read_b128 a[156:159], v23 offset:12288
    ds_read_b64_tr_b16 a[132:133], v25 offset:24576
    v_mfma_f32_16x16x32_bf16 v[84:87], a[144:147], a[8:11], v[56:59]
    s_waitcnt lgkmcnt(5)
    v_exp_f32 v119, v119
    v_mfma_f32_16x16x32_bf16 v[92:95], a[144:147], a[12:15], v[60:63]
    ds_read_b64_tr_b16 a[134:135], v25 offset:28672
    v_cvt_pk_bf16_f32 v114, v116, v117
    v_mfma_f32_16x16x32_bf16 v[68:71], a[148:151], a[32:35], v[68:71]
    v_exp_f32 v124, v124
    v_mfma_f32_16x16x32_bf16 v[76:79], a[148:151], a[36:39], v[76:79]
    ds_read_b64_tr_b16 a[136:137], v26 offset:24576
    ds_read_b64_tr_b16 a[138:139], v26 offset:28672
    v_mfma_f32_16x16x32_bf16 v[84:87], a[148:151], a[40:43], v[84:87]
    s_waitcnt lgkmcnt(7)
    v_exp_f32 v125, v125
    v_mfma_f32_16x16x32_bf16 v[92:95], a[148:151], a[44:47], v[92:95]
    buffer_load_dwordx4 v13, s[32:35], s60 offen offset:1024 lds
    v_cvt_pk_bf16_f32 v115, v118, v119
    v_mfma_f32_16x16x32_bf16 v[68:71], a[152:155], a[64:67], v[68:71]
    v_exp_f32 v126, v126
    v_mfma_f32_16x16x32_bf16 v[76:79], a[152:155], a[68:71], v[76:79]
    ds_read_b64_tr_b16 a[140:141], v27 offset:24576
    ds_read_b64_tr_b16 a[142:143], v27 offset:28672
    v_mfma_f32_16x16x32_bf16 v[84:87], a[152:155], a[72:75], v[84:87]
    s_waitcnt lgkmcnt(6)
    v_exp_f32 v127, v127
    v_mfma_f32_16x16x32_bf16 v[92:95], a[152:155], a[76:79], v[92:95]
    buffer_load_dwordx4 v14, s[32:35], s60 offen offset:2048 lds
    v_cvt_pk_bf16_f32 v122, v124, v125
    v_mfma_f32_16x16x32_bf16 v[68:71], a[156:159], a[96:99], v[68:71]
    v_exp_f32 v64, v64
    v_mfma_f32_16x16x32_bf16 v[76:79], a[156:159], a[100:103], v[76:79]
    ds_read_b64_tr_b16 a[144:145], v28 offset:24576
    ds_read_b64_tr_b16 a[146:147], v28 offset:28672
    v_mfma_f32_16x16x32_bf16 v[84:87], a[156:159], a[104:107], v[84:87]
    v_exp_f32 v65, v65
    v_mfma_f32_16x16x32_bf16 v[92:95], a[156:159], a[108:111], v[92:95]
    buffer_load_dwordx4 v15, s[32:35], s60 offen offset:3072 lds
    v_cvt_pk_bf16_f32 v123, v126, v127
    v_mfma_f32_16x16x32_bf16 v[128:131], v[96:99], a[128:131], v[128:131]
    v_exp_f32 v66, v66
    v_mfma_f32_16x16x32_bf16 v[132:135], v[104:107], a[128:131], v[132:135]
    ds_read_b64_tr_b16 a[148:149], v29 offset:24576
    v_cvt_pk_bf16_f32 v64, v64, v65
    v_mfma_f32_16x16x32_bf16 v[136:139], v[112:115], a[128:131], v[136:139]
    s_waitcnt lgkmcnt(7)
    v_exp_f32 v67, v67
    v_mfma_f32_16x16x32_bf16 v[140:143], v[120:123], a[128:131], v[140:143]
    ds_read_b64_tr_b16 a[150:151], v29 offset:28672
    v_mfma_f32_16x16x32_bf16 v[156:159], v[120:123], a[132:135], v[156:159]
    v_exp_f32 v72, v72
    v_mfma_f32_16x16x32_bf16 v[152:155], v[112:115], a[132:135], v[152:155]
    ds_read_b64_tr_b16 a[152:153], v30 offset:24576
    v_cvt_pk_bf16_f32 v65, v66, v67
    v_mfma_f32_16x16x32_bf16 v[148:151], v[104:107], a[132:135], v[148:151]
    s_waitcnt lgkmcnt(7)
    v_exp_f32 v73, v73
    v_mfma_f32_16x16x32_bf16 v[144:147], v[96:99], a[132:135], v[144:147]
    ds_read_b64_tr_b16 a[154:155], v30 offset:28672
    v_mfma_f32_16x16x32_bf16 a[224:227], a[240:243], v[96:99], a[224:227]
    v_mfma_f32_16x16x32_bf16 v[160:163], v[96:99], a[136:139], v[160:163]
    v_exp_f32 v74, v74
    v_mfma_f32_16x16x32_bf16 v[164:167], v[104:107], a[136:139], v[164:167]
    ds_read_b64_tr_b16 a[156:157], v31 offset:24576
    v_cvt_pk_bf16_f32 v72, v72, v73
    v_mfma_f32_16x16x32_bf16 v[168:171], v[112:115], a[136:139], v[168:171]
    s_waitcnt lgkmcnt(7)
    v_exp_f32 v75, v75
    v_mfma_f32_16x16x32_bf16 v[172:175], v[120:123], a[136:139], v[172:175]
    ds_read_b64_tr_b16 a[158:159], v31 offset:28672
    v_mfma_f32_16x16x32_bf16 v[188:191], v[120:123], a[140:143], v[188:191]
    s_add_u32 s67, s78, 20480
    v_exp_f32 v80, v80
    v_mfma_f32_16x16x32_bf16 v[184:187], v[112:115], a[140:143], v[184:187]
    buffer_load_dwordx4 a[176:179], v2, s[80:83], s67 offen offset:0 sc1
    v_cvt_pk_bf16_f32 v73, v74, v75
    v_mfma_f32_16x16x32_bf16 v[180:183], v[104:107], a[140:143], v[180:183]
    s_waitcnt lgkmcnt(6)
    v_exp_f32 v81, v81
    v_mfma_f32_16x16x32_bf16 v[176:179], v[96:99], a[140:143], v[176:179]
    v_mfma_f32_16x16x32_bf16 a[228:231], a[240:243], v[104:107], a[228:231]
    v_mfma_f32_16x16x32_bf16 v[192:195], v[96:99], a[144:147], v[192:195]
    v_exp_f32 v82, v82
    v_mfma_f32_16x16x32_bf16 v[196:199], v[104:107], a[144:147], v[196:199]
    buffer_load_dwordx4 a[180:183], v2, s[80:83], s67 offen offset:1024 sc1
    v_cvt_pk_bf16_f32 v80, v80, v81
    v_mfma_f32_16x16x32_bf16 v[200:203], v[112:115], a[144:147], v[200:203]
    s_waitcnt lgkmcnt(4)
    v_exp_f32 v83, v83
    v_mfma_f32_16x16x32_bf16 v[204:207], v[120:123], a[144:147], v[204:207]
    v_mfma_f32_16x16x32_bf16 v[220:223], v[120:123], a[148:151], v[220:223]
    s_waitcnt vmcnt(19) lgkmcnt(0)
    s_barrier
    s_add_u32 m0, s59, 65536
    v_exp_f32 v88, v88
    v_mfma_f32_16x16x32_bf16 v[216:219], v[112:115], a[148:151], v[216:219]
    ds_read_b128 a[128:131], v20 offset:16384
    v_cvt_pk_bf16_f32 v81, v82, v83
    v_mfma_f32_16x16x32_bf16 v[212:215], v[104:107], a[148:151], v[212:215]
    v_exp_f32 v89, v89
    v_mfma_f32_16x16x32_bf16 v[208:211], v[96:99], a[148:151], v[208:211]
    buffer_load_dwordx4 v32, s[8:11], s62 offen offset:0 lds
    v_mfma_f32_16x16x32_bf16 a[232:235], a[240:243], v[112:115], a[232:235]
    v_mfma_f32_16x16x32_bf16 v[224:227], v[96:99], a[152:155], v[224:227]
    v_exp_f32 v90, v90
    v_mfma_f32_16x16x32_bf16 v[228:231], v[104:107], a[152:155], v[228:231]
    ds_read_b128 a[132:135], v21 offset:16384
    v_cvt_pk_bf16_f32 v88, v88, v89
    v_mfma_f32_16x16x32_bf16 v[232:235], v[112:115], a[152:155], v[232:235]
    v_exp_f32 v91, v91
    v_mfma_f32_16x16x32_bf16 v[236:239], v[120:123], a[152:155], v[236:239]
    buffer_load_dwordx4 v33, s[8:11], s62 offen offset:1024 lds
    v_mfma_f32_16x16x32_bf16 v[252:255], v[120:123], a[156:159], v[252:255]
    v_exp_f32 v68, v68
    v_mfma_f32_16x16x32_bf16 v[248:251], v[112:115], a[156:159], v[248:251]
    ds_read_b128 a[136:139], v22 offset:16384
    v_cvt_pk_bf16_f32 v89, v90, v91
    v_mfma_f32_16x16x32_bf16 v[244:247], v[104:107], a[156:159], v[244:247]
    s_waitcnt lgkmcnt(2)
    v_exp_f32 v69, v69
    v_mfma_f32_16x16x32_bf16 v[240:243], v[96:99], a[156:159], v[240:243]
    buffer_load_dwordx4 v34, s[8:11], s62 offen offset:2048 lds
    v_mfma_f32_16x16x32_bf16 a[236:239], a[240:243], v[120:123], a[236:239]
    v_mfma_f32_16x16x32_bf16 v[96:99], a[128:131], a[0:3], v[48:51]
    v_exp_f32 v70, v70
    v_mfma_f32_16x16x32_bf16 v[104:107], a[128:131], a[4:7], v[52:55]
    ds_read_b128 a[140:143], v23 offset:16384
    v_cvt_pk_bf16_f32 v66, v68, v69
    v_mfma_f32_16x16x32_bf16 v[112:115], a[128:131], a[8:11], v[56:59]
    s_waitcnt lgkmcnt(2)
    v_exp_f32 v71, v71
    v_mfma_f32_16x16x32_bf16 v[120:123], a[128:131], a[12:15], v[60:63]
    buffer_load_dwordx4 v35, s[8:11], s62 offen offset:3072 lds
    v_mfma_f32_16x16x32_bf16 v[96:99], a[132:135], a[32:35], v[96:99]
    s_add_u32 m0, s59, 16384
    v_exp_f32 v76, v76
    v_mfma_f32_16x16x32_bf16 v[104:107], a[132:135], a[36:39], v[104:107]
    ds_read_b128 a[144:147], v20 offset:20480
    v_cvt_pk_bf16_f32 v67, v70, v71
    v_mfma_f32_16x16x32_bf16 v[112:115], a[132:135], a[40:43], v[112:115]
    s_waitcnt lgkmcnt(2)
    v_exp_f32 v77, v77
    v_mfma_f32_16x16x32_bf16 v[120:123], a[132:135], a[44:47], v[120:123]
    buffer_load_dwordx4 v36, s[12:15], s63 offen offset:0 lds
    v_mfma_f32_16x16x32_bf16 v[96:99], a[136:139], a[64:67], v[96:99]
    v_exp_f32 v78, v78
    v_mfma_f32_16x16x32_bf16 v[104:107], a[136:139], a[68:71], v[104:107]
    ds_read_b128 a[148:151], v21 offset:20480
    v_cvt_pk_bf16_f32 v74, v76, v77
    v_mfma_f32_16x16x32_bf16 v[112:115], a[136:139], a[72:75], v[112:115]
    s_waitcnt lgkmcnt(2)
    v_exp_f32 v79, v79
    v_mfma_f32_16x16x32_bf16 v[120:123], a[136:139], a[76:79], v[120:123]
    buffer_load_dwordx4 v37, s[12:15], s63 offen offset:1024 lds
    v_mfma_f32_16x16x32_bf16 v[96:99], a[140:143], a[96:99], v[96:99]
    v_exp_f32 v84, v84
    v_mfma_f32_16x16x32_bf16 v[104:107], a[140:143], a[100:103], v[104:107]
    ds_read_b128 a[152:155], v22 offset:20480
    v_cvt_pk_bf16_f32 v75, v78, v79
    v_mfma_f32_16x16x32_bf16 v[112:115], a[140:143], a[104:107], v[112:115]
    s_waitcnt lgkmcnt(2)
    v_exp_f32 v85, v85
    v_mfma_f32_16x16x32_bf16 v[120:123], a[140:143], a[108:111], v[120:123]
    buffer_load_dwordx4 v36, s[12:15], s63 offen offset:2048 lds
    v_mfma_f32_16x16x32_bf16 v[100:103], a[144:147], a[0:3], v[48:51]
    v_exp_f32 v86, v86
    v_mfma_f32_16x16x32_bf16 v[108:111], a[144:147], a[4:7], v[52:55]
    ds_read_b128 a[156:159], v23 offset:20480
    v_cvt_pk_bf16_f32 v82, v84, v85
    v_mfma_f32_16x16x32_bf16 v[116:119], a[144:147], a[8:11], v[56:59]
    s_waitcnt lgkmcnt(2)
    v_exp_f32 v87, v87
    v_mfma_f32_16x16x32_bf16 v[124:127], a[144:147], a[12:15], v[60:63]
    buffer_load_dwordx4 v37, s[12:15], s63 offen offset:3072 lds
    v_mfma_f32_16x16x32_bf16 v[100:103], a[148:151], a[32:35], v[100:103]
    v_exp_f32 v92, v92
    v_mfma_f32_16x16x32_bf16 v[108:111], a[148:151], a[36:39], v[108:111]
    ds_read_b64_tr_b16 a[128:129], v24 offset:0
    ds_read_b64_tr_b16 a[130:131], v24 offset:4096
    v_mfma_f32_16x16x32_bf16 v[116:119], a[148:151], a[40:43], v[116:119]
    s_waitcnt lgkmcnt(3)
    v_exp_f32 v93, v93
    v_mfma_f32_16x16x32_bf16 v[124:127], a[148:151], a[44:47], v[124:127]
    buffer_load_dwordx4 a[184:187], v2, s[80:83], s67 offen offset:2048 sc1
    v_cvt_pk_bf16_f32 v83, v86, v87
    v_mfma_f32_16x16x32_bf16 v[100:103], a[152:155], a[64:67], v[100:103]
    v_exp_f32 v94, v94
    v_mfma_f32_16x16x32_bf16 v[108:111], a[152:155], a[68:71], v[108:111]
    ds_read_b64_tr_b16 a[132:133], v25 offset:0
    v_cvt_pk_bf16_f32 v90, v92, v93
    v_mfma_f32_16x16x32_bf16 v[116:119], a[152:155], a[72:75], v[116:119]
    s_waitcnt lgkmcnt(3)
    v_exp_f32 v95, v95
    v_mfma_f32_16x16x32_bf16 v[124:127], a[152:155], a[76:79], v[124:127]
    ds_read_b64_tr_b16 a[134:135], v25 offset:4096
    v_mfma_f32_16x16x32_bf16 v[100:103], a[156:159], a[96:99], v[100:103]
    v_exp_f32 v96, v96
    v_mfma_f32_16x16x32_bf16 v[108:111], a[156:159], a[100:103], v[108:111]
    ds_read_b64_tr_b16 a[136:137], v26 offset:0
    v_cvt_pk_bf16_f32 v91, v94, v95
    v_mfma_f32_16x16x32_bf16 v[116:119], a[156:159], a[104:107], v[116:119]
    s_waitcnt lgkmcnt(3)
    v_exp_f32 v97, v97
    v_mfma_f32_16x16x32_bf16 v[124:127], a[156:159], a[108:111], v[124:127]
    ds_read_b64_tr_b16 a[138:139], v26 offset:4096
    v_mfma_f32_16x16x32_bf16 v[128:131], v[64:67], a[128:131], v[128:131]
    v_exp_f32 v98, v98
    v_mfma_f32_16x16x32_bf16 v[132:135], v[72:75], a[128:131], v[132:135]
    ds_read_b64_tr_b16 a[140:141], v27 offset:0
    v_cvt_pk_bf16_f32 v96, v96, v97
    v_mfma_f32_16x16x32_bf16 v[136:139], v[80:83], a[128:131], v[136:139]
    s_waitcnt lgkmcnt(3)
    v_exp_f32 v99, v99
    v_mfma_f32_16x16x32_bf16 v[140:143], v[88:91], a[128:131], v[140:143]
    ds_read_b64_tr_b16 a[142:143], v27 offset:4096
    v_mfma_f32_16x16x32_bf16 v[156:159], v[88:91], a[132:135], v[156:159]
    v_exp_f32 v104, v104
    v_mfma_f32_16x16x32_bf16 v[152:155], v[80:83], a[132:135], v[152:155]
    ds_read_b64_tr_b16 a[144:145], v28 offset:0
    ds_read_b64_tr_b16 a[146:147], v28 offset:4096
    v_mfma_f32_16x16x32_bf16 v[148:151], v[72:75], a[132:135], v[148:151]
    s_waitcnt lgkmcnt(4)
    v_exp_f32 v105, v105
    v_mfma_f32_16x16x32_bf16 v[144:147], v[64:67], a[132:135], v[144:147]
    buffer_load_dwordx4 a[188:191], v2, s[80:83], s67 offen offset:3072 sc1
    v_cvt_pk_bf16_f32 v97, v98, v99
    v_mfma_f32_16x16x32_bf16 a[224:227], a[240:243], v[64:67], a[224:227]
    v_mfma_f32_16x16x32_bf16 v[160:163], v[64:67], a[136:139], v[160:163]
    v_exp_f32 v106, v106
    v_mfma_f32_16x16x32_bf16 v[164:167], v[72:75], a[136:139], v[164:167]
    ds_read_b64_tr_b16 a[148:149], v29 offset:0
    v_cvt_pk_bf16_f32 v104, v104, v105
    v_mfma_f32_16x16x32_bf16 v[168:171], v[80:83], a[136:139], v[168:171]
    s_waitcnt lgkmcnt(3)
    v_exp_f32 v107, v107
    v_mfma_f32_16x16x32_bf16 v[172:175], v[88:91], a[136:139], v[172:175]
    ds_read_b64_tr_b16 a[150:151], v29 offset:4096
    v_mfma_f32_16x16x32_bf16 v[188:191], v[88:91], a[140:143], v[188:191]
    s_add_u32 s67, s78, 24576
    v_exp_f32 v112, v112
    v_mfma_f32_16x16x32_bf16 v[184:187], v[80:83], a[140:143], v[184:187]
    ds_read_b64_tr_b16 a[152:153], v30 offset:0
    ds_read_b64_tr_b16 a[154:155], v30 offset:4096
    v_mfma_f32_16x16x32_bf16 v[180:183], v[72:75], a[140:143], v[180:183]
    s_waitcnt lgkmcnt(4)
    v_exp_f32 v113, v113
    v_mfma_f32_16x16x32_bf16 v[176:179], v[64:67], a[140:143], v[176:179]
    buffer_load_dwordx4 a[192:195], v2, s[80:83], s67 offen offset:0 sc1
    v_cvt_pk_bf16_f32 v105, v106, v107
    v_mfma_f32_16x16x32_bf16 a[228:231], a[240:243], v[72:75], a[228:231]
    v_mfma_f32_16x16x32_bf16 v[192:195], v[64:67], a[144:147], v[192:195]
    v_exp_f32 v114, v114
    v_mfma_f32_16x16x32_bf16 v[196:199], v[72:75], a[144:147], v[196:199]
    ds_read_b64_tr_b16 a[156:157], v31 offset:0
    v_cvt_pk_bf16_f32 v112, v112, v113
    v_mfma_f32_16x16x32_bf16 v[200:203], v[80:83], a[144:147], v[200:203]
    s_waitcnt lgkmcnt(3)
    v_exp_f32 v115, v115
    v_mfma_f32_16x16x32_bf16 v[204:207], v[88:91], a[144:147], v[204:207]
    ds_read_b64_tr_b16 a[158:159], v31 offset:4096
    v_mfma_f32_16x16x32_bf16 v[220:223], v[88:91], a[148:151], v[220:223]
    v_exp_f32 v120, v120
    v_mfma_f32_16x16x32_bf16 v[216:219], v[80:83], a[148:151], v[216:219]
    ds_read_b128 a[128:131], v20 offset:24576
    v_cvt_pk_bf16_f32 v113, v114, v115
    v_mfma_f32_16x16x32_bf16 v[212:215], v[72:75], a[148:151], v[212:215]
    s_waitcnt lgkmcnt(3)
    v_exp_f32 v121, v121
    v_mfma_f32_16x16x32_bf16 v[208:211], v[64:67], a[148:151], v[208:211]
    buffer_load_dwordx4 a[196:199], v2, s[80:83], s67 offen offset:1024 sc1
    v_mfma_f32_16x16x32_bf16 a[232:235], a[240:243], v[80:83], a[232:235]
    v_mfma_f32_16x16x32_bf16 v[224:227], v[64:67], a[152:155], v[224:227]
    v_exp_f32 v122, v122
    v_mfma_f32_16x16x32_bf16 v[228:231], v[72:75], a[152:155], v[228:231]
    ds_read_b128 a[132:135], v21 offset:24576
    v_cvt_pk_bf16_f32 v120, v120, v121
    v_mfma_f32_16x16x32_bf16 v[232:235], v[80:83], a[152:155], v[232:235]
    s_waitcnt lgkmcnt(2)
    v_exp_f32 v123, v123
    v_mfma_f32_16x16x32_bf16 v[236:239], v[88:91], a[152:155], v[236:239]
    buffer_load_dwordx4 a[200:203], v2, s[80:83], s67 offen offset:2048 sc1
    v_mfma_f32_16x16x32_bf16 v[252:255], v[88:91], a[156:159], v[252:255]
    v_exp_f32 v100, v100
    v_mfma_f32_16x16x32_bf16 v[248:251], v[80:83], a[156:159], v[248:251]
    ds_read_b128 a[136:139], v22 offset:24576
    v_cvt_pk_bf16_f32 v121, v122, v123
    v_mfma_f32_16x16x32_bf16 v[244:247], v[72:75], a[156:159], v[244:247]
    s_waitcnt lgkmcnt(2)
    v_exp_f32 v101, v101
    v_mfma_f32_16x16x32_bf16 v[240:243], v[64:67], a[156:159], v[240:243]
    buffer_load_dwordx4 a[204:207], v2, s[80:83], s67 offen offset:3072 sc1
    v_mfma_f32_16x16x32_bf16 a[236:239], a[240:243], v[88:91], a[236:239]
    v_mfma_f32_16x16x32_bf16 v[64:67], a[128:131], a[0:3], v[48:51]
    s_add_u32 s67, s78, 28672
    v_exp_f32 v102, v102
    v_mfma_f32_16x16x32_bf16 v[72:75], a[128:131], a[4:7], v[52:55]
    ds_read_b128 a[140:143], v23 offset:24576
    v_cvt_pk_bf16_f32 v98, v100, v101
    v_mfma_f32_16x16x32_bf16 v[80:83], a[128:131], a[8:11], v[56:59]
    s_waitcnt lgkmcnt(2)
    v_exp_f32 v103, v103
    v_mfma_f32_16x16x32_bf16 v[88:91], a[128:131], a[12:15], v[60:63]
    buffer_load_dwordx4 a[208:211], v2, s[80:83], s67 offen offset:0 sc1
    v_mfma_f32_16x16x32_bf16 v[64:67], a[132:135], a[32:35], v[64:67]
    v_exp_f32 v108, v108
    v_mfma_f32_16x16x32_bf16 v[72:75], a[132:135], a[36:39], v[72:75]
    ds_read_b128 a[144:147], v20 offset:28672
    v_cvt_pk_bf16_f32 v99, v102, v103
    v_mfma_f32_16x16x32_bf16 v[80:83], a[132:135], a[40:43], v[80:83]
    s_waitcnt lgkmcnt(2)
    v_exp_f32 v109, v109
    v_mfma_f32_16x16x32_bf16 v[88:91], a[132:135], a[44:47], v[88:91]
    buffer_load_dwordx4 a[212:215], v2, s[80:83], s67 offen offset:1024 sc1
    v_mfma_f32_16x16x32_bf16 v[64:67], a[136:139], a[64:67], v[64:67]
    v_exp_f32 v110, v110
    v_mfma_f32_16x16x32_bf16 v[72:75], a[136:139], a[68:71], v[72:75]
    ds_read_b128 a[148:151], v21 offset:28672
    v_cvt_pk_bf16_f32 v106, v108, v109
    v_mfma_f32_16x16x32_bf16 v[80:83], a[136:139], a[72:75], v[80:83]
    s_waitcnt lgkmcnt(2)
    v_exp_f32 v111, v111
    v_mfma_f32_16x16x32_bf16 v[88:91], a[136:139], a[76:79], v[88:91]
    buffer_load_dwordx4 a[216:219], v2, s[80:83], s67 offen offset:2048 sc1
    v_mfma_f32_16x16x32_bf16 v[64:67], a[140:143], a[96:99], v[64:67]
    v_exp_f32 v116, v116
    v_mfma_f32_16x16x32_bf16 v[72:75], a[140:143], a[100:103], v[72:75]
    ds_read_b128 a[152:155], v22 offset:28672
    ds_read_b64_tr_b16 a[128:129], v24 offset:8192
    v_mfma_f32_16x16x32_bf16 v[80:83], a[140:143], a[104:107], v[80:83]
    s_waitcnt lgkmcnt(3)
    v_exp_f32 v117, v117
    v_mfma_f32_16x16x32_bf16 v[88:91], a[140:143], a[108:111], v[88:91]
    ds_read_b64_tr_b16 a[130:131], v24 offset:12288
    v_cvt_pk_bf16_f32 v107, v110, v111
    v_mfma_f32_16x16x32_bf16 v[68:71], a[144:147], a[0:3], v[48:51]
    v_exp_f32 v118, v118
    v_mfma_f32_16x16x32_bf16 v[76:79], a[144:147], a[4:7], v[52:55]
    ds_read_b128 a[156:159], v23 offset:28672
    ds_read_b64_tr_b16 a[132:133], v25 offset:8192
    v_mfma_f32_16x16x32_bf16 v[84:87], a[144:147], a[8:11], v[56:59]
    s_waitcnt lgkmcnt(5)
    v_exp_f32 v119, v119
    v_mfma_f32_16x16x32_bf16 v[92:95], a[144:147], a[12:15], v[60:63]
    ds_read_b64_tr_b16 a[134:135], v25 offset:12288
    v_cvt_pk_bf16_f32 v114, v116, v117
    v_mfma_f32_16x16x32_bf16 v[68:71], a[148:151], a[32:35], v[68:71]
    v_exp_f32 v124, v124
    v_mfma_f32_16x16x32_bf16 v[76:79], a[148:151], a[36:39], v[76:79]
    ds_read_b64_tr_b16 a[136:137], v26 offset:8192
    v_cvt_pk_bf16_f32 v115, v118, v119
    v_mfma_f32_16x16x32_bf16 v[84:87], a[148:151], a[40:43], v[84:87]
    s_waitcnt lgkmcnt(6)
    v_exp_f32 v125, v125
    v_mfma_f32_16x16x32_bf16 v[92:95], a[148:151], a[44:47], v[92:95]
    ds_read_b64_tr_b16 a[138:139], v26 offset:12288
    v_mfma_f32_16x16x32_bf16 v[68:71], a[152:155], a[64:67], v[68:71]
    v_exp_f32 v126, v126
    v_mfma_f32_16x16x32_bf16 v[76:79], a[152:155], a[68:71], v[76:79]
    ds_read_b64_tr_b16 a[140:141], v27 offset:8192
    v_cvt_pk_bf16_f32 v122, v124, v125
    v_mfma_f32_16x16x32_bf16 v[84:87], a[152:155], a[72:75], v[84:87]
    s_waitcnt lgkmcnt(5)
    v_exp_f32 v127, v127
    v_mfma_f32_16x16x32_bf16 v[92:95], a[152:155], a[76:79], v[92:95]
    ds_read_b64_tr_b16 a[142:143], v27 offset:12288
    v_mfma_f32_16x16x32_bf16 v[68:71], a[156:159], a[96:99], v[68:71]
    v_exp_f32 v64, v64
    v_mfma_f32_16x16x32_bf16 v[76:79], a[156:159], a[100:103], v[76:79]
    ds_read_b64_tr_b16 a[144:145], v28 offset:8192
    v_cvt_pk_bf16_f32 v123, v126, v127
    v_mfma_f32_16x16x32_bf16 v[84:87], a[156:159], a[104:107], v[84:87]
    v_exp_f32 v65, v65
    v_mfma_f32_16x16x32_bf16 v[92:95], a[156:159], a[108:111], v[92:95]
    ds_read_b64_tr_b16 a[146:147], v28 offset:12288
    v_mfma_f32_16x16x32_bf16 v[128:131], v[96:99], a[128:131], v[128:131]
    v_exp_f32 v66, v66
    v_mfma_f32_16x16x32_bf16 v[132:135], v[104:107], a[128:131], v[132:135]
    ds_read_b64_tr_b16 a[148:149], v29 offset:8192
    v_cvt_pk_bf16_f32 v64, v64, v65
    v_mfma_f32_16x16x32_bf16 v[136:139], v[112:115], a[128:131], v[136:139]
    s_waitcnt lgkmcnt(7)
    v_exp_f32 v67, v67
    v_mfma_f32_16x16x32_bf16 v[140:143], v[120:123], a[128:131], v[140:143]
    ds_read_b64_tr_b16 a[150:151], v29 offset:12288
    v_mfma_f32_16x16x32_bf16 v[156:159], v[120:123], a[132:135], v[156:159]
    v_exp_f32 v72, v72
    v_mfma_f32_16x16x32_bf16 v[152:155], v[112:115], a[132:135], v[152:155]
    ds_read_b64_tr_b16 a[152:153], v30 offset:8192
    v_cvt_pk_bf16_f32 v65, v66, v67
    v_mfma_f32_16x16x32_bf16 v[148:151], v[104:107], a[132:135], v[148:151]
    s_waitcnt lgkmcnt(7)
    v_exp_f32 v73, v73
    v_mfma_f32_16x16x32_bf16 v[144:147], v[96:99], a[132:135], v[144:147]
    ds_read_b64_tr_b16 a[154:155], v30 offset:12288
    v_mfma_f32_16x16x32_bf16 a[224:227], a[240:243], v[96:99], a[224:227]
    v_mfma_f32_16x16x32_bf16 v[160:163], v[96:99], a[136:139], v[160:163]
    v_exp_f32 v74, v74
    v_mfma_f32_16x16x32_bf16 v[164:167], v[104:107], a[136:139], v[164:167]
    ds_read_b64_tr_b16 a[156:157], v31 offset:8192
    v_cvt_pk_bf16_f32 v72, v72, v73
    v_mfma_f32_16x16x32_bf16 v[168:171], v[112:115], a[136:139], v[168:171]
    s_waitcnt lgkmcnt(7)
    v_exp_f32 v75, v75
    v_mfma_f32_16x16x32_bf16 v[172:175], v[120:123], a[136:139], v[172:175]
    ds_read_b64_tr_b16 a[158:159], v31 offset:12288
    v_mfma_f32_16x16x32_bf16 v[188:191], v[120:123], a[140:143], v[188:191]
    v_exp_f32 v80, v80
    v_mfma_f32_16x16x32_bf16 v[184:187], v[112:115], a[140:143], v[184:187]
    buffer_load_dwordx4 a[220:223], v2, s[80:83], s67 offen offset:3072 sc1
    v_cvt_pk_bf16_f32 v73, v74, v75
    v_mfma_f32_16x16x32_bf16 v[180:183], v[104:107], a[140:143], v[180:183]
    s_waitcnt lgkmcnt(6)
    v_exp_f32 v81, v81
    v_mfma_f32_16x16x32_bf16 v[176:179], v[96:99], a[140:143], v[176:179]
    v_mfma_f32_16x16x32_bf16 a[228:231], a[240:243], v[104:107], a[228:231]
    v_mfma_f32_16x16x32_bf16 v[192:195], v[96:99], a[144:147], v[192:195]
    v_exp_f32 v82, v82
    v_mfma_f32_16x16x32_bf16 v[196:199], v[104:107], a[144:147], v[196:199]
    v_cvt_pk_bf16_f32 v80, v80, v81
    v_mfma_f32_16x16x32_bf16 v[200:203], v[112:115], a[144:147], v[200:203]
    s_waitcnt lgkmcnt(4)
    v_exp_f32 v83, v83
    v_mfma_f32_16x16x32_bf16 v[204:207], v[120:123], a[144:147], v[204:207]
    v_mfma_f32_16x16x32_bf16 v[220:223], v[120:123], a[148:151], v[220:223]
    s_waitcnt vmcnt(10) lgkmcnt(0)
    s_barrier
    s_add_u32 m0, s59, 81920
    s_mov_b32 s60, 131072
    v_exp_f32 v88, v88
    v_mfma_f32_16x16x32_bf16 v[216:219], v[112:115], a[148:151], v[216:219]
    ds_read_b128 a[128:131], v20 offset:0
    v_cvt_pk_bf16_f32 v81, v82, v83
    v_mfma_f32_16x16x32_bf16 v[212:215], v[104:107], a[148:151], v[212:215]
    v_exp_f32 v89, v89
    v_mfma_f32_16x16x32_bf16 v[208:211], v[96:99], a[148:151], v[208:211]
    buffer_load_dwordx4 v12, s[32:35], s60 offen offset:0 lds
    v_mfma_f32_16x16x32_bf16 a[232:235], a[240:243], v[112:115], a[232:235]
    v_mfma_f32_16x16x32_bf16 v[224:227], v[96:99], a[152:155], v[224:227]
    v_exp_f32 v90, v90
    v_mfma_f32_16x16x32_bf16 v[228:231], v[104:107], a[152:155], v[228:231]
    ds_read_b128 a[132:135], v21 offset:0
    v_cvt_pk_bf16_f32 v88, v88, v89
    v_mfma_f32_16x16x32_bf16 v[232:235], v[112:115], a[152:155], v[232:235]
    v_exp_f32 v91, v91
    v_mfma_f32_16x16x32_bf16 v[236:239], v[120:123], a[152:155], v[236:239]
    buffer_load_dwordx4 v13, s[32:35], s60 offen offset:1024 lds
    v_mfma_f32_16x16x32_bf16 v[252:255], v[120:123], a[156:159], v[252:255]
    v_exp_f32 v68, v68
    v_mfma_f32_16x16x32_bf16 v[248:251], v[112:115], a[156:159], v[248:251]
    ds_read_b128 a[136:139], v22 offset:0
    v_cvt_pk_bf16_f32 v89, v90, v91
    v_mfma_f32_16x16x32_bf16 v[244:247], v[104:107], a[156:159], v[244:247]
    s_waitcnt lgkmcnt(2)
    v_exp_f32 v69, v69
    v_mfma_f32_16x16x32_bf16 v[240:243], v[96:99], a[156:159], v[240:243]
    buffer_load_dwordx4 v14, s[32:35], s60 offen offset:2048 lds
    v_mfma_f32_16x16x32_bf16 a[236:239], a[240:243], v[120:123], a[236:239]
    v_mfma_f32_16x16x32_bf16 v[96:99], a[128:131], a[0:3], v[48:51]
    v_exp_f32 v70, v70
    v_mfma_f32_16x16x32_bf16 v[104:107], a[128:131], a[4:7], v[52:55]
    ds_read_b128 a[140:143], v23 offset:0
    v_cvt_pk_bf16_f32 v66, v68, v69
    v_mfma_f32_16x16x32_bf16 v[112:115], a[128:131], a[8:11], v[56:59]
    s_waitcnt lgkmcnt(2)
    v_exp_f32 v71, v71
    v_mfma_f32_16x16x32_bf16 v[120:123], a[128:131], a[12:15], v[60:63]
    buffer_load_dwordx4 v15, s[32:35], s60 offen offset:3072 lds
    v_mfma_f32_16x16x32_bf16 v[96:99], a[132:135], a[32:35], v[96:99]
    s_add_u32 m0, s59, 0
    s_mov_b32 s60, 163840
    v_exp_f32 v76, v76
    v_mfma_f32_16x16x32_bf16 v[104:107], a[132:135], a[36:39], v[104:107]
    ds_read_b128 a[144:147], v20 offset:4096
    v_cvt_pk_bf16_f32 v67, v70, v71
    v_mfma_f32_16x16x32_bf16 v[112:115], a[132:135], a[40:43], v[112:115]
    s_waitcnt lgkmcnt(2)
    v_exp_f32 v77, v77
    v_mfma_f32_16x16x32_bf16 v[120:123], a[132:135], a[44:47], v[120:123]
    buffer_load_dwordx4 v12, s[32:35], s60 offen offset:0 lds
    v_mfma_f32_16x16x32_bf16 v[96:99], a[136:139], a[64:67], v[96:99]
    v_exp_f32 v78, v78
    v_mfma_f32_16x16x32_bf16 v[104:107], a[136:139], a[68:71], v[104:107]
    ds_read_b128 a[148:151], v21 offset:4096
    v_cvt_pk_bf16_f32 v74, v76, v77
    v_mfma_f32_16x16x32_bf16 v[112:115], a[136:139], a[72:75], v[112:115]
    s_waitcnt lgkmcnt(2)
    v_exp_f32 v79, v79
    v_mfma_f32_16x16x32_bf16 v[120:123], a[136:139], a[76:79], v[120:123]
    buffer_load_dwordx4 v13, s[32:35], s60 offen offset:1024 lds
    v_mfma_f32_16x16x32_bf16 v[96:99], a[140:143], a[96:99], v[96:99]
    v_exp_f32 v84, v84
    v_mfma_f32_16x16x32_bf16 v[104:107], a[140:143], a[100:103], v[104:107]
    ds_read_b128 a[152:155], v22 offset:4096
    v_cvt_pk_bf16_f32 v75, v78, v79
    v_mfma_f32_16x16x32_bf16 v[112:115], a[140:143], a[104:107], v[112:115]
    s_waitcnt lgkmcnt(2)
    v_exp_f32 v85, v85
    v_mfma_f32_16x16x32_bf16 v[120:123], a[140:143], a[108:111], v[120:123]
    buffer_load_dwordx4 v14, s[32:35], s60 offen offset:2048 lds
    v_mfma_f32_16x16x32_bf16 v[100:103], a[144:147], a[0:3], v[48:51]
    v_exp_f32 v86, v86
    v_mfma_f32_16x16x32_bf16 v[108:111], a[144:147], a[4:7], v[52:55]
    ds_read_b128 a[156:159], v23 offset:4096
    v_cvt_pk_bf16_f32 v82, v84, v85
    v_mfma_f32_16x16x32_bf16 v[116:119], a[144:147], a[8:11], v[56:59]
    s_waitcnt lgkmcnt(2)
    v_exp_f32 v87, v87
    v_mfma_f32_16x16x32_bf16 v[124:127], a[144:147], a[12:15], v[60:63]
    buffer_load_dwordx4 v15, s[32:35], s60 offen offset:3072 lds
    v_mfma_f32_16x16x32_bf16 v[100:103], a[148:151], a[32:35], v[100:103]
    s_add_u32 m0, s59, 32768
    s_mov_b32 s60, 196608
    v_exp_f32 v92, v92
    v_mfma_f32_16x16x32_bf16 v[108:111], a[148:151], a[36:39], v[108:111]
    ds_read_b64_tr_b16 a[128:129], v24 offset:16384
    ds_read_b64_tr_b16 a[130:131], v24 offset:20480
    v_mfma_f32_16x16x32_bf16 v[116:119], a[148:151], a[40:43], v[116:119]
    s_waitcnt lgkmcnt(3)
    v_exp_f32 v93, v93
    v_mfma_f32_16x16x32_bf16 v[124:127], a[148:151], a[44:47], v[124:127]
    buffer_load_dwordx4 v12, s[32:35], s60 offen offset:0 lds
    v_cvt_pk_bf16_f32 v83, v86, v87
    v_mfma_f32_16x16x32_bf16 v[100:103], a[152:155], a[64:67], v[100:103]
    v_exp_f32 v94, v94
    v_mfma_f32_16x16x32_bf16 v[108:111], a[152:155], a[68:71], v[108:111]
    ds_read_b64_tr_b16 a[132:133], v25 offset:16384
    ds_read_b64_tr_b16 a[134:135], v25 offset:20480
    v_mfma_f32_16x16x32_bf16 v[116:119], a[152:155], a[72:75], v[116:119]
    s_waitcnt lgkmcnt(4)
    v_exp_f32 v95, v95
    v_mfma_f32_16x16x32_bf16 v[124:127], a[152:155], a[76:79], v[124:127]
    buffer_load_dwordx4 v13, s[32:35], s60 offen offset:1024 lds
    v_cvt_pk_bf16_f32 v90, v92, v93
    v_mfma_f32_16x16x32_bf16 v[100:103], a[156:159], a[96:99], v[100:103]
    v_exp_f32 v96, v96
    v_mfma_f32_16x16x32_bf16 v[108:111], a[156:159], a[100:103], v[108:111]
    ds_read_b64_tr_b16 a[136:137], v26 offset:16384
    ds_read_b64_tr_b16 a[138:139], v26 offset:20480
    v_mfma_f32_16x16x32_bf16 v[116:119], a[156:159], a[104:107], v[116:119]
    s_waitcnt lgkmcnt(4)
    v_exp_f32 v97, v97
    v_mfma_f32_16x16x32_bf16 v[124:127], a[156:159], a[108:111], v[124:127]
    buffer_load_dwordx4 v14, s[32:35], s60 offen offset:2048 lds
    v_cvt_pk_bf16_f32 v91, v94, v95
    v_mfma_f32_16x16x32_bf16 v[128:131], v[64:67], a[128:131], v[128:131]
    v_exp_f32 v98, v98
    v_mfma_f32_16x16x32_bf16 v[132:135], v[72:75], a[128:131], v[132:135]
    ds_read_b64_tr_b16 a[140:141], v27 offset:16384
    ds_read_b64_tr_b16 a[142:143], v27 offset:20480
    v_mfma_f32_16x16x32_bf16 v[136:139], v[80:83], a[128:131], v[136:139]
    s_waitcnt lgkmcnt(4)
    v_exp_f32 v99, v99
    v_mfma_f32_16x16x32_bf16 v[140:143], v[88:91], a[128:131], v[140:143]
    buffer_load_dwordx4 v15, s[32:35], s60 offen offset:3072 lds
    v_cvt_pk_bf16_f32 v96, v96, v97
    v_mfma_f32_16x16x32_bf16 v[156:159], v[88:91], a[132:135], v[156:159]
    s_add_u32 m0, s59, 49152
    s_mov_b32 s60, 229376
    v_exp_f32 v104, v104
    v_mfma_f32_16x16x32_bf16 v[152:155], v[80:83], a[132:135], v[152:155]
    ds_read_b64_tr_b16 a[144:145], v28 offset:16384
    ds_read_b64_tr_b16 a[146:147], v28 offset:20480
    v_mfma_f32_16x16x32_bf16 v[148:151], v[72:75], a[132:135], v[148:151]
    s_waitcnt lgkmcnt(4)
    v_exp_f32 v105, v105
    v_mfma_f32_16x16x32_bf16 v[144:147], v[64:67], a[132:135], v[144:147]
    buffer_load_dwordx4 v12, s[32:35], s60 offen offset:0 lds
    v_cvt_pk_bf16_f32 v97, v98, v99
    v_mfma_f32_16x16x32_bf16 a[224:227], a[240:243], v[64:67], a[224:227]
    v_mfma_f32_16x16x32_bf16 v[160:163], v[64:67], a[136:139], v[160:163]
    v_exp_f32 v106, v106
    v_mfma_f32_16x16x32_bf16 v[164:167], v[72:75], a[136:139], v[164:167]
    ds_read_b64_tr_b16 a[148:149], v29 offset:16384
    ds_read_b64_tr_b16 a[150:151], v29 offset:20480
    v_mfma_f32_16x16x32_bf16 v[168:171], v[80:83], a[136:139], v[168:171]
    s_waitcnt lgkmcnt(4)
    v_exp_f32 v107, v107
    v_mfma_f32_16x16x32_bf16 v[172:175], v[88:91], a[136:139], v[172:175]
    buffer_load_dwordx4 v13, s[32:35], s60 offen offset:1024 lds
    v_cvt_pk_bf16_f32 v104, v104, v105
    v_mfma_f32_16x16x32_bf16 v[188:191], v[88:91], a[140:143], v[188:191]
    v_exp_f32 v112, v112
    v_mfma_f32_16x16x32_bf16 v[184:187], v[80:83], a[140:143], v[184:187]
    ds_read_b64_tr_b16 a[152:153], v30 offset:16384
    ds_read_b64_tr_b16 a[154:155], v30 offset:20480
    v_mfma_f32_16x16x32_bf16 v[180:183], v[72:75], a[140:143], v[180:183]
    s_waitcnt lgkmcnt(4)
    v_exp_f32 v113, v113
    v_mfma_f32_16x16x32_bf16 v[176:179], v[64:67], a[140:143], v[176:179]
    buffer_load_dwordx4 v14, s[32:35], s60 offen offset:2048 lds
    v_cvt_pk_bf16_f32 v105, v106, v107
    v_mfma_f32_16x16x32_bf16 a[228:231], a[240:243], v[72:75], a[228:231]
    v_mfma_f32_16x16x32_bf16 v[192:195], v[64:67], a[144:147], v[192:195]
    v_exp_f32 v114, v114
    v_mfma_f32_16x16x32_bf16 v[196:199], v[72:75], a[144:147], v[196:199]
    ds_read_b64_tr_b16 a[156:157], v31 offset:16384
    ds_read_b64_tr_b16 a[158:159], v31 offset:20480
    v_mfma_f32_16x16x32_bf16 v[200:203], v[80:83], a[144:147], v[200:203]
    s_waitcnt lgkmcnt(4)
    v_exp_f32 v115, v115
    v_mfma_f32_16x16x32_bf16 v[204:207], v[88:91], a[144:147], v[204:207]
    buffer_load_dwordx4 v15, s[32:35], s60 offen offset:3072 lds
    v_cvt_pk_bf16_f32 v112, v112, v113
    v_mfma_f32_16x16x32_bf16 v[220:223], v[88:91], a[148:151], v[220:223]
    v_exp_f32 v120, v120
    v_mfma_f32_16x16x32_bf16 v[216:219], v[80:83], a[148:151], v[216:219]
    ds_read_b64_tr_b16 a[128:129], v24 offset:24576
    ds_read_b64_tr_b16 a[130:131], v24 offset:28672
    v_mfma_f32_16x16x32_bf16 v[212:215], v[72:75], a[148:151], v[212:215]
    s_waitcnt lgkmcnt(4)
    v_exp_f32 v121, v121
    v_mfma_f32_16x16x32_bf16 v[208:211], v[64:67], a[148:151], v[208:211]
    buffer_load_dwordx2 v[40:41], v39, s[88:91], 0 offen offset:0
    v_cvt_pk_bf16_f32 v113, v114, v115
    v_mfma_f32_16x16x32_bf16 a[232:235], a[240:243], v[80:83], a[232:235]
    v_mfma_f32_16x16x32_bf16 v[224:227], v[64:67], a[152:155], v[224:227]
    v_exp_f32 v122, v122
    v_mfma_f32_16x16x32_bf16 v[228:231], v[72:75], a[152:155], v[228:231]
    ds_read_b64_tr_b16 a[132:133], v25 offset:24576
    ds_read_b64_tr_b16 a[134:135], v25 offset:28672
    v_mfma_f32_16x16x32_bf16 v[232:235], v[80:83], a[152:155], v[232:235]
    s_waitcnt lgkmcnt(4)
    v_exp_f32 v123, v123
    v_mfma_f32_16x16x32_bf16 v[236:239], v[88:91], a[152:155], v[236:239]
    buffer_load_dwordx2 v[42:43], v39, s[88:91], 0 offen offset:32
    v_cvt_pk_bf16_f32 v120, v120, v121
    v_mfma_f32_16x16x32_bf16 v[252:255], v[88:91], a[156:159], v[252:255]
    v_exp_f32 v100, v100
    v_mfma_f32_16x16x32_bf16 v[248:251], v[80:83], a[156:159], v[248:251]
    ds_read_b64_tr_b16 a[136:137], v26 offset:24576
    ds_read_b64_tr_b16 a[138:139], v26 offset:28672
    v_mfma_f32_16x16x32_bf16 v[244:247], v[72:75], a[156:159], v[244:247]
    v_exp_f32 v101, v101
    v_mfma_f32_16x16x32_bf16 v[240:243], v[64:67], a[156:159], v[240:243]
    buffer_load_dwordx2 v[44:45], v39, s[88:91], 0 offen offset:64
    v_cvt_pk_bf16_f32 v121, v122, v123
    v_mfma_f32_16x16x32_bf16 a[236:239], a[240:243], v[88:91], a[236:239]
    v_exp_f32 v102, v102
    ds_read_b64_tr_b16 a[140:141], v27 offset:24576
    ds_read_b64_tr_b16 a[142:143], v27 offset:28672
    v_exp_f32 v103, v103
    buffer_load_dwordx2 v[46:47], v39, s[88:91], 0 offen offset:96
    v_cvt_pk_bf16_f32 v98, v100, v101
    v_exp_f32 v108, v108
    ds_read_b64_tr_b16 a[144:145], v28 offset:24576
    v_cvt_pk_bf16_f32 v99, v102, v103
    v_exp_f32 v109, v109
    ds_read_b64_tr_b16 a[146:147], v28 offset:28672
    v_exp_f32 v110, v110
    ds_read_b64_tr_b16 a[148:149], v29 offset:24576
    v_cvt_pk_bf16_f32 v106, v108, v109
    v_exp_f32 v111, v111
    ds_read_b64_tr_b16 a[150:151], v29 offset:28672
    v_exp_f32 v116, v116
    ds_read_b64_tr_b16 a[152:153], v30 offset:24576
    v_cvt_pk_bf16_f32 v107, v110, v111
    v_exp_f32 v117, v117
    ds_read_b64_tr_b16 a[154:155], v30 offset:28672
    v_exp_f32 v118, v118
    ds_read_b64_tr_b16 a[156:157], v31 offset:24576
    v_cvt_pk_bf16_f32 v114, v116, v117
    v_exp_f32 v119, v119
    ds_read_b64_tr_b16 a[158:159], v31 offset:28672
    v_exp_f32 v124, v124
    s_nop 0
    v_cvt_pk_bf16_f32 v115, v118, v119
    v_exp_f32 v125, v125
    s_nop 0
    v_exp_f32 v126, v126
    s_nop 0
    v_cvt_pk_bf16_f32 v122, v124, v125
    v_exp_f32 v127, v127
    s_nop 0
    s_nop 0
    v_cvt_pk_bf16_f32 v123, v126, v127
    s_waitcnt lgkmcnt(14)
    s_nop 0
    s_nop 1
    v_mfma_f32_16x16x32_bf16 a[224:227], a[240:243], v[96:99], a[224:227]
    v_mfma_f32_16x16x32_bf16 a[228:231], a[240:243], v[104:107], a[228:231]
    v_mfma_f32_16x16x32_bf16 a[232:235], a[240:243], v[112:115], a[232:235]
    v_mfma_f32_16x16x32_bf16 a[236:239], a[240:243], v[120:123], a[236:239]
    v_mfma_f32_16x16x32_bf16 v[128:131], v[96:99], a[128:131], v[128:131]
    s_waitcnt lgkmcnt(0)
    s_barrier
    s_add_u32 m0, s59, 65536
    s_mov_b32 s60, 0
    v_mfma_f32_16x16x32_bf16 v[132:135], v[104:107], a[128:131], v[132:135]
    buffer_load_dwordx4 v16, s[20:23], s60 offen offset:0 lds
    v_mfma_f32_16x16x32_bf16 v[136:139], v[112:115], a[128:131], v[136:139]
    v_mfma_f32_16x16x32_bf16 v[140:143], v[120:123], a[128:131], v[140:143]
    v_mfma_f32_16x16x32_bf16 v[156:159], v[120:123], a[132:135], v[156:159]
    v_mfma_f32_16x16x32_bf16 v[152:155], v[112:115], a[132:135], v[152:155]
    buffer_load_dwordx4 v17, s[20:23], s60 offen offset:1024 lds
    v_mfma_f32_16x16x32_bf16 v[148:151], v[104:107], a[132:135], v[148:151]
    v_mfma_f32_16x16x32_bf16 v[144:147], v[96:99], a[132:135], v[144:147]
    v_mfma_f32_16x16x32_bf16 v[160:163], v[96:99], a[136:139], v[160:163]
    v_accvgpr_read_b32 v48, a224
    v_accvgpr_read_b32 v49, a228
    v_mfma_f32_16x16x32_bf16 v[164:167], v[104:107], a[136:139], v[164:167]
    buffer_load_dwordx4 v18, s[20:23], s60 offen offset:2048 lds
    v_accvgpr_read_b32 v50, a232
    v_mfma_f32_16x16x32_bf16 v[168:171], v[112:115], a[136:139], v[168:171]
    v_accvgpr_read_b32 v51, a236
    v_add_f32 v60, v48, v49
    v_mfma_f32_16x16x32_bf16 v[172:175], v[120:123], a[136:139], v[172:175]
    v_add_f32 v61, v50, v51
    v_add_f32 v60, v60, v61
    v_mfma_f32_16x16x32_bf16 v[188:191], v[120:123], a[140:143], v[188:191]
    v_rcp_f32 v52, v48
    v_mfma_f32_16x16x32_bf16 v[184:187], v[112:115], a[140:143], v[184:187]
    buffer_load_dwordx4 v19, s[20:23], s60 offen offset:3072 lds
    v_rcp_f32 v53, v49
    v_mfma_f32_16x16x32_bf16 v[180:183], v[104:107], a[140:143], v[180:183]
    v_rcp_f32 v54, v50
    v_mfma_f32_16x16x32_bf16 v[176:179], v[96:99], a[140:143], v[176:179]
    v_rcp_f32 v55, v51
    v_mfma_f32_16x16x32_bf16 v[192:195], v[96:99], a[144:147], v[192:195]
    s_add_u32 m0, s59, 16384
    s_mov_b32 s60, 128
    v_cmp_nge_f32 vcc, 0x4e800000, v60
    v_subrev_u32 v56, 65536, v4
    v_mfma_f32_16x16x32_bf16 v[196:199], v[104:107], a[144:147], v[196:199]
    buffer_load_dwordx4 v16, s[20:23], s60 offen offset:0 lds
    v_subrev_u32 v57, 65536, v5
    v_mfma_f32_16x16x32_bf16 v[200:203], v[112:115], a[144:147], v[200:203]
    v_subrev_u32 v58, 65536, v6
    v_subrev_u32 v59, 65536, v7
    v_mfma_f32_16x16x32_bf16 v[204:207], v[120:123], a[144:147], v[204:207]
    v_and_b32 v61, 48, v1
    ds_bpermute_b32 v100, v61, v52 offset:0
    v_mfma_f32_16x16x32_bf16 v[220:223], v[120:123], a[148:151], v[220:223]
    ds_bpermute_b32 v101, v61, v52 offset:4
    ds_bpermute_b32 v102, v61, v52 offset:8
    v_mfma_f32_16x16x32_bf16 v[216:219], v[112:115], a[148:151], v[216:219]
    buffer_load_dwordx4 v17, s[20:23], s60 offen offset:1024 lds
    ds_bpermute_b32 v103, v61, v52 offset:12
    v_mfma_f32_16x16x32_bf16 v[212:215], v[104:107], a[148:151], v[212:215]
    ds_bpermute_b32 v108, v61, v53 offset:0
    ds_bpermute_b32 v109, v61, v53 offset:4
    v_mfma_f32_16x16x32_bf16 v[208:211], v[96:99], a[148:151], v[208:211]
    ds_bpermute_b32 v110, v61, v53 offset:8
    ds_bpermute_b32 v111, v61, v53 offset:12
    v_mfma_f32_16x16x32_bf16 v[224:227], v[96:99], a[152:155], v[224:227]
    ds_bpermute_b32 v116, v61, v54 offset:0
    ds_bpermute_b32 v117, v61, v54 offset:4
    v_mfma_f32_16x16x32_bf16 v[228:231], v[104:107], a[152:155], v[228:231]
    buffer_load_dwordx4 v18, s[20:23], s60 offen offset:2048 lds
    ds_bpermute_b32 v118, v61, v54 offset:8
    v_mfma_f32_16x16x32_bf16 v[232:235], v[112:115], a[152:155], v[232:235]
    ds_bpermute_b32 v119, v61, v54 offset:12
    ds_bpermute_b32 v124, v61, v55 offset:0
    v_mfma_f32_16x16x32_bf16 v[236:239], v[120:123], a[152:155], v[236:239]
    ds_bpermute_b32 v125, v61, v55 offset:4
    ds_bpermute_b32 v126, v61, v55 offset:8
    v_mfma_f32_16x16x32_bf16 v[252:255], v[120:123], a[156:159], v[252:255]
    ds_bpermute_b32 v127, v61, v55 offset:12
    v_lshrrev_b32 v63, 4, v1
    v_mfma_f32_16x16x32_bf16 v[248:251], v[112:115], a[156:159], v[248:251]
    buffer_load_dwordx4 v19, s[20:23], s60 offen offset:3072 lds
    v_bfe_u32 v60, v1, 2, 2
    v_mfma_f32_16x16x32_bf16 v[244:247], v[104:107], a[156:159], v[244:247]
    v_xor_b32 v60, v60, v63
    v_and_b32 v62, 15, v1
    v_mfma_f32_16x16x32_bf16 v[240:243], v[96:99], a[156:159], v[240:243]
    v_lshlrev_b32 v62, 5, v62
    v_lshl_add_u32 v62, v60, 3, v62
    v_subrev_u32 v62, 65536, v62
    v_add_u32 v62, s59, v62
    v_xor_b32 v63, v63, v1
    v_lshlrev_b32 v63, 3, v63
    ds_read_b64_tr_b16 v[64:65], v56 offset:0
    ds_read_b64_tr_b16 v[66:67], v56 offset:512
    ds_read_b64_tr_b16 v[68:69], v57 offset:0
    ds_read_b64_tr_b16 v[70:71], v57 offset:512
    ds_read_b64_tr_b16 v[72:73], v58 offset:0
    ds_read_b64_tr_b16 v[74:75], v58 offset:512
    s_waitcnt lgkmcnt(0)
    v_mfma_f32_16x16x32_bf16 a[128:131], v[64:67], a[16:19], 0
    ds_read_b64_tr_b16 v[76:77], v59 offset:0
    v_and_b32 v61, 3, v1
    v_lshlrev_b32 v61, 12, v61
    v_mfma_f32_16x16x32_bf16 a[132:135], v[64:67], a[20:23], 0
    ds_read_b64_tr_b16 v[78:79], v59 offset:512
    v_mul_f32 v128, v128, v100
    v_mul_f32 v129, v129, v101
    v_mfma_f32_16x16x32_bf16 a[136:139], v[64:67], a[24:27], 0
    v_mul_f32 v130, v130, v102
    v_mul_f32 v131, v131, v103
    v_mfma_f32_16x16x32_bf16 a[140:143], v[64:67], a[28:31], 0
    v_mul_f32 v144, v144, v100
    v_mul_f32 v145, v145, v101
    v_mul_f32 v146, v146, v102
    v_mfma_f32_16x16x32_bf16 a[156:159], v[68:71], a[28:31], 0
    ds_read_b64_tr_b16 v[80:81], v56 offset:16384
    v_mul_f32 v147, v147, v103
    v_cvt_pk_bf16_f32 v128, v128, v129
    v_mfma_f32_16x16x32_bf16 a[152:155], v[68:71], a[24:27], 0
    ds_read_b64_tr_b16 v[82:83], v56 offset:16896
    v_cvt_pk_bf16_f32 v129, v130, v131
    v_cvt_pk_bf16_f32 v130, v144, v145
    v_mfma_f32_16x16x32_bf16 a[148:151], v[68:71], a[20:23], 0
    v_cvt_pk_bf16_f32 v131, v146, v147
    s_cbranch_vccz L_nomark
    v_mov_b32 v128, 0x7fc17fc1
L_nomark:
    v_mul_f32 v132, v132, v108
    v_mfma_f32_16x16x32_bf16 a[144:147], v[68:71], a[16:19], 0
    v_mul_f32 v133, v133, v109
    v_mul_f32 v134, v134, v110
    v_mul_f32 v135, v135, v111
    v_mfma_f32_16x16x32_bf16 a[224:227], v[72:75], a[16:19], 0
    ds_read_b64_tr_b16 v[84:85], v57 offset:16384
    v_mul_f32 v148, v148, v108
    v_mul_f32 v149, v149, v109
    v_mfma_f32_16x16x32_bf16 a[228:231], v[72:75], a[20:23], 0
    ds_read_b64_tr_b16 v[86:87], v57 offset:16896
    v_mul_f32 v150, v150, v110
    v_mul_f32 v151, v151, v111
    v_mfma_f32_16x16x32_bf16 a[232:235], v[72:75], a[24:27], 0
    v_cvt_pk_bf16_f32 v132, v132, v133
    v_cvt_pk_bf16_f32 v133, v134, v135
    v_mfma_f32_16x16x32_bf16 a[236:239], v[72:75], a[28:31], 0
    s_waitcnt lgkmcnt(2)
    v_cvt_pk_bf16_f32 v134, v148, v149
    v_cvt_pk_bf16_f32 v135, v150, v151
    v_mul_f32 v136, v136, v116
    v_mfma_f32_16x16x32_bf16 a[252:255], v[76:79], a[28:31], 0
    ds_read_b64_tr_b16 v[88:89], v58 offset:16384
    v_mul_f32 v137, v137, v117
    v_mul_f32 v138, v138, v118
    v_mfma_f32_16x16x32_bf16 a[248:251], v[76:79], a[24:27], 0
    ds_read_b64_tr_b16 v[90:91], v58 offset:16896
    v_mul_f32 v139, v139, v119
    v_mul_f32 v152, v152, v116
    v_mfma_f32_16x16x32_bf16 a[244:247], v[76:79], a[20:23], 0
    v_mul_f32 v153, v153, v117
    v_mul_f32 v154, v154, v118
    v_mul_f32 v155, v155, v119
    v_mfma_f32_16x16x32_bf16 a[240:243], v[76:79], a[16:19], 0
    v_cvt_pk_bf16_f32 v136, v136, v137
    v_cvt_pk_bf16_f32 v137, v138, v139
    v_mfma_f32_16x16x32_bf16 a[128:131], v[80:83], a[48:51], a[128:131]
    ds_read_b64_tr_b16 v[92:93], v59 offset:16384
    v_cvt_pk_bf16_f32 v138, v152, v153
    v_cvt_pk_bf16_f32 v139, v154, v155
    v_mfma_f32_16x16x32_bf16 a[132:135], v[80:83], a[52:55], a[132:135]
    ds_read_b64_tr_b16 v[94:95], v59 offset:16896
    v_mul_f32 v140, v140, v124
    v_mul_f32 v141, v141, v125
    v_mfma_f32_16x16x32_bf16 a[136:139], v[80:83], a[56:59], a[136:139]
    v_mul_f32 v142, v142, v126
    v_mul_f32 v143, v143, v127
    v_mul_f32 v156, v156, v124
    v_mfma_f32_16x16x32_bf16 a[140:143], v[80:83], a[60:63], a[140:143]
    s_waitcnt lgkmcnt(2)
    v_mul_f32 v157, v157, v125
    v_mul_f32 v158, v158, v126
    v_mfma_f32_16x16x32_bf16 a[156:159], v[84:87], a[60:63], a[156:159]
    ds_read_b64_tr_b16 v[64:65], v56 offset:32768
    v_mul_f32 v159, v159, v127
    v_cvt_pk_bf16_f32 v140, v140, v141
    v_mfma_f32_16x16x32_bf16 a[152:155], v[84:87], a[56:59], a[152:155]
    ds_read_b64_tr_b16 v[66:67], v56 offset:33280
    v_cvt_pk_bf16_f32 v141, v142, v143
    v_cvt_pk_bf16_f32 v142, v156, v157
    v_mfma_f32_16x16x32_bf16 a[148:151], v[84:87], a[52:55], a[148:151]
    s_add_u32 s67, s78, 32768
    buffer_load_dwordx4 a[16:19], v2, s[80:83], s67 offen offset:0 sc1
    v_cvt_pk_bf16_f32 v143, v158, v159
    v_mul_f32 v160, v160, v100
    v_mfma_f32_16x16x32_bf16 a[144:147], v[84:87], a[48:51], a[144:147]
    v_mul_f32 v161, v161, v101
    v_mul_f32 v162, v162, v102
    v_mfma_f32_16x16x32_bf16 a[224:227], v[88:91], a[48:51], a[224:227]
    ds_read_b64_tr_b16 v[68:69], v57 offset:32768
    v_mul_f32 v163, v163, v103
    v_mul_f32 v176, v176, v100
    v_mfma_f32_16x16x32_bf16 a[228:231], v[88:91], a[52:55], a[228:231]
    ds_read_b64_tr_b16 v[70:71], v57 offset:33280
    v_mul_f32 v177, v177, v101
    v_mul_f32 v178, v178, v102
    v_mfma_f32_16x16x32_bf16 a[232:235], v[88:91], a[56:59], a[232:235]
    s_add_u32 s67, s78, 32768
    buffer_load_dwordx4 a[20:23], v2, s[80:83], s67 offen offset:1024 sc1
    v_mul_f32 v179, v179, v103
    v_cvt_pk_bf16_f32 v160, v160, v161
    v_mfma_f32_16x16x32_bf16 a[236:239], v[88:91], a[60:63], a[236:239]
    s_waitcnt lgkmcnt(2)
    v_cvt_pk_bf16_f32 v161, v162, v163
    v_cvt_pk_bf16_f32 v162, v176, v177
    v_cvt_pk_bf16_f32 v163, v178, v179
    v_mfma_f32_16x16x32_bf16 a[252:255], v[92:95], a[60:63], a[252:255]
    ds_read_b64_tr_b16 v[72:73], v58 offset:32768
    v_mul_f32 v164, v164, v108
    v_mfma_f32_16x16x32_bf16 a[248:251], v[92:95], a[56:59], a[248:251]
    ds_read_b64_tr_b16 v[74:75], v58 offset:33280
    v_mul_f32 v165, v165, v109
    v_mul_f32 v166, v166, v110
    v_mfma_f32_16x16x32_bf16 a[244:247], v[92:95], a[52:55], a[244:247]
    s_add_u32 s67, s78, 32768
    buffer_load_dwordx4 a[24:27], v2, s[80:83], s67 offen offset:2048 sc1
    v_mul_f32 v167, v167, v111
    v_mul_f32 v180, v180, v108
    v_mfma_f32_16x16x32_bf16 a[240:243], v[92:95], a[48:51], a[240:243]
    v_mul_f32 v181, v181, v109
    v_mul_f32 v182, v182, v110
    v_mul_f32 v183, v183, v111
    v_mfma_f32_16x16x32_bf16 a[128:131], v[64:67], a[80:83], a[128:131]
    ds_read_b64_tr_b16 v[76:77], v59 offset:32768
    v_cvt_pk_bf16_f32 v164, v164, v165
    v_mfma_f32_16x16x32_bf16 a[132:135], v[64:67], a[84:87], a[132:135]
    ds_read_b64_tr_b16 v[78:79], v59 offset:33280
    v_cvt_pk_bf16_f32 v165, v166, v167
    v_cvt_pk_bf16_f32 v166, v180, v181
    v_mfma_f32_16x16x32_bf16 a[136:139], v[64:67], a[88:91], a[136:139]
    s_add_u32 s67, s78, 32768
    buffer_load_dwordx4 a[28:31], v2, s[80:83], s67 offen offset:3072 sc1
    v_cvt_pk_bf16_f32 v167, v182, v183
    v_mul_f32 v168, v168, v116
    v_mfma_f32_16x16x32_bf16 a[140:143], v[64:67], a[92:95], a[140:143]
    s_waitcnt lgkmcnt(2)
    v_mul_f32 v169, v169, v117
    v_mul_f32 v170, v170, v118
    v_mul_f32 v171, v171, v119
    v_mfma_f32_16x16x32_bf16 a[156:159], v[68:71], a[92:95], a[156:159]
    ds_read_b64_tr_b16 v[80:81], v56 offset:49152
    v_mul_f32 v184, v184, v116
    v_mfma_f32_16x16x32_bf16 a[152:155], v[68:71], a[88:91], a[152:155]
    ds_read_b64_tr_b16 v[82:83], v56 offset:49664
    v_mul_f32 v185, v185, v117
    v_mul_f32 v186, v186, v118
    v_mfma_f32_16x16x32_bf16 a[148:151], v[68:71], a[84:87], a[148:151]
    s_add_u32 s67, s78, 36864
    buffer_load_dwordx4 a[48:51], v2, s[80:83], s67 offen offset:0 sc1
    v_mul_f32 v187, v187, v119
    v_cvt_pk_bf16_f32 v168, v168, v169
    v_mfma_f32_16x16x32_bf16 a[144:147], v[68:71], a[80:83], a[144:147]
    v_cvt_pk_bf16_f32 v169, v170, v171
    v_cvt_pk_bf16_f32 v170, v184, v185
    v_cvt_pk_bf16_f32 v171, v186, v187
    v_mfma_f32_16x16x32_bf16 a[224:227], v[72:75], a[80:83], a[224:227]
    ds_read_b64_tr_b16 v[84:85], v57 offset:49152
    v_mul_f32 v172, v172, v124
    v_mul_f32 v173, v173, v125
    v_mfma_f32_16x16x32_bf16 a[228:231], v[72:75], a[84:87], a[228:231]
    ds_read_b64_tr_b16 v[86:87], v57 offset:49664
    v_mul_f32 v174, v174, v126
    v_mfma_f32_16x16x32_bf16 a[232:235], v[72:75], a[88:91], a[232:235]
    s_add_u32 s67, s78, 36864
    buffer_load_dwordx4 a[52:55], v2, s[80:83], s67 offen offset:1024 sc1
    v_mul_f32 v175, v175, v127
    v_mul_f32 v188, v188, v124
    v_mfma_f32_16x16x32_bf16 a[236:239], v[72:75], a[92:95], a[236:239]
    s_waitcnt lgkmcnt(2)
    v_mul_f32 v189, v189, v125
    v_mul_f32 v190, v190, v126
    v_mul_f32 v191, v191, v127
    v_mfma_f32_16x16x32_bf16 a[252:255], v[76:79], a[92:95], a[252:255]
    ds_read_b64_tr_b16 v[88:89], v58 offset:49152
    v_cvt_pk_bf16_f32 v172, v172, v173
    v_cvt_pk_bf16_f32 v173, v174, v175
    v_mfma_f32_16x16x32_bf16 a[248:251], v[76:79], a[88:91], a[248:251]
    ds_read_b64_tr_b16 v[90:91], v58 offset:49664
    v_cvt_pk_bf16_f32 v174, v188, v189
    v_mfma_f32_16x16x32_bf16 a[244:247], v[76:79], a[84:87], a[244:247]
    ds_write_b64 v62, v[128:129] offset:0
    ds_write_b64 v62, v[130:131] offset:512
    s_add_u32 s67, s78, 36864
    buffer_load_dwordx4 a[56:59], v2, s[80:83], s67 offen offset:2048 sc1
    v_cvt_pk_bf16_f32 v175, v190, v191
    v_mfma_f32_16x16x32_bf16 a[240:243], v[76:79], a[80:83], a[240:243]
    v_mul_f32 v192, v192, v100
    v_mul_f32 v193, v193, v101
    v_mul_f32 v194, v194, v102
    v_mfma_f32_16x16x32_bf16 a[128:131], v[80:83], a[112:115], a[128:131]
    ds_read_b64_tr_b16 v[92:93], v59 offset:49152
    v_mul_f32 v195, v195, v103
    v_mul_f32 v208, v208, v100
    v_mfma_f32_16x16x32_bf16 a[132:135], v[80:83], a[116:119], a[132:135]
    ds_read_b64_tr_b16 v[94:95], v59 offset:49664
    v_mul_f32 v209, v209, v101
    v_mfma_f32_16x16x32_bf16 a[136:139], v[80:83], a[120:123], a[136:139]
    ds_write_b64 v62, v[132:133] offset:1024
    ds_write_b64 v62, v[134:135] offset:1536
    s_add_u32 s67, s78, 36864
    buffer_load_dwordx4 a[60:63], v2, s[80:83], s67 offen offset:3072 sc1
    v_mul_f32 v210, v210, v102
    v_mfma_f32_16x16x32_bf16 a[140:143], v[80:83], a[124:127], a[140:143]
    s_waitcnt vmcnt(32) lgkmcnt(6)
    v_mul_f32 v211, v211, v103
    v_cvt_pk_bf16_f32 v192, v192, v193
    v_cvt_pk_bf16_f32 v193, v194, v195
    v_mfma_f32_16x16x32_bf16 a[156:159], v[84:87], a[124:127], a[156:159]
    ds_read_b64_tr_b16 v[64:65], v8 offset:32768
    v_cvt_pk_bf16_f32 v194, v208, v209
    v_cvt_pk_bf16_f32 v195, v210, v211
    v_mfma_f32_16x16x32_bf16 a[152:155], v[84:87], a[120:123], a[152:155]
    ds_read_b64_tr_b16 v[66:67], v8 offset:33280
    v_mul_f32 v196, v196, v108
    v_mul_f32 v197, v197, v109
    v_mfma_f32_16x16x32_bf16 a[148:151], v[84:87], a[116:119], a[148:151]
    ds_write_b64 v62, v[136:137] offset:2048
    ds_write_b64 v62, v[138:139] offset:2560
    s_add_u32 s67, s78, 40960
    buffer_load_dwordx4 a[80:83], v2, s[80:83], s67 offen offset:0 sc1
    v_mfma_f32_16x16x32_bf16 a[144:147], v[84:87], a[112:115], a[144:147]
    v_mul_f32 v198, v198, v110
    v_mul_f32 v199, v199, v111
    v_mul_f32 v212, v212, v108
    v_mfma_f32_16x16x32_bf16 a[224:227], v[88:91], a[112:115], a[224:227]
    ds_read_b64_tr_b16 v[68:69], v9 offset:32768
    v_mul_f32 v213, v213, v109
    v_mul_f32 v214, v214, v110
    v_mfma_f32_16x16x32_bf16 a[228:231], v[88:91], a[116:119], a[228:231]
    ds_read_b64_tr_b16 v[70:71], v9 offset:33280
    v_mul_f32 v215, v215, v111
    v_cvt_pk_bf16_f32 v196, v196, v197
    v_mfma_f32_16x16x32_bf16 a[232:235], v[88:91], a[120:123], a[232:235]
    ds_write_b64 v62, v[140:141] offset:3072
    ds_write_b64 v62, v[142:143] offset:3584
    s_add_u32 s67, s78, 40960
    buffer_load_dwordx4 a[84:87], v2, s[80:83], s67 offen offset:1024 sc1
    v_mfma_f32_16x16x32_bf16 a[236:239], v[88:91], a[124:127], a[236:239]
    s_waitcnt lgkmcnt(6)
    v_cvt_pk_bf16_f32 v197, v198, v199
    v_cvt_pk_bf16_f32 v198, v212, v213
    v_cvt_pk_bf16_f32 v199, v214, v215
    v_mfma_f32_16x16x32_bf16 a[252:255], v[92:95], a[124:127], a[252:255]
    ds_read_b64_tr_b16 v[72:73], v10 offset:32768
    v_mul_f32 v200, v200, v116
    v_mul_f32 v201, v201, v117
    v_mfma_f32_16x16x32_bf16 a[248:251], v[92:95], a[120:123], a[248:251]
    ds_read_b64_tr_b16 v[74:75], v10 offset:33280
    v_mul_f32 v202, v202, v118
    v_mul_f32 v203, v203, v119
    v_mfma_f32_16x16x32_bf16 a[244:247], v[92:95], a[116:119], a[244:247]
    ds_write_b64 v62, v[160:161] offset:16384
    ds_write_b64 v62, v[162:163] offset:16896
    s_add_u32 s67, s78, 40960
    buffer_load_dwordx4 a[88:91], v2, s[80:83], s67 offen offset:2048 sc1
    v_mfma_f32_16x16x32_bf16 a[240:243], v[92:95], a[112:115], a[240:243]
    v_mul_f32 v216, v216, v116
    v_mul_f32 v217, v217, v117
    v_mul_f32 v218, v218, v118
    v_mfma_f32_16x16x32_bf16 a[128:131], v[64:67], a[160:163], a[128:131]
    ds_read_b64_tr_b16 v[76:77], v11 offset:32768
    v_mul_f32 v219, v219, v119
    v_cvt_pk_bf16_f32 v200, v200, v201
    v_mfma_f32_16x16x32_bf16 a[132:135], v[64:67], a[164:167], a[132:135]
    ds_read_b64_tr_b16 v[78:79], v11 offset:33280
    v_cvt_pk_bf16_f32 v201, v202, v203
    v_cvt_pk_bf16_f32 v202, v216, v217
    v_mfma_f32_16x16x32_bf16 a[136:139], v[64:67], a[168:171], a[136:139]
    ds_write_b64 v62, v[164:165] offset:17408
    ds_write_b64 v62, v[166:167] offset:17920
    s_add_u32 s67, s78, 40960
    buffer_load_dwordx4 a[92:95], v2, s[80:83], s67 offen offset:3072 sc1
    v_cvt_pk_bf16_f32 v203, v218, v219
    v_mfma_f32_16x16x32_bf16 a[140:143], v[64:67], a[172:175], a[140:143]
    s_waitcnt vmcnt(32) lgkmcnt(6)
    v_mul_f32 v204, v204, v124
    v_mul_f32 v205, v205, v125
    v_mfma_f32_16x16x32_bf16 a[156:159], v[68:71], a[172:175], a[156:159]
    ds_read_b64_tr_b16 v[80:81], v4 offset:0
    v_mul_f32 v206, v206, v126
    v_mul_f32 v207, v207, v127
    v_mfma_f32_16x16x32_bf16 a[152:155], v[68:71], a[168:171], a[152:155]
    ds_read_b64_tr_b16 v[82:83], v4 offset:512
    v_mul_f32 v220, v220, v124
    v_mul_f32 v221, v221, v125
    v_mfma_f32_16x16x32_bf16 a[148:151], v[68:71], a[164:167], a[148:151]
    ds_write_b64 v62, v[168:169] offset:18432
    ds_write_b64 v62, v[170:171] offset:18944
    s_add_u32 s67, s78, 45056
    buffer_load_dwordx4 a[112:115], v2, s[80:83], s67 offen offset:0 sc1
    v_mul_f32 v222, v222, v126
    v_mfma_f32_16x16x32_bf16 a[144:147], v[68:71], a[160:163], a[144:147]
    v_mul_f32 v223, v223, v127
    v_cvt_pk_bf16_f32 v204, v204, v205
    v_mfma_f32_16x16x32_bf16 a[224:227], v[72:75], a[160:163], a[224:227]
    ds_read_b64_tr_b16 v[84:85], v5 offset:0
    v_cvt_pk_bf16_f32 v205, v206, v207
    v_cvt_pk_bf16_f32 v206, v220, v221
    v_mfma_f32_16x16x32_bf16 a[228:231], v[72:75], a[164:167], a[228:231]
    ds_read_b64_tr_b16 v[86:87], v5 offset:512
    v_cvt_pk_bf16_f32 v207, v222, v223
    v_mul_f32 v224, v224, v100
    v_mfma_f32_16x16x32_bf16 a[232:235], v[72:75], a[168:171], a[232:235]
    ds_write_b64 v62, v[172:173] offset:19456
    ds_write_b64 v62, v[174:175] offset:19968
    s_add_u32 s67, s78, 45056
    buffer_load_dwordx4 a[116:119], v2, s[80:83], s67 offen offset:1024 sc1
    v_mul_f32 v225, v225, v101
    v_mfma_f32_16x16x32_bf16 a[236:239], v[72:75], a[172:175], a[236:239]
    s_waitcnt lgkmcnt(6)
    v_mul_f32 v226, v226, v102
    v_mul_f32 v227, v227, v103
    v_mfma_f32_16x16x32_bf16 a[252:255], v[76:79], a[172:175], a[252:255]
    ds_read_b64_tr_b16 v[88:89], v6 offset:0
    v_mul_f32 v240, v240, v100
    v_mul_f32 v241, v241, v101
    v_mfma_f32_16x16x32_bf16 a[248:251], v[76:79], a[168:171], a[248:251]
    ds_read_b64_tr_b16 v[90:91], v6 offset:512
    v_mul_f32 v242, v242, v102
    v_mul_f32 v243, v243, v103
    v_mfma_f32_16x16x32_bf16 a[244:247], v[76:79], a[164:167], a[244:247]
    ds_write_b64 v62, v[192:193] offset:32768
    ds_write_b64 v62, v[194:195] offset:33280
    s_add_u32 s67, s78, 45056
    buffer_load_dwordx4 a[120:123], v2, s[80:83], s67 offen offset:2048 sc1
    v_cvt_pk_bf16_f32 v224, v224, v225
    v_mfma_f32_16x16x32_bf16 a[240:243], v[76:79], a[160:163], a[240:243]
    v_cvt_pk_bf16_f32 v225, v226, v227
    v_cvt_pk_bf16_f32 v226, v240, v241
    v_cvt_pk_bf16_f32 v227, v242, v243
    v_mfma_f32_16x16x32_bf16 a[128:131], v[80:83], a[176:179], a[128:131]
    ds_read_b64_tr_b16 v[92:93], v7 offset:0
    v_mul_f32 v228, v228, v108
    v_mfma_f32_16x16x32_bf16 a[132:135], v[80:83], a[180:183], a[132:135]
    ds_read_b64_tr_b16 v[94:95], v7 offset:512
    v_mul_f32 v229, v229, v109
    v_mul_f32 v230, v230, v110
    v_mfma_f32_16x16x32_bf16 a[136:139], v[80:83], a[184:187], a[136:139]
    s_add_u32 m0, s59, 81920
    s_mov_b32 s60, 32768
    ds_write_b64 v62, v[196:197] offset:33792
    ds_write_b64 v62, v[198:199] offset:34304
    s_add_u32 s67, s78, 45056
    buffer_load_dwordx4 a[124:127], v2, s[80:83], s67 offen offset:3072 sc1
    v_mul_f32 v231, v231, v111
    v_mfma_f32_16x16x32_bf16 a[140:143], v[80:83], a[188:191], a[140:143]
    s_waitcnt vmcnt(32) lgkmcnt(6)
    buffer_load_dwordx4 v16, s[20:23], s60 offen offset:0 lds
    v_mul_f32 v244, v244, v108
    v_mul_f32 v245, v245, v109
    v_mfma_f32_16x16x32_bf16 a[156:159], v[84:87], a[188:191], a[156:159]
    ds_read_b64_tr_b16 v[64:65], v4 offset:32768
    v_mul_f32 v246, v246, v110
    v_mfma_f32_16x16x32_bf16 a[152:155], v[84:87], a[184:187], a[152:155]
    ds_read_b64_tr_b16 v[66:67], v4 offset:33280
    v_mul_f32 v247, v247, v111
    v_cvt_pk_bf16_f32 v228, v228, v229
    v_mfma_f32_16x16x32_bf16 a[148:151], v[84:87], a[180:183], a[148:151]
    ds_write_b64 v62, v[200:201] offset:34816
    ds_write_b64 v62, v[202:203] offset:35328
    s_add_u32 s67, s78, 49152
    buffer_load_dwordx4 a[160:163], v2, s[80:83], s67 offen offset:0 sc1
    v_cvt_pk_bf16_f32 v229, v230, v231
    v_mfma_f32_16x16x32_bf16 a[144:147], v[84:87], a[176:179], a[144:147]
    buffer_load_dwordx4 v17, s[20:23], s60 offen offset:1024 lds
    v_cvt_pk_bf16_f32 v230, v244, v245
    v_cvt_pk_bf16_f32 v231, v246, v247
    v_mfma_f32_16x16x32_bf16 a[224:227], v[88:91], a[176:179], a[224:227]
    ds_read_b64_tr_b16 v[68:69], v5 offset:32768
    v_mul_f32 v232, v232, v116
    v_mfma_f32_16x16x32_bf16 a[228:231], v[88:91], a[180:183], a[228:231]
    ds_read_b64_tr_b16 v[70:71], v5 offset:33280
    v_mul_f32 v233, v233, v117
    v_mul_f32 v234, v234, v118
    v_mfma_f32_16x16x32_bf16 a[232:235], v[88:91], a[184:187], a[232:235]
    ds_write_b64 v62, v[204:205] offset:35840
    ds_write_b64 v62, v[206:207] offset:36352
    s_add_u32 s67, s78, 49152
    buffer_load_dwordx4 a[164:167], v2, s[80:83], s67 offen offset:1024 sc1
    v_mul_f32 v235, v235, v119
    v_mfma_f32_16x16x32_bf16 a[236:239], v[88:91], a[188:191], a[236:239]
    s_waitcnt lgkmcnt(6)
    buffer_load_dwordx4 v18, s[20:23], s60 offen offset:2048 lds
    v_mul_f32 v248, v248, v116
    v_mul_f32 v249, v249, v117
    v_mfma_f32_16x16x32_bf16 a[252:255], v[92:95], a[188:191], a[252:255]
    ds_read_b64_tr_b16 v[72:73], v6 offset:32768
    v_mul_f32 v250, v250, v118
    v_mul_f32 v251, v251, v119
    v_mfma_f32_16x16x32_bf16 a[248:251], v[92:95], a[184:187], a[248:251]
    ds_read_b64_tr_b16 v[74:75], v6 offset:33280
    v_cvt_pk_bf16_f32 v232, v232, v233
    v_mfma_f32_16x16x32_bf16 a[244:247], v[92:95], a[180:183], a[244:247]
    ds_write_b64 v62, v[224:225] offset:49152
    ds_write_b64 v62, v[226:227] offset:49664
    s_add_u32 s67, s78, 49152
    buffer_load_dwordx4 a[168:171], v2, s[80:83], s67 offen offset:2048 sc1
    v_cvt_pk_bf16_f32 v233, v234, v235
    v_mfma_f32_16x16x32_bf16 a[240:243], v[92:95], a[176:179], a[240:243]
    buffer_load_dwordx4 v19, s[20:23], s60 offen offset:3072 lds
    v_cvt_pk_bf16_f32 v234, v248, v249
    v_cvt_pk_bf16_f32 v235, v250, v251
    v_mfma_f32_16x16x32_bf16 a[128:131], v[64:67], a[192:195], a[128:131]
    ds_read_b64_tr_b16 v[76:77], v7 offset:32768
    v_mul_f32 v236, v236, v124
    v_mul_f32 v237, v237, v125
    v_mfma_f32_16x16x32_bf16 a[132:135], v[64:67], a[196:199], a[132:135]
    ds_read_b64_tr_b16 v[78:79], v7 offset:33280
    v_mul_f32 v238, v238, v126
    v_mfma_f32_16x16x32_bf16 a[136:139], v[64:67], a[200:203], a[136:139]
    s_add_u32 m0, s59, 0
    s_mov_b32 s60, 32896
    ds_write_b64 v62, v[228:229] offset:50176
    ds_write_b64 v62, v[230:231] offset:50688
    s_add_u32 s67, s78, 49152
    buffer_load_dwordx4 a[172:175], v2, s[80:83], s67 offen offset:3072 sc1
    v_mul_f32 v239, v239, v127
    v_mfma_f32_16x16x32_bf16 a[140:143], v[64:67], a[204:207], a[140:143]
    s_waitcnt vmcnt(36) lgkmcnt(6)
    buffer_load_dwordx4 v16, s[20:23], s60 offen offset:0 lds
    v_mul_f32 v252, v252, v124
    v_mul_f32 v253, v253, v125
    v_mfma_f32_16x16x32_bf16 a[156:159], v[68:71], a[204:207], a[156:159]
    ds_read_b64_tr_b16 v[80:81], v8 offset:0
    v_mul_f32 v254, v254, v126
    v_mul_f32 v255, v255, v127
    v_mfma_f32_16x16x32_bf16 a[152:155], v[68:71], a[200:203], a[152:155]
    ds_read_b64_tr_b16 v[82:83], v8 offset:512
    v_cvt_pk_bf16_f32 v236, v236, v237
    v_mfma_f32_16x16x32_bf16 a[148:151], v[68:71], a[196:199], a[148:151]
    ds_write_b64 v62, v[232:233] offset:51200
    ds_write_b64 v62, v[234:235] offset:51712
    s_add_u32 s67, s78, 53248
    buffer_load_dwordx4 a[176:179], v2, s[80:83], s67 offen offset:0 sc1
    v_cvt_pk_bf16_f32 v237, v238, v239
    v_mfma_f32_16x16x32_bf16 a[144:147], v[68:71], a[192:195], a[144:147]
    buffer_load_dwordx4 v17, s[20:23], s60 offen offset:1024 lds
    v_cvt_pk_bf16_f32 v238, v252, v253
    v_cvt_pk_bf16_f32 v239, v254, v255
    v_mfma_f32_16x16x32_bf16 a[224:227], v[72:75], a[192:195], a[224:227]
    ds_read_b64_tr_b16 v[84:85], v9 offset:0
    v_mfma_f32_16x16x32_bf16 a[228:231], v[72:75], a[196:199], a[228:231]
    ds_read_b64_tr_b16 v[86:87], v9 offset:512
    v_mfma_f32_16x16x32_bf16 a[232:235], v[72:75], a[200:203], a[232:235]
    ds_write_b64 v62, v[236:237] offset:52224
    ds_write_b64 v62, v[238:239] offset:52736
    s_add_u32 s67, s78, 53248
    buffer_load_dwordx4 a[180:183], v2, s[80:83], s67 offen offset:1024 sc1
    v_mfma_f32_16x16x32_bf16 a[236:239], v[72:75], a[204:207], a[236:239]
    s_waitcnt lgkmcnt(6)
    buffer_load_dwordx4 v18, s[20:23], s60 offen offset:2048 lds
    v_mfma_f32_16x16x32_bf16 a[252:255], v[76:79], a[204:207], a[252:255]
    ds_read_b64_tr_b16 v[88:89], v10 offset:0
    v_mfma_f32_16x16x32_bf16 a[248:251], v[76:79], a[200:203], a[248:251]
    ds_read_b64_tr_b16 v[90:91], v10 offset:512
    v_mfma_f32_16x16x32_bf16 a[244:247], v[76:79], a[196:199], a[244:247]
    s_add_u32 s67, s78, 53248
    buffer_load_dwordx4 a[184:187], v2, s[80:83], s67 offen offset:2048 sc1
    v_mfma_f32_16x16x32_bf16 a[240:243], v[76:79], a[192:195], a[240:243]
    buffer_load_dwordx4 v19, s[20:23], s60 offen offset:3072 lds
    v_mfma_f32_16x16x32_bf16 a[128:131], v[80:83], a[208:211], a[128:131]
    ds_read_b64_tr_b16 v[92:93], v11 offset:0
    v_mfma_f32_16x16x32_bf16 a[132:135], v[80:83], a[212:215], a[132:135]
    ds_read_b64_tr_b16 v[94:95], v11 offset:512
    v_mfma_f32_16x16x32_bf16 a[136:139], v[80:83], a[216:219], a[136:139]
    s_add_u32 m0, s59, 32768
    s_mov_b32 s60, 65536
    s_add_u32 s67, s78, 53248
    buffer_load_dwordx4 a[188:191], v2, s[80:83], s67 offen offset:3072 sc1
    v_mfma_f32_16x16x32_bf16 a[140:143], v[80:83], a[220:223], a[140:143]
    s_waitcnt lgkmcnt(6)
    buffer_load_dwordx4 v16, s[20:23], s60 offen offset:0 lds
    v_mfma_f32_16x16x32_bf16 a[156:159], v[84:87], a[220:223], a[156:159]
    s_waitcnt vmcnt(37)
    ds_read_b64_tr_b16 v[64:65], v8 offset:16384
    s_waitcnt lgkmcnt(0)
    s_barrier
    ds_read_b32 v60, v61 offset:0
    v_mfma_f32_16x16x32_bf16 a[152:155], v[84:87], a[216:219], a[152:155]
    ds_read_b64_tr_b16 v[66:67], v8 offset:16896
    ds_read_b64_tr_b16 v[96:97], v63 offset:0
    ds_read_b64_tr_b16 v[98:99], v63 offset:512
    v_mfma_f32_16x16x32_bf16 a[148:151], v[84:87], a[212:215], a[148:151]
    ds_read_b64_tr_b16 v[100:101], v63 offset:1024
    ds_read_b64_tr_b16 v[102:103], v63 offset:1536
    v_mfma_f32_16x16x32_bf16 a[144:147], v[84:87], a[208:211], a[144:147]
    buffer_load_dwordx4 v17, s[20:23], s60 offen offset:1024 lds
    v_mfma_f32_16x16x32_bf16 a[224:227], v[88:91], a[208:211], a[224:227]
    ds_read_b64_tr_b16 v[68:69], v9 offset:16384
    ds_read_b64_tr_b16 v[104:105], v63 offset:2048
    ds_read_b64_tr_b16 v[106:107], v63 offset:2560
    v_mfma_f32_16x16x32_bf16 a[228:231], v[88:91], a[212:215], a[228:231]
    ds_read_b64_tr_b16 v[70:71], v9 offset:16896
    v_mfma_f32_16x16x32_bf16 a[232:235], v[88:91], a[216:219], a[232:235]
    ds_read_b64_tr_b16 v[108:109], v63 offset:3072
    ds_read_b64_tr_b16 v[110:111], v63 offset:3584
    v_mfma_f32_16x16x32_bf16 a[236:239], v[88:91], a[220:223], a[236:239]
    buffer_load_dwordx4 v18, s[20:23], s60 offen offset:2048 lds
    v_mfma_f32_16x16x32_bf16 a[252:255], v[92:95], a[220:223], a[252:255]
    ds_read_b64_tr_b16 v[72:73], v10 offset:16384
    v_mfma_f32_16x16x32_bf16 a[248:251], v[92:95], a[216:219], a[248:251]
    ds_read_b64_tr_b16 v[74:75], v10 offset:16896
    v_mfma_f32_16x16x32_bf16 a[244:247], v[92:95], a[212:215], a[244:247]
    s_waitcnt lgkmcnt(2)
    v_cmp_eq_u32 vcc, 0x7fc17fc1, v60
    s_cmp_lg_u32 s64, 0
    s_cbranch_scc1 L_nofb
    s_nop 1
    s_cbranch_vccnz L_fallback
L_nofb:
    v_mfma_f32_16x16x32_bf16 a[240:243], v[92:95], a[208:211], a[240:243]
    buffer_load_dwordx4 v19, s[20:23], s60 offen offset:3072 lds
    v_mfma_f32_16x16x32_bf16 v[128:131], v[64:67], v[96:99], 0
    ds_read_b64_tr_b16 v[76:77], v11 offset:16384
    v_mfma_f32_16x16x32_bf16 v[132:135], v[64:67], v[100:103], 0
    ds_read_b64_tr_b16 v[78:79], v11 offset:16896
    v_mfma_f32_16x16x32_bf16 v[136:139], v[64:67], v[104:107], 0
    s_add_u32 m0, s59, 49152
    s_mov_b32 s60, 65664
    v_mfma_f32_16x16x32_bf16 v[140:143], v[64:67], v[108:111], 0
    buffer_load_dwordx4 v16, s[20:23], s60 offen offset:0 lds
    v_mfma_f32_16x16x32_bf16 v[156:159], v[68:71], v[108:111], 0
    s_waitcnt vmcnt(37)
    ds_read_b64_tr_b16 v[80:81], v4 offset:16384
    v_mfma_f32_16x16x32_bf16 v[152:155], v[68:71], v[104:107], 0
    ds_read_b64_tr_b16 v[82:83], v4 offset:16896
    v_mfma_f32_16x16x32_bf16 v[148:151], v[68:71], v[100:103], 0
    ds_read_b64_tr_b16 v[112:113], v63 offset:16384
    ds_read_b64_tr_b16 v[114:115], v63 offset:16896
    v_mfma_f32_16x16x32_bf16 v[144:147], v[68:71], v[96:99], 0
    s_waitcnt lgkmcnt(6)
    buffer_load_dwordx4 v17, s[20:23], s60 offen offset:1024 lds
    v_mfma_f32_16x16x32_bf16 v[160:163], v[72:75], v[96:99], 0
    ds_read_b64_tr_b16 v[84:85], v5 offset:16384
    v_and_b32 v48, 15, v1
    s_lshl_b32 s55, s54, 4
    v_mfma_f32_16x16x32_bf16 v[164:167], v[72:75], v[100:103], 0
    ds_read_b64_tr_b16 v[86:87], v5 offset:16896
    v_add_u32 v48, s55, v48
    v_mfma_f32_16x16x32_bf16 v[168:171], v[72:75], v[104:107], 0
    ds_read_b64_tr_b16 v[116:117], v63 offset:17408
    ds_read_b64_tr_b16 v[118:119], v63 offset:17920
    v_lshlrev_b32 v48, 10, v48
    v_mfma_f32_16x16x32_bf16 v[172:175], v[72:75], v[108:111], 0
    s_waitcnt lgkmcnt(8)
    buffer_load_dwordx4 v18, s[20:23], s60 offen offset:2048 lds
    v_lshrrev_b32 v59, 4, v1
    v_mfma_f32_16x16x32_bf16 v[188:191], v[76:79], v[108:111], 0
    ds_read_b64_tr_b16 v[88:89], v6 offset:16384
    v_lshl_add_u32 v48, v59, 3, v48
    s_lshl_b32 s55, s77, 7
    v_mfma_f32_16x16x32_bf16 v[184:187], v[76:79], v[104:107], 0
    ds_read_b64_tr_b16 v[90:91], v6 offset:16896
    v_add_u32 v48, s55, v48
    v_mfma_f32_16x16x32_bf16 v[180:183], v[76:79], v[100:103], 0
    ds_read_b64_tr_b16 v[120:121], v63 offset:18432
    ds_read_b64_tr_b16 v[122:123], v63 offset:18944
    v_and_b32 v51, 7, v1
    v_mfma_f32_16x16x32_bf16 v[176:179], v[76:79], v[96:99], 0
    s_waitcnt lgkmcnt(10)
    buffer_load_dwordx4 v19, s[20:23], s60 offen offset:3072 lds
    v_lshlrev_b32 v51, 2, v51
    v_mfma_f32_16x16x32_bf16 v[192:195], v[80:83], v[96:99], 0
    ds_read_b64_tr_b16 v[92:93], v7 offset:16384
    v_add_u32 v50, s59, v2
    s_lshl_b32 s55, s54, 14
    s_add_u32 s55, s55, 65536
    v_mfma_f32_16x16x32_bf16 v[196:199], v[80:83], v[100:103], 0
    ds_read_b64_tr_b16 v[94:95], v7 offset:16896
    v_add_u32 v55, s55, v2
    s_lshl_b32 s58, s54, 4
    s_add_u32 s58, s58, s52
    s_lshl_b32 s58, s58, 13
    v_mfma_f32_16x16x32_bf16 v[200:203], v[80:83], v[104:107], 0
    s_add_u32 m0, s59, 65536
    s_mov_b32 s60, 98304
    ds_read_b64_tr_b16 v[124:125], v63 offset:19456
    ds_read_b64_tr_b16 v[126:127], v63 offset:19968
    v_mfma_f32_16x16x32_bf16 v[204:207], v[80:83], v[108:111], 0
    s_waitcnt lgkmcnt(10)
    buffer_load_dwordx4 v16, s[20:23], s60 offen offset:0 lds
    v_mfma_f32_16x16x32_bf16 v[220:223], v[84:87], v[108:111], 0
    s_waitcnt vmcnt(18)
    ds_read_b64_tr_b16 v[64:65], v8 offset:32768
    v_mfma_f32_16x16x32_bf16 v[216:219], v[84:87], v[104:107], 0
    ds_read_b64_tr_b16 v[66:67], v8 offset:33280
    v_mfma_f32_16x16x32_bf16 v[212:215], v[84:87], v[100:103], 0
    v_mfma_f32_16x16x32_bf16 v[208:211], v[84:87], v[96:99], 0
    s_waitcnt lgkmcnt(8)
    buffer_load_dwordx4 v17, s[20:23], s60 offen offset:1024 lds
    v_mfma_f32_16x16x32_bf16 v[224:227], v[88:91], v[96:99], 0
    ds_read_b64_tr_b16 v[68:69], v9 offset:32768
    v_mfma_f32_16x16x32_bf16 v[228:231], v[88:91], v[100:103], 0
    ds_read_b64_tr_b16 v[70:71], v9 offset:33280
    v_mfma_f32_16x16x32_bf16 v[232:235], v[88:91], v[104:107], 0
    v_mfma_f32_16x16x32_bf16 v[236:239], v[88:91], v[108:111], 0
    s_waitcnt lgkmcnt(6)
    buffer_load_dwordx4 v18, s[20:23], s60 offen offset:2048 lds
    v_mfma_f32_16x16x32_bf16 v[252:255], v[92:95], v[108:111], 0
    ds_read_b64_tr_b16 v[72:73], v10 offset:32768
    v_mfma_f32_16x16x32_bf16 v[248:251], v[92:95], v[104:107], 0
    ds_read_b64_tr_b16 v[74:75], v10 offset:33280
    v_mfma_f32_16x16x32_bf16 v[244:247], v[92:95], v[100:103], 0
    v_mfma_f32_16x16x32_bf16 v[240:243], v[92:95], v[96:99], 0
    s_waitcnt lgkmcnt(4)
    buffer_load_dwordx4 v19, s[20:23], s60 offen offset:3072 lds
    v_mfma_f32_16x16x32_bf16 v[128:131], v[64:67], v[112:115], v[128:131]
    ds_read_b64_tr_b16 v[76:77], v11 offset:32768
    v_mfma_f32_16x16x32_bf16 v[132:135], v[64:67], v[116:119], v[132:135]
    ds_read_b64_tr_b16 v[78:79], v11 offset:33280
    v_mfma_f32_16x16x32_bf16 v[136:139], v[64:67], v[120:123], v[136:139]
    s_add_u32 m0, s59, 16384
    s_mov_b32 s60, 98432
    v_mfma_f32_16x16x32_bf16 v[140:143], v[64:67], v[124:127], v[140:143]
    s_waitcnt lgkmcnt(4)
    buffer_load_dwordx4 v16, s[20:23], s60 offen offset:0 lds
    v_mfma_f32_16x16x32_bf16 v[156:159], v[68:71], v[124:127], v[156:159]
    s_waitcnt vmcnt(14)
    ds_read_b64_tr_b16 v[80:81], v4 offset:0
    v_mfma_f32_16x16x32_bf16 v[152:155], v[68:71], v[120:123], v[152:155]
    ds_read_b64_tr_b16 v[82:83], v4 offset:512
    v_mfma_f32_16x16x32_bf16 v[148:151], v[68:71], v[116:119], v[148:151]
    ds_read_b64_tr_b16 v[96:97], v63 offset:32768
    ds_read_b64_tr_b16 v[98:99], v63 offset:33280
    v_mfma_f32_16x16x32_bf16 v[144:147], v[68:71], v[112:115], v[144:147]
    s_waitcnt lgkmcnt(6)
    buffer_load_dwordx4 v17, s[20:23], s60 offen offset:1024 lds
    v_mfma_f32_16x16x32_bf16 v[160:163], v[72:75], v[112:115], v[160:163]
    ds_read_b64_tr_b16 v[84:85], v5 offset:0
    v_mfma_f32_16x16x32_bf16 v[164:167], v[72:75], v[116:119], v[164:167]
    ds_read_b64_tr_b16 v[86:87], v5 offset:512
    v_mfma_f32_16x16x32_bf16 v[168:171], v[72:75], v[120:123], v[168:171]
    ds_read_b64_tr_b16 v[100:101], v63 offset:33792
    ds_read_b64_tr_b16 v[102:103], v63 offset:34304
    v_mfma_f32_16x16x32_bf16 v[172:175], v[72:75], v[124:127], v[172:175]
    s_waitcnt lgkmcnt(8)
    buffer_load_dwordx4 v18, s[20:23], s60 offen offset:2048 lds
    v_mfma_f32_16x16x32_bf16 v[188:191], v[76:79], v[124:127], v[188:191]
    ds_read_b64_tr_b16 v[88:89], v6 offset:0
    v_mfma_f32_16x16x32_bf16 v[184:187], v[76:79], v[120:123], v[184:187]
    ds_read_b64_tr_b16 v[90:91], v6 offset:512
    v_mfma_f32_16x16x32_bf16 v[180:183], v[76:79], v[116:119], v[180:183]
    ds_read_b64_tr_b16 v[104:105], v63 offset:34816
    ds_read_b64_tr_b16 v[106:107], v63 offset:35328
    v_mfma_f32_16x16x32_bf16 v[176:179], v[76:79], v[112:115], v[176:179]
    s_waitcnt lgkmcnt(10)
    buffer_load_dwordx4 v19, s[20:23], s60 offen offset:3072 lds
    v_mfma_f32_16x16x32_bf16 v[192:195], v[80:83], v[112:115], v[192:195]
    ds_read_b64_tr_b16 v[92:93], v7 offset:0
    v_mfma_f32_16x16x32_bf16 v[196:199], v[80:83], v[116:119], v[196:199]
    ds_read_b64_tr_b16 v[94:95], v7 offset:512
    v_mfma_f32_16x16x32_bf16 v[200:203], v[80:83], v[120:123], v[200:203]
    s_add_u32 m0, s59, 81920
    s_mov_b32 s60, 131072
    ds_read_b64_tr_b16 v[108:109], v63 offset:35840
    ds_read_b64_tr_b16 v[110:111], v63 offset:36352
    v_mfma_f32_16x16x32_bf16 v[204:207], v[80:83], v[124:127], v[204:207]
    s_waitcnt lgkmcnt(10)
    buffer_load_dwordx4 v16, s[20:23], s60 offen offset:0 lds
    v_mfma_f32_16x16x32_bf16 v[220:223], v[84:87], v[124:127], v[220:223]
    s_waitcnt vmcnt(13)
    ds_read_b64_tr_b16 v[64:65], v4 offset:32768
    v_mfma_f32_16x16x32_bf16 v[216:219], v[84:87], v[120:123], v[216:219]
    ds_read_b64_tr_b16 v[66:67], v4 offset:33280
    v_mfma_f32_16x16x32_bf16 v[212:215], v[84:87], v[116:119], v[212:215]
    v_mfma_f32_16x16x32_bf16 v[208:211], v[84:87], v[112:115], v[208:211]
    s_waitcnt lgkmcnt(8)
    buffer_load_dwordx4 v17, s[20:23], s60 offen offset:1024 lds
    v_mfma_f32_16x16x32_bf16 v[224:227], v[88:91], v[112:115], v[224:227]
    ds_read_b64_tr_b16 v[68:69], v5 offset:32768
    v_mfma_f32_16x16x32_bf16 v[228:231], v[88:91], v[116:119], v[228:231]
    ds_read_b64_tr_b16 v[70:71], v5 offset:33280
    v_mfma_f32_16x16x32_bf16 v[232:235], v[88:91], v[120:123], v[232:235]
    v_mfma_f32_16x16x32_bf16 v[236:239], v[88:91], v[124:127], v[236:239]
    s_waitcnt lgkmcnt(6)
    buffer_load_dwordx4 v18, s[20:23], s60 offen offset:2048 lds
    v_mfma_f32_16x16x32_bf16 v[252:255], v[92:95], v[124:127], v[252:255]
    ds_read_b64_tr_b16 v[72:73], v6 offset:32768
    v_mfma_f32_16x16x32_bf16 v[248:251], v[92:95], v[120:123], v[248:251]
    ds_read_b64_tr_b16 v[74:75], v6 offset:33280
    v_mfma_f32_16x16x32_bf16 v[244:247], v[92:95], v[116:119], v[244:247]
    v_mfma_f32_16x16x32_bf16 v[240:243], v[92:95], v[112:115], v[240:243]
    s_waitcnt lgkmcnt(4)
    buffer_load_dwordx4 v19, s[20:23], s60 offen offset:3072 lds
    v_mfma_f32_16x16x32_bf16 v[128:131], v[64:67], v[96:99], v[128:131]
    ds_read_b64_tr_b16 v[76:77], v7 offset:32768
    v_mfma_f32_16x16x32_bf16 v[132:135], v[64:67], v[100:103], v[132:135]
    ds_read_b64_tr_b16 v[78:79], v7 offset:33280
    v_mfma_f32_16x16x32_bf16 v[136:139], v[64:67], v[104:107], v[136:139]
    s_add_u32 m0, s59, 0
    s_mov_b32 s60, 131200
    v_mfma_f32_16x16x32_bf16 v[140:143], v[64:67], v[108:111], v[140:143]
    s_waitcnt lgkmcnt(4)
    buffer_load_dwordx4 v16, s[20:23], s60 offen offset:0 lds
    v_mfma_f32_16x16x32_bf16 v[156:159], v[68:71], v[108:111], v[156:159]
    s_waitcnt vmcnt(13)
    ds_read_b64_tr_b16 v[80:81], v8 offset:0
    v_mfma_f32_16x16x32_bf16 v[152:155], v[68:71], v[104:107], v[152:155]
    ds_read_b64_tr_b16 v[82:83], v8 offset:512
    v_mfma_f32_16x16x32_bf16 v[148:151], v[68:71], v[100:103], v[148:151]
    ds_read_b64_tr_b16 v[112:113], v63 offset:49152
    ds_read_b64_tr_b16 v[114:115], v63 offset:49664
    v_mfma_f32_16x16x32_bf16 v[144:147], v[68:71], v[96:99], v[144:147]
    s_waitcnt lgkmcnt(6)
    buffer_load_dwordx4 v17, s[20:23], s60 offen offset:1024 lds
    v_mfma_f32_16x16x32_bf16 v[160:163], v[72:75], v[96:99], v[160:163]
    ds_read_b64_tr_b16 v[84:85], v9 offset:0
    v_mfma_f32_16x16x32_bf16 v[164:167], v[72:75], v[100:103], v[164:167]
    ds_read_b64_tr_b16 v[86:87], v9 offset:512
    v_mfma_f32_16x16x32_bf16 v[168:171], v[72:75], v[104:107], v[168:171]
    ds_read_b64_tr_b16 v[116:117], v63 offset:50176
    ds_read_b64_tr_b16 v[118:119], v63 offset:50688
    v_mfma_f32_16x16x32_bf16 v[172:175], v[72:75], v[108:111], v[172:175]
    s_waitcnt lgkmcnt(8)
    buffer_load_dwordx4 v18, s[20:23], s60 offen offset:2048 lds
    v_mfma_f32_16x16x32_bf16 v[188:191], v[76:79], v[108:111], v[188:191]
    ds_read_b64_tr_b16 v[88:89], v10 offset:0
    v_mfma_f32_16x16x32_bf16 v[184:187], v[76:79], v[104:107], v[184:187]
    ds_read_b64_tr_b16 v[90:91], v10 offset:512
    v_mfma_f32_16x16x32_bf16 v[180:183], v[76:79], v[100:103], v[180:183]
    ds_read_b64_tr_b16 v[120:121], v63 offset:51200
    ds_read_b64_tr_b16 v[122:123], v63 offset:51712
    v_mfma_f32_16x16x32_bf16 v[176:179], v[76:79], v[96:99], v[176:179]
    s_waitcnt lgkmcnt(10)
    buffer_load_dwordx4 v19, s[20:23], s60 offen offset:3072 lds
    v_mfma_f32_16x16x32_bf16 v[192:195], v[80:83], v[96:99], v[192:195]
    ds_read_b64_tr_b16 v[92:93], v11 offset:0
    v_mfma_f32_16x16x32_bf16 v[196:199], v[80:83], v[100:103], v[196:199]
    ds_read_b64_tr_b16 v[94:95], v11 offset:512
    v_mfma_f32_16x16x32_bf16 v[200:203], v[80:83], v[104:107], v[200:203]
    s_add_u32 m0, s59, 32768
    s_mov_b32 s60, 163840
    ds_read_b64_tr_b16 v[124:125], v63 offset:52224
    ds_read_b64_tr_b16 v[126:127], v63 offset:52736
    v_mfma_f32_16x16x32_bf16 v[204:207], v[80:83], v[108:111], v[204:207]
    s_waitcnt lgkmcnt(10)
    buffer_load_dwordx4 v16, s[20:23], s60 offen offset:0 lds
    v_mfma_f32_16x16x32_bf16 v[220:223], v[84:87], v[108:111], v[220:223]
    s_waitcnt vmcnt(13)
    ds_read_b64_tr_b16 v[64:65], v8 offset:16384
    v_mfma_f32_16x16x32_bf16 v[216:219], v[84:87], v[104:107], v[216:219]
    ds_read_b64_tr_b16 v[66:67], v8 offset:16896
    v_mfma_f32_16x16x32_bf16 v[212:215], v[84:87], v[100:103], v[212:215]
    v_mfma_f32_16x16x32_bf16 v[208:211], v[84:87], v[96:99], v[208:211]
    s_waitcnt lgkmcnt(8)
    buffer_load_dwordx4 v17, s[20:23], s60 offen offset:1024 lds
    v_mfma_f32_16x16x32_bf16 v[224:227], v[88:91], v[96:99], v[224:227]
    ds_read_b64_tr_b16 v[68:69], v9 offset:16384
    v_mfma_f32_16x16x32_bf16 v[228:231], v[88:91], v[100:103], v[228:231]
    ds_read_b64_tr_b16 v[70:71], v9 offset:16896
    v_mfma_f32_16x16x32_bf16 v[232:235], v[88:91], v[104:107], v[232:235]
    v_mfma_f32_16x16x32_bf16 v[236:239], v[88:91], v[108:111], v[236:239]
    s_waitcnt lgkmcnt(6)
    buffer_load_dwordx4 v18, s[20:23], s60 offen offset:2048 lds
    v_mfma_f32_16x16x32_bf16 v[252:255], v[92:95], v[108:111], v[252:255]
    ds_read_b64_tr_b16 v[72:73], v10 offset:16384
    v_mfma_f32_16x16x32_bf16 v[248:251], v[92:95], v[104:107], v[248:251]
    ds_read_b64_tr_b16 v[74:75], v10 offset:16896
    v_mfma_f32_16x16x32_bf16 v[244:247], v[92:95], v[100:103], v[244:247]
    v_mfma_f32_16x16x32_bf16 v[240:243], v[92:95], v[96:99], v[240:243]
    s_waitcnt lgkmcnt(4)
    buffer_load_dwordx4 v19, s[20:23], s60 offen offset:3072 lds
    v_mfma_f32_16x16x32_bf16 v[128:131], v[64:67], v[112:115], v[128:131]
    ds_read_b64_tr_b16 v[76:77], v11 offset:16384
    v_mfma_f32_16x16x32_bf16 v[132:135], v[64:67], v[116:119], v[132:135]
    ds_read_b64_tr_b16 v[78:79], v11 offset:16896
    v_mfma_f32_16x16x32_bf16 v[136:139], v[64:67], v[120:123], v[136:139]
    s_add_u32 m0, s59, 49152
    s_mov_b32 s60, 163968
    v_mfma_f32_16x16x32_bf16 v[140:143], v[64:67], v[124:127], v[140:143]
    s_waitcnt lgkmcnt(4)
    buffer_load_dwordx4 v16, s[20:23], s60 offen offset:0 lds
    v_mfma_f32_16x16x32_bf16 v[156:159], v[68:71], v[124:127], v[156:159]
    s_waitcnt vmcnt(13)
    ds_read_b64_tr_b16 v[80:81], v4 offset:16384
    v_mfma_f32_16x16x32_bf16 v[152:155], v[68:71], v[120:123], v[152:155]
    ds_read_b64_tr_b16 v[82:83], v4 offset:16896
    v_mfma_f32_16x16x32_bf16 v[148:151], v[68:71], v[116:119], v[148:151]
    ds_read_b64_tr_b16 v[96:97], v63 offset:4096
    ds_read_b64_tr_b16 v[98:99], v63 offset:4608
    v_mfma_f32_16x16x32_bf16 v[144:147], v[68:71], v[112:115], v[144:147]
    s_waitcnt lgkmcnt(6)
    buffer_load_dwordx4 v17, s[20:23], s60 offen offset:1024 lds
    v_mfma_f32_16x16x32_bf16 v[160:163], v[72:75], v[112:115], v[160:163]
    ds_read_b64_tr_b16 v[84:85], v5 offset:16384
    v_mfma_f32_16x16x32_bf16 v[164:167], v[72:75], v[116:119], v[164:167]
    ds_read_b64_tr_b16 v[86:87], v5 offset:16896
    v_mfma_f32_16x16x32_bf16 v[168:171], v[72:75], v[120:123], v[168:171]
    ds_read_b64_tr_b16 v[100:101], v63 offset:5120
    ds_read_b64_tr_b16 v[102:103], v63 offset:5632
    v_mfma_f32_16x16x32_bf16 v[172:175], v[72:75], v[124:127], v[172:175]
    s_waitcnt lgkmcnt(8)
    buffer_load_dwordx4 v18, s[20:23], s60 offen offset:2048 lds
    v_mfma_f32_16x16x32_bf16 v[188:191], v[76:79], v[124:127], v[188:191]
    ds_read_b64_tr_b16 v[88:89], v6 offset:16384
    v_mfma_f32_16x16x32_bf16 v[184:187], v[76:79], v[120:123], v[184:187]
    ds_read_b64_tr_b16 v[90:91], v6 offset:16896
    v_mfma_f32_16x16x32_bf16 v[180:183], v[76:79], v[116:119], v[180:183]
    ds_read_b64_tr_b16 v[104:105], v63 offset:6144
    ds_read_b64_tr_b16 v[106:107], v63 offset:6656
    v_mfma_f32_16x16x32_bf16 v[176:179], v[76:79], v[112:115], v[176:179]
    s_waitcnt lgkmcnt(10)
    buffer_load_dwordx4 v19, s[20:23], s60 offen offset:3072 lds
    v_mfma_f32_16x16x32_bf16 v[192:195], v[80:83], v[112:115], v[192:195]
    ds_read_b64_tr_b16 v[92:93], v7 offset:16384
    v_mfma_f32_16x16x32_bf16 v[196:199], v[80:83], v[116:119], v[196:199]
    ds_read_b64_tr_b16 v[94:95], v7 offset:16896
    v_mfma_f32_16x16x32_bf16 v[200:203], v[80:83], v[120:123], v[200:203]
    s_add_u32 m0, s59, 65536
    s_mov_b32 s60, 196608
    ds_read_b64_tr_b16 v[108:109], v63 offset:7168
    ds_read_b64_tr_b16 v[110:111], v63 offset:7680
    v_mfma_f32_16x16x32_bf16 v[204:207], v[80:83], v[124:127], v[204:207]
    s_waitcnt lgkmcnt(10)
    buffer_load_dwordx4 v16, s[20:23], s60 offen offset:0 lds
    v_mfma_f32_16x16x32_bf16 v[220:223], v[84:87], v[124:127], v[220:223]
    s_waitcnt vmcnt(13)
    ds_read_b64_tr_b16 v[64:65], v8 offset:32768
    v_mfma_f32_16x16x32_bf16 v[216:219], v[84:87], v[120:123], v[216:219]
    ds_read_b64_tr_b16 v[66:67], v8 offset:33280
    v_mfma_f32_16x16x32_bf16 v[212:215], v[84:87], v[116:119], v[212:215]
    v_mfma_f32_16x16x32_bf16 v[208:211], v[84:87], v[112:115], v[208:211]
    s_waitcnt lgkmcnt(8)
    buffer_load_dwordx4 v17, s[20:23], s60 offen offset:1024 lds
    v_mfma_f32_16x16x32_bf16 v[224:227], v[88:91], v[112:115], v[224:227]
    ds_read_b64_tr_b16 v[68:69], v9 offset:32768
    v_mfma_f32_16x16x32_bf16 v[228:231], v[88:91], v[116:119], v[228:231]
    ds_read_b64_tr_b16 v[70:71], v9 offset:33280
    v_mfma_f32_16x16x32_bf16 v[232:235], v[88:91], v[120:123], v[232:235]
    v_mfma_f32_16x16x32_bf16 v[236:239], v[88:91], v[124:127], v[236:239]
    s_waitcnt lgkmcnt(6)
    buffer_load_dwordx4 v18, s[20:23], s60 offen offset:2048 lds
    v_mfma_f32_16x16x32_bf16 v[252:255], v[92:95], v[124:127], v[252:255]
    ds_read_b64_tr_b16 v[72:73], v10 offset:32768
    v_mfma_f32_16x16x32_bf16 v[248:251], v[92:95], v[120:123], v[248:251]
    ds_read_b64_tr_b16 v[74:75], v10 offset:33280
    v_mfma_f32_16x16x32_bf16 v[244:247], v[92:95], v[116:119], v[244:247]
    v_mfma_f32_16x16x32_bf16 v[240:243], v[92:95], v[112:115], v[240:243]
    s_waitcnt lgkmcnt(4)
    buffer_load_dwordx4 v19, s[20:23], s60 offen offset:3072 lds
    v_mfma_f32_16x16x32_bf16 v[128:131], v[64:67], v[96:99], v[128:131]
    ds_read_b64_tr_b16 v[76:77], v11 offset:32768
    v_mfma_f32_16x16x32_bf16 v[132:135], v[64:67], v[100:103], v[132:135]
    ds_read_b64_tr_b16 v[78:79], v11 offset:33280
    v_mfma_f32_16x16x32_bf16 v[136:139], v[64:67], v[104:107], v[136:139]
    s_add_u32 m0, s59, 16384
    s_mov_b32 s60, 196736
    v_mfma_f32_16x16x32_bf16 v[140:143], v[64:67], v[108:111], v[140:143]
    s_waitcnt lgkmcnt(4)
    buffer_load_dwordx4 v16, s[20:23], s60 offen offset:0 lds
    v_mfma_f32_16x16x32_bf16 v[156:159], v[68:71], v[108:111], v[156:159]
    s_waitcnt vmcnt(13)
    ds_read_b64_tr_b16 v[80:81], v4 offset:0
    v_mfma_f32_16x16x32_bf16 v[152:155], v[68:71], v[104:107], v[152:155]
    ds_read_b64_tr_b16 v[82:83], v4 offset:512
    v_mfma_f32_16x16x32_bf16 v[148:151], v[68:71], v[100:103], v[148:151]
    ds_read_b64_tr_b16 v[112:113], v63 offset:20480
    ds_read_b64_tr_b16 v[114:115], v63 offset:20992
    v_mfma_f32_16x16x32_bf16 v[144:147], v[68:71], v[96:99], v[144:147]
    s_waitcnt lgkmcnt(6)
    buffer_load_dwordx4 v17, s[20:23], s60 offen offset:1024 lds
    v_mfma_f32_16x16x32_bf16 v[160:163], v[72:75], v[96:99], v[160:163]
    ds_read_b64_tr_b16 v[84:85], v5 offset:0
    v_mfma_f32_16x16x32_bf16 v[164:167], v[72:75], v[100:103], v[164:167]
    ds_read_b64_tr_b16 v[86:87], v5 offset:512
    v_mfma_f32_16x16x32_bf16 v[168:171], v[72:75], v[104:107], v[168:171]
    ds_read_b64_tr_b16 v[116:117], v63 offset:21504
    ds_read_b64_tr_b16 v[118:119], v63 offset:22016
    v_mfma_f32_16x16x32_bf16 v[172:175], v[72:75], v[108:111], v[172:175]
    s_waitcnt lgkmcnt(8)
    buffer_load_dwordx4 v18, s[20:23], s60 offen offset:2048 lds
    v_mfma_f32_16x16x32_bf16 v[188:191], v[76:79], v[108:111], v[188:191]
    ds_read_b64_tr_b16 v[88:89], v6 offset:0
    v_mfma_f32_16x16x32_bf16 v[184:187], v[76:79], v[104:107], v[184:187]
    ds_read_b64_tr_b16 v[90:91], v6 offset:512
    v_mfma_f32_16x16x32_bf16 v[180:183], v[76:79], v[100:103], v[180:183]
    ds_read_b64_tr_b16 v[120:121], v63 offset:22528
    ds_read_b64_tr_b16 v[122:123], v63 offset:23040
    v_mfma_f32_16x16x32_bf16 v[176:179], v[76:79], v[96:99], v[176:179]
    s_waitcnt lgkmcnt(10)
    buffer_load_dwordx4 v19, s[20:23], s60 offen offset:3072 lds
    v_mfma_f32_16x16x32_bf16 v[192:195], v[80:83], v[96:99], v[192:195]
    ds_read_b64_tr_b16 v[92:93], v7 offset:0
    v_mfma_f32_16x16x32_bf16 v[196:199], v[80:83], v[100:103], v[196:199]
    ds_read_b64_tr_b16 v[94:95], v7 offset:512
    v_mfma_f32_16x16x32_bf16 v[200:203], v[80:83], v[104:107], v[200:203]
    s_add_u32 m0, s59, 81920
    s_mov_b32 s60, 229376
    ds_read_b64_tr_b16 v[124:125], v63 offset:23552
    ds_read_b64_tr_b16 v[126:127], v63 offset:24064
    v_mfma_f32_16x16x32_bf16 v[204:207], v[80:83], v[108:111], v[204:207]
    s_waitcnt lgkmcnt(10)
    buffer_load_dwordx4 v16, s[20:23], s60 offen offset:0 lds
    v_mfma_f32_16x16x32_bf16 v[220:223], v[84:87], v[108:111], v[220:223]
    s_waitcnt vmcnt(13)
    ds_read_b64_tr_b16 v[64:65], v4 offset:32768
    v_mfma_f32_16x16x32_bf16 v[216:219], v[84:87], v[104:107], v[216:219]
    ds_read_b64_tr_b16 v[66:67], v4 offset:33280
    v_mfma_f32_16x16x32_bf16 v[212:215], v[84:87], v[100:103], v[212:215]
    v_mfma_f32_16x16x32_bf16 v[208:211], v[84:87], v[96:99], v[208:211]
    s_waitcnt lgkmcnt(8)
    buffer_load_dwordx4 v17, s[20:23], s60 offen offset:1024 lds
    v_mfma_f32_16x16x32_bf16 v[224:227], v[88:91], v[96:99], v[224:227]
    ds_read_b64_tr_b16 v[68:69], v5 offset:32768
    v_mfma_f32_16x16x32_bf16 v[228:231], v[88:91], v[100:103], v[228:231]
    ds_read_b64_tr_b16 v[70:71], v5 offset:33280
    v_mfma_f32_16x16x32_bf16 v[232:235], v[88:91], v[104:107], v[232:235]
    v_mfma_f32_16x16x32_bf16 v[236:239], v[88:91], v[108:111], v[236:239]
    s_waitcnt lgkmcnt(6)
    buffer_load_dwordx4 v18, s[20:23], s60 offen offset:2048 lds
    v_mfma_f32_16x16x32_bf16 v[252:255], v[92:95], v[108:111], v[252:255]
    ds_read_b64_tr_b16 v[72:73], v6 offset:32768
    v_mfma_f32_16x16x32_bf16 v[248:251], v[92:95], v[104:107], v[248:251]
    ds_read_b64_tr_b16 v[74:75], v6 offset:33280
    v_mfma_f32_16x16x32_bf16 v[244:247], v[92:95], v[100:103], v[244:247]
    v_mfma_f32_16x16x32_bf16 v[240:243], v[92:95], v[96:99], v[240:243]
    s_waitcnt lgkmcnt(4)
    buffer_load_dwordx4 v19, s[20:23], s60 offen offset:3072 lds
    v_mfma_f32_16x16x32_bf16 v[128:131], v[64:67], v[112:115], v[128:131]
    ds_read_b64_tr_b16 v[76:77], v7 offset:32768
    v_mfma_f32_16x16x32_bf16 v[132:135], v[64:67], v[116:119], v[132:135]
    ds_read_b64_tr_b16 v[78:79], v7 offset:33280
    v_mfma_f32_16x16x32_bf16 v[136:139], v[64:67], v[120:123], v[136:139]
    s_add_u32 m0, s59, 0
    s_mov_b32 s60, 229504
    v_mfma_f32_16x16x32_bf16 v[140:143], v[64:67], v[124:127], v[140:143]
    s_waitcnt lgkmcnt(4)
    buffer_load_dwordx4 v16, s[20:23], s60 offen offset:0 lds
    v_mfma_f32_16x16x32_bf16 v[156:159], v[68:71], v[124:127], v[156:159]
    s_waitcnt vmcnt(13)
    ds_read_b64_tr_b16 v[80:81], v8 offset:0
    v_mfma_f32_16x16x32_bf16 v[152:155], v[68:71], v[120:123], v[152:155]
    ds_read_b64_tr_b16 v[82:83], v8 offset:512
    v_mfma_f32_16x16x32_bf16 v[148:151], v[68:71], v[116:119], v[148:151]
    ds_read_b64_tr_b16 v[96:97], v63 offset:36864
    ds_read_b64_tr_b16 v[98:99], v63 offset:37376
    v_mfma_f32_16x16x32_bf16 v[144:147], v[68:71], v[112:115], v[144:147]
    s_waitcnt lgkmcnt(6)
    buffer_load_dwordx4 v17, s[20:23], s60 offen offset:1024 lds
    v_mfma_f32_16x16x32_bf16 v[160:163], v[72:75], v[112:115], v[160:163]
    ds_read_b64_tr_b16 v[84:85], v9 offset:0
    v_mfma_f32_16x16x32_bf16 v[164:167], v[72:75], v[116:119], v[164:167]
    ds_read_b64_tr_b16 v[86:87], v9 offset:512
    v_mfma_f32_16x16x32_bf16 v[168:171], v[72:75], v[120:123], v[168:171]
    ds_read_b64_tr_b16 v[100:101], v63 offset:37888
    ds_read_b64_tr_b16 v[102:103], v63 offset:38400
    v_mfma_f32_16x16x32_bf16 v[172:175], v[72:75], v[124:127], v[172:175]
    s_waitcnt lgkmcnt(8)
    buffer_load_dwordx4 v18, s[20:23], s60 offen offset:2048 lds
    v_mfma_f32_16x16x32_bf16 v[188:191], v[76:79], v[124:127], v[188:191]
    ds_read_b64_tr_b16 v[88:89], v10 offset:0
    v_mfma_f32_16x16x32_bf16 v[184:187], v[76:79], v[120:123], v[184:187]
    ds_read_b64_tr_b16 v[90:91], v10 offset:512
    v_mfma_f32_16x16x32_bf16 v[180:183], v[76:79], v[116:119], v[180:183]
    ds_read_b64_tr_b16 v[104:105], v63 offset:38912
    ds_read_b64_tr_b16 v[106:107], v63 offset:39424
    v_mfma_f32_16x16x32_bf16 v[176:179], v[76:79], v[112:115], v[176:179]
    s_waitcnt lgkmcnt(10)
    buffer_load_dwordx4 v19, s[20:23], s60 offen offset:3072 lds
    v_mfma_f32_16x16x32_bf16 v[192:195], v[80:83], v[112:115], v[192:195]
    ds_read_b64_tr_b16 v[92:93], v11 offset:0
    v_mfma_f32_16x16x32_bf16 v[196:199], v[80:83], v[116:119], v[196:199]
    ds_read_b64_tr_b16 v[94:95], v11 offset:512
    v_mfma_f32_16x16x32_bf16 v[200:203], v[80:83], v[120:123], v[200:203]
    s_add_u32 m0, s59, 32768
    s_mov_b32 s60, 262144
    ds_read_b64_tr_b16 v[108:109], v63 offset:39936
    ds_read_b64_tr_b16 v[110:111], v63 offset:40448
    v_mfma_f32_16x16x32_bf16 v[204:207], v[80:83], v[124:127], v[204:207]
    s_waitcnt lgkmcnt(10)
    buffer_load_dwordx4 v16, s[20:23], s60 offen offset:0 lds
    v_mfma_f32_16x16x32_bf16 v[220:223], v[84:87], v[124:127], v[220:223]
    s_waitcnt vmcnt(13)
    ds_read_b64_tr_b16 v[64:65], v8 offset:16384
    v_mfma_f32_16x16x32_bf16 v[216:219], v[84:87], v[120:123], v[216:219]
    ds_read_b64_tr_b16 v[66:67], v8 offset:16896
    v_mfma_f32_16x16x32_bf16 v[212:215], v[84:87], v[116:119], v[212:215]
    v_mfma_f32_16x16x32_bf16 v[208:211], v[84:87], v[112:115], v[208:211]
    s_waitcnt lgkmcnt(8)
    buffer_load_dwordx4 v17, s[20:23], s60 offen offset:1024 lds
    v_mfma_f32_16x16x32_bf16 v[224:227], v[88:91], v[112:115], v[224:227]
    ds_read_b64_tr_b16 v[68:69], v9 offset:16384
    v_mfma_f32_16x16x32_bf16 v[228:231], v[88:91], v[116:119], v[228:231]
    ds_read_b64_tr_b16 v[70:71], v9 offset:16896
    v_mfma_f32_16x16x32_bf16 v[232:235], v[88:91], v[120:123], v[232:235]
    v_mfma_f32_16x16x32_bf16 v[236:239], v[88:91], v[124:127], v[236:239]
    s_waitcnt lgkmcnt(6)
    buffer_load_dwordx4 v18, s[20:23], s60 offen offset:2048 lds
    v_mfma_f32_16x16x32_bf16 v[252:255], v[92:95], v[124:127], v[252:255]
    ds_read_b64_tr_b16 v[72:73], v10 offset:16384
    v_mfma_f32_16x16x32_bf16 v[248:251], v[92:95], v[120:123], v[248:251]
    ds_read_b64_tr_b16 v[74:75], v10 offset:16896
    v_mfma_f32_16x16x32_bf16 v[244:247], v[92:95], v[116:119], v[244:247]
    v_mfma_f32_16x16x32_bf16 v[240:243], v[92:95], v[112:115], v[240:243]
    s_waitcnt lgkmcnt(4)
    buffer_load_dwordx4 v19, s[20:23], s60 offen offset:3072 lds
    v_mfma_f32_16x16x32_bf16 v[128:131], v[64:67], v[96:99], v[128:131]
    ds_read_b64_tr_b16 v[76:77], v11 offset:16384
    v_mfma_f32_16x16x32_bf16 v[132:135], v[64:67], v[100:103], v[132:135]
    ds_read_b64_tr_b16 v[78:79], v11 offset:16896
    v_mfma_f32_16x16x32_bf16 v[136:139], v[64:67], v[104:107], v[136:139]
    s_add_u32 m0, s59, 49152
    s_mov_b32 s60, 262272
    v_mfma_f32_16x16x32_bf16 v[140:143], v[64:67], v[108:111], v[140:143]
    s_waitcnt lgkmcnt(4)
    buffer_load_dwordx4 v16, s[20:23], s60 offen offset:0 lds
    v_mfma_f32_16x16x32_bf16 v[156:159], v[68:71], v[108:111], v[156:159]
    s_waitcnt vmcnt(13)
    ds_read_b64_tr_b16 v[80:81], v4 offset:16384
    v_mfma_f32_16x16x32_bf16 v[152:155], v[68:71], v[104:107], v[152:155]
    ds_read_b64_tr_b16 v[82:83], v4 offset:16896
    v_mfma_f32_16x16x32_bf16 v[148:151], v[68:71], v[100:103], v[148:151]
    ds_read_b64_tr_b16 v[112:113], v63 offset:53248
    ds_read_b64_tr_b16 v[114:115], v63 offset:53760
    v_mfma_f32_16x16x32_bf16 v[144:147], v[68:71], v[96:99], v[144:147]
    s_waitcnt lgkmcnt(6)
    buffer_load_dwordx4 v17, s[20:23], s60 offen offset:1024 lds
    v_mfma_f32_16x16x32_bf16 v[160:163], v[72:75], v[96:99], v[160:163]
    ds_read_b64_tr_b16 v[84:85], v5 offset:16384
    v_mfma_f32_16x16x32_bf16 v[164:167], v[72:75], v[100:103], v[164:167]
    ds_read_b64_tr_b16 v[86:87], v5 offset:16896
    v_mfma_f32_16x16x32_bf16 v[168:171], v[72:75], v[104:107], v[168:171]
    ds_read_b64_tr_b16 v[116:117], v63 offset:54272
    ds_read_b64_tr_b16 v[118:119], v63 offset:54784
    v_mfma_f32_16x16x32_bf16 v[172:175], v[72:75], v[108:111], v[172:175]
    s_waitcnt lgkmcnt(8)
    buffer_load_dwordx4 v18, s[20:23], s60 offen offset:2048 lds
    v_mfma_f32_16x16x32_bf16 v[188:191], v[76:79], v[108:111], v[188:191]
    ds_read_b64_tr_b16 v[88:89], v6 offset:16384
    v_mfma_f32_16x16x32_bf16 v[184:187], v[76:79], v[104:107], v[184:187]
    ds_read_b64_tr_b16 v[90:91], v6 offset:16896
    v_mfma_f32_16x16x32_bf16 v[180:183], v[76:79], v[100:103], v[180:183]
    ds_read_b64_tr_b16 v[120:121], v63 offset:55296
    ds_read_b64_tr_b16 v[122:123], v63 offset:55808
    v_mfma_f32_16x16x32_bf16 v[176:179], v[76:79], v[96:99], v[176:179]
    s_waitcnt lgkmcnt(10)
    buffer_load_dwordx4 v19, s[20:23], s60 offen offset:3072 lds
    v_mfma_f32_16x16x32_bf16 v[192:195], v[80:83], v[96:99], v[192:195]
    ds_read_b64_tr_b16 v[92:93], v7 offset:16384
    v_mfma_f32_16x16x32_bf16 v[196:199], v[80:83], v[100:103], v[196:199]
    ds_read_b64_tr_b16 v[94:95], v7 offset:16896
    v_mfma_f32_16x16x32_bf16 v[200:203], v[80:83], v[104:107], v[200:203]
    s_add_u32 m0, s59, 65536
    s_mov_b32 s60, 294912
    ds_read_b64_tr_b16 v[124:125], v63 offset:56320
    ds_read_b64_tr_b16 v[126:127], v63 offset:56832
    v_mfma_f32_16x16x32_bf16 v[204:207], v[80:83], v[108:111], v[204:207]
    s_waitcnt lgkmcnt(10)
    buffer_load_dwordx4 v16, s[20:23], s60 offen offset:0 lds
    v_mfma_f32_16x16x32_bf16 v[220:223], v[84:87], v[108:111], v[220:223]
    s_waitcnt vmcnt(13)
    ds_read_b64_tr_b16 v[64:65], v8 offset:32768
    v_mfma_f32_16x16x32_bf16 v[216:219], v[84:87], v[104:107], v[216:219]
    ds_read_b64_tr_b16 v[66:67], v8 offset:33280
    v_mfma_f32_16x16x32_bf16 v[212:215], v[84:87], v[100:103], v[212:215]
    v_mfma_f32_16x16x32_bf16 v[208:211], v[84:87], v[96:99], v[208:211]
    s_waitcnt lgkmcnt(8)
    buffer_load_dwordx4 v17, s[20:23], s60 offen offset:1024 lds
    v_mfma_f32_16x16x32_bf16 v[224:227], v[88:91], v[96:99], v[224:227]
    ds_read_b64_tr_b16 v[68:69], v9 offset:32768
    v_mfma_f32_16x16x32_bf16 v[228:231], v[88:91], v[100:103], v[228:231]
    ds_read_b64_tr_b16 v[70:71], v9 offset:33280
    v_mfma_f32_16x16x32_bf16 v[232:235], v[88:91], v[104:107], v[232:235]
    v_mfma_f32_16x16x32_bf16 v[236:239], v[88:91], v[108:111], v[236:239]
    s_waitcnt lgkmcnt(6)
    buffer_load_dwordx4 v18, s[20:23], s60 offen offset:2048 lds
    v_mfma_f32_16x16x32_bf16 v[252:255], v[92:95], v[108:111], v[252:255]
    ds_read_b64_tr_b16 v[72:73], v10 offset:32768
    v_mfma_f32_16x16x32_bf16 v[248:251], v[92:95], v[104:107], v[248:251]
    ds_read_b64_tr_b16 v[74:75], v10 offset:33280
    v_mfma_f32_16x16x32_bf16 v[244:247], v[92:95], v[100:103], v[244:247]
    v_mfma_f32_16x16x32_bf16 v[240:243], v[92:95], v[96:99], v[240:243]
    s_waitcnt lgkmcnt(4)
    buffer_load_dwordx4 v19, s[20:23], s60 offen offset:3072 lds
    v_mfma_f32_16x16x32_bf16 v[128:131], v[64:67], v[112:115], v[128:131]
    ds_read_b64_tr_b16 v[76:77], v11 offset:32768
    v_mfma_f32_16x16x32_bf16 v[132:135], v[64:67], v[116:119], v[132:135]
    ds_read_b64_tr_b16 v[78:79], v11 offset:33280
    v_mfma_f32_16x16x32_bf16 v[136:139], v[64:67], v[120:123], v[136:139]
    s_add_u32 m0, s59, 16384
    s_mov_b32 s60, 295040
    v_mfma_f32_16x16x32_bf16 v[140:143], v[64:67], v[124:127], v[140:143]
    s_waitcnt lgkmcnt(4)
    buffer_load_dwordx4 v16, s[20:23], s60 offen offset:0 lds
    v_mfma_f32_16x16x32_bf16 v[156:159], v[68:71], v[124:127], v[156:159]
    s_waitcnt vmcnt(13)
    ds_read_b64_tr_b16 v[80:81], v4 offset:0
    v_mfma_f32_16x16x32_bf16 v[152:155], v[68:71], v[120:123], v[152:155]
    ds_read_b64_tr_b16 v[82:83], v4 offset:512
    v_mfma_f32_16x16x32_bf16 v[148:151], v[68:71], v[116:119], v[148:151]
    ds_read_b64_tr_b16 v[96:97], v63 offset:8192
    ds_read_b64_tr_b16 v[98:99], v63 offset:8704
    v_mfma_f32_16x16x32_bf16 v[144:147], v[68:71], v[112:115], v[144:147]
    s_waitcnt lgkmcnt(6)
    buffer_load_dwordx4 v17, s[20:23], s60 offen offset:1024 lds
    v_mfma_f32_16x16x32_bf16 v[160:163], v[72:75], v[112:115], v[160:163]
    ds_read_b64_tr_b16 v[84:85], v5 offset:0
    v_mfma_f32_16x16x32_bf16 v[164:167], v[72:75], v[116:119], v[164:167]
    ds_read_b64_tr_b16 v[86:87], v5 offset:512
    v_mfma_f32_16x16x32_bf16 v[168:171], v[72:75], v[120:123], v[168:171]
    ds_read_b64_tr_b16 v[100:101], v63 offset:9216
    ds_read_b64_tr_b16 v[102:103], v63 offset:9728
    v_mfma_f32_16x16x32_bf16 v[172:175], v[72:75], v[124:127], v[172:175]
    s_waitcnt lgkmcnt(8)
    buffer_load_dwordx4 v18, s[20:23], s60 offen offset:2048 lds
    v_mfma_f32_16x16x32_bf16 v[188:191], v[76:79], v[124:127], v[188:191]
    ds_read_b64_tr_b16 v[88:89], v6 offset:0
    v_mfma_f32_16x16x32_bf16 v[184:187], v[76:79], v[120:123], v[184:187]
    ds_read_b64_tr_b16 v[90:91], v6 offset:512
    v_mfma_f32_16x16x32_bf16 v[180:183], v[76:79], v[116:119], v[180:183]
    ds_read_b64_tr_b16 v[104:105], v63 offset:10240
    ds_read_b64_tr_b16 v[106:107], v63 offset:10752
    v_mfma_f32_16x16x32_bf16 v[176:179], v[76:79], v[112:115], v[176:179]
    s_waitcnt lgkmcnt(10)
    buffer_load_dwordx4 v19, s[20:23], s60 offen offset:3072 lds
    v_mfma_f32_16x16x32_bf16 v[192:195], v[80:83], v[112:115], v[192:195]
    ds_read_b64_tr_b16 v[92:93], v7 offset:0
    v_mfma_f32_16x16x32_bf16 v[196:199], v[80:83], v[116:119], v[196:199]
    ds_read_b64_tr_b16 v[94:95], v7 offset:512
    v_mfma_f32_16x16x32_bf16 v[200:203], v[80:83], v[120:123], v[200:203]
    s_add_u32 m0, s59, 81920
    s_mov_b32 s60, 327680
    ds_read_b64_tr_b16 v[108:109], v63 offset:11264
    ds_read_b64_tr_b16 v[110:111], v63 offset:11776
    v_mfma_f32_16x16x32_bf16 v[204:207], v[80:83], v[124:127], v[204:207]
    s_waitcnt lgkmcnt(10)
    buffer_load_dwordx4 v16, s[20:23], s60 offen offset:0 lds
    v_mfma_f32_16x16x32_bf16 v[220:223], v[84:87], v[124:127], v[220:223]
    s_waitcnt vmcnt(13)
    ds_read_b64_tr_b16 v[64:65], v4 offset:32768
    v_mfma_f32_16x16x32_bf16 v[216:219], v[84:87], v[120:123], v[216:219]
    ds_read_b64_tr_b16 v[66:67], v4 offset:33280
    v_mfma_f32_16x16x32_bf16 v[212:215], v[84:87], v[116:119], v[212:215]
    v_mfma_f32_16x16x32_bf16 v[208:211], v[84:87], v[112:115], v[208:211]
    s_waitcnt lgkmcnt(8)
    buffer_load_dwordx4 v17, s[20:23], s60 offen offset:1024 lds
    v_mfma_f32_16x16x32_bf16 v[224:227], v[88:91], v[112:115], v[224:227]
    ds_read_b64_tr_b16 v[68:69], v5 offset:32768
    v_mfma_f32_16x16x32_bf16 v[228:231], v[88:91], v[116:119], v[228:231]
    ds_read_b64_tr_b16 v[70:71], v5 offset:33280
    v_mfma_f32_16x16x32_bf16 v[232:235], v[88:91], v[120:123], v[232:235]
    v_mfma_f32_16x16x32_bf16 v[236:239], v[88:91], v[124:127], v[236:239]
    s_waitcnt lgkmcnt(6)
    buffer_load_dwordx4 v18, s[20:23], s60 offen offset:2048 lds
    v_mfma_f32_16x16x32_bf16 v[252:255], v[92:95], v[124:127], v[252:255]
    ds_read_b64_tr_b16 v[72:73], v6 offset:32768
    v_mfma_f32_16x16x32_bf16 v[248:251], v[92:95], v[120:123], v[248:251]
    ds_read_b64_tr_b16 v[74:75], v6 offset:33280
    v_mfma_f32_16x16x32_bf16 v[244:247], v[92:95], v[116:119], v[244:247]
    v_mfma_f32_16x16x32_bf16 v[240:243], v[92:95], v[112:115], v[240:243]
    s_waitcnt lgkmcnt(4)
    buffer_load_dwordx4 v19, s[20:23], s60 offen offset:3072 lds
    v_mfma_f32_16x16x32_bf16 v[128:131], v[64:67], v[96:99], v[128:131]
    ds_read_b64_tr_b16 v[76:77], v7 offset:32768
    v_mfma_f32_16x16x32_bf16 v[132:135], v[64:67], v[100:103], v[132:135]
    ds_read_b64_tr_b16 v[78:79], v7 offset:33280
    v_mfma_f32_16x16x32_bf16 v[136:139], v[64:67], v[104:107], v[136:139]
    s_add_u32 m0, s59, 0
    s_mov_b32 s60, 327808
    v_mfma_f32_16x16x32_bf16 v[140:143], v[64:67], v[108:111], v[140:143]
    s_waitcnt lgkmcnt(4)
    buffer_load_dwordx4 v16, s[20:23], s60 offen offset:0 lds
    v_mfma_f32_16x16x32_bf16 v[156:159], v[68:71], v[108:111], v[156:159]
    s_waitcnt vmcnt(13)
    ds_read_b64_tr_b16 v[80:81], v8 offset:0
    v_mfma_f32_16x16x32_bf16 v[152:155], v[68:71], v[104:107], v[152:155]
    ds_read_b64_tr_b16 v[82:83], v8 offset:512
    v_mfma_f32_16x16x32_bf16 v[148:151], v[68:71], v[100:103], v[148:151]
    ds_read_b64_tr_b16 v[112:113], v63 offset:24576
    ds_read_b64_tr_b16 v[114:115], v63 offset:25088
    v_mfma_f32_16x16x32_bf16 v[144:147], v[68:71], v[96:99], v[144:147]
    s_waitcnt lgkmcnt(6)
    buffer_load_dwordx4 v17, s[20:23], s60 offen offset:1024 lds
    v_mfma_f32_16x16x32_bf16 v[160:163], v[72:75], v[96:99], v[160:163]
    ds_read_b64_tr_b16 v[84:85], v9 offset:0
    v_mfma_f32_16x16x32_bf16 v[164:167], v[72:75], v[100:103], v[164:167]
    ds_read_b64_tr_b16 v[86:87], v9 offset:512
    v_mfma_f32_16x16x32_bf16 v[168:171], v[72:75], v[104:107], v[168:171]
    ds_read_b64_tr_b16 v[116:117], v63 offset:25600
    ds_read_b64_tr_b16 v[118:119], v63 offset:26112
    v_mfma_f32_16x16x32_bf16 v[172:175], v[72:75], v[108:111], v[172:175]
    s_waitcnt lgkmcnt(8)
    buffer_load_dwordx4 v18, s[20:23], s60 offen offset:2048 lds
    v_mfma_f32_16x16x32_bf16 v[188:191], v[76:79], v[108:111], v[188:191]
    ds_read_b64_tr_b16 v[88:89], v10 offset:0
    v_mfma_f32_16x16x32_bf16 v[184:187], v[76:79], v[104:107], v[184:187]
    ds_read_b64_tr_b16 v[90:91], v10 offset:512
    v_mfma_f32_16x16x32_bf16 v[180:183], v[76:79], v[100:103], v[180:183]
    ds_read_b64_tr_b16 v[120:121], v63 offset:26624
    ds_read_b64_tr_b16 v[122:123], v63 offset:27136
    v_mfma_f32_16x16x32_bf16 v[176:179], v[76:79], v[96:99], v[176:179]
    s_waitcnt lgkmcnt(10)
    buffer_load_dwordx4 v19, s[20:23], s60 offen offset:3072 lds
    v_mfma_f32_16x16x32_bf16 v[192:195], v[80:83], v[96:99], v[192:195]
    ds_read_b64_tr_b16 v[92:93], v11 offset:0
    v_mfma_f32_16x16x32_bf16 v[196:199], v[80:83], v[100:103], v[196:199]
    ds_read_b64_tr_b16 v[94:95], v11 offset:512
    v_mfma_f32_16x16x32_bf16 v[200:203], v[80:83], v[104:107], v[200:203]
    s_add_u32 m0, s59, 32768
    s_mov_b32 s60, 360448
    ds_read_b64_tr_b16 v[124:125], v63 offset:27648
    ds_read_b64_tr_b16 v[126:127], v63 offset:28160
    v_mfma_f32_16x16x32_bf16 v[204:207], v[80:83], v[108:111], v[204:207]
    s_waitcnt lgkmcnt(10)
    buffer_load_dwordx4 v16, s[20:23], s60 offen offset:0 lds
    v_mfma_f32_16x16x32_bf16 v[220:223], v[84:87], v[108:111], v[220:223]
    s_waitcnt vmcnt(13)
    ds_read_b64_tr_b16 v[64:65], v8 offset:16384
    v_mfma_f32_16x16x32_bf16 v[216:219], v[84:87], v[104:107], v[216:219]
    ds_read_b64_tr_b16 v[66:67], v8 offset:16896
    v_mfma_f32_16x16x32_bf16 v[212:215], v[84:87], v[100:103], v[212:215]
    v_mfma_f32_16x16x32_bf16 v[208:211], v[84:87], v[96:99], v[208:211]
    s_waitcnt lgkmcnt(8)
    buffer_load_dwordx4 v17, s[20:23], s60 offen offset:1024 lds
    v_mfma_f32_16x16x32_bf16 v[224:227], v[88:91], v[96:99], v[224:227]
    ds_read_b64_tr_b16 v[68:69], v9 offset:16384
    v_mfma_f32_16x16x32_bf16 v[228:231], v[88:91], v[100:103], v[228:231]
    ds_read_b64_tr_b16 v[70:71], v9 offset:16896
    v_mfma_f32_16x16x32_bf16 v[232:235], v[88:91], v[104:107], v[232:235]
    v_mfma_f32_16x16x32_bf16 v[236:239], v[88:91], v[108:111], v[236:239]
    s_waitcnt lgkmcnt(6)
    buffer_load_dwordx4 v18, s[20:23], s60 offen offset:2048 lds
    v_mfma_f32_16x16x32_bf16 v[252:255], v[92:95], v[108:111], v[252:255]
    ds_read_b64_tr_b16 v[72:73], v10 offset:16384
    v_mfma_f32_16x16x32_bf16 v[248:251], v[92:95], v[104:107], v[248:251]
    ds_read_b64_tr_b16 v[74:75], v10 offset:16896
    v_mfma_f32_16x16x32_bf16 v[244:247], v[92:95], v[100:103], v[244:247]
    v_mfma_f32_16x16x32_bf16 v[240:243], v[92:95], v[96:99], v[240:243]
    s_waitcnt lgkmcnt(4)
    buffer_load_dwordx4 v19, s[20:23], s60 offen offset:3072 lds
    v_mfma_f32_16x16x32_bf16 v[128:131], v[64:67], v[112:115], v[128:131]
    ds_read_b64_tr_b16 v[76:77], v11 offset:16384
    v_mfma_f32_16x16x32_bf16 v[132:135], v[64:67], v[116:119], v[132:135]
    ds_read_b64_tr_b16 v[78:79], v11 offset:16896
    v_mfma_f32_16x16x32_bf16 v[136:139], v[64:67], v[120:123], v[136:139]
    s_add_u32 m0, s59, 49152
    s_mov_b32 s60, 360576
    v_mfma_f32_16x16x32_bf16 v[140:143], v[64:67], v[124:127], v[140:143]
    s_waitcnt lgkmcnt(4)
    buffer_load_dwordx4 v16, s[20:23], s60 offen offset:0 lds
    v_mfma_f32_16x16x32_bf16 v[156:159], v[68:71], v[124:127], v[156:159]
    s_waitcnt vmcnt(13)
    ds_read_b64_tr_b16 v[80:81], v4 offset:16384
    v_mfma_f32_16x16x32_bf16 v[152:155], v[68:71], v[120:123], v[152:155]
    ds_read_b64_tr_b16 v[82:83], v4 offset:16896
    v_mfma_f32_16x16x32_bf16 v[148:151], v[68:71], v[116:119], v[148:151]
    ds_read_b64_tr_b16 v[96:97], v63 offset:40960
    ds_read_b64_tr_b16 v[98:99], v63 offset:41472
    v_mfma_f32_16x16x32_bf16 v[144:147], v[68:71], v[112:115], v[144:147]
    s_waitcnt lgkmcnt(6)
    buffer_load_dwordx4 v17, s[20:23], s60 offen offset:1024 lds
    v_mfma_f32_16x16x32_bf16 v[160:163], v[72:75], v[112:115], v[160:163]
    ds_read_b64_tr_b16 v[84:85], v5 offset:16384
    v_mfma_f32_16x16x32_bf16 v[164:167], v[72:75], v[116:119], v[164:167]
    ds_read_b64_tr_b16 v[86:87], v5 offset:16896
    v_mfma_f32_16x16x32_bf16 v[168:171], v[72:75], v[120:123], v[168:171]
    ds_read_b64_tr_b16 v[100:101], v63 offset:41984
    ds_read_b64_tr_b16 v[102:103], v63 offset:42496
    v_mfma_f32_16x16x32_bf16 v[172:175], v[72:75], v[124:127], v[172:175]
    s_waitcnt lgkmcnt(8)
    buffer_load_dwordx4 v18, s[20:23], s60 offen offset:2048 lds
    v_mfma_f32_16x16x32_bf16 v[188:191], v[76:79], v[124:127], v[188:191]
    ds_read_b64_tr_b16 v[88:89], v6 offset:16384
    v_mfma_f32_16x16x32_bf16 v[184:187], v[76:79], v[120:123], v[184:187]
    ds_read_b64_tr_b16 v[90:91], v6 offset:16896
    v_mfma_f32_16x16x32_bf16 v[180:183], v[76:79], v[116:119], v[180:183]
    ds_read_b64_tr_b16 v[104:105], v63 offset:43008
    ds_read_b64_tr_b16 v[106:107], v63 offset:43520
    v_mfma_f32_16x16x32_bf16 v[176:179], v[76:79], v[112:115], v[176:179]
    s_waitcnt lgkmcnt(10)
    buffer_load_dwordx4 v19, s[20:23], s60 offen offset:3072 lds
    v_mfma_f32_16x16x32_bf16 v[192:195], v[80:83], v[112:115], v[192:195]
    ds_read_b64_tr_b16 v[92:93], v7 offset:16384
    v_mfma_f32_16x16x32_bf16 v[196:199], v[80:83], v[116:119], v[196:199]
    ds_read_b64_tr_b16 v[94:95], v7 offset:16896
    v_mfma_f32_16x16x32_bf16 v[200:203], v[80:83], v[120:123], v[200:203]
    s_add_u32 m0, s59, 65536
    s_mov_b32 s60, 393216
    ds_read_b64_tr_b16 v[108:109], v63 offset:44032
    ds_read_b64_tr_b16 v[110:111], v63 offset:44544
    v_mfma_f32_16x16x32_bf16 v[204:207], v[80:83], v[124:127], v[204:207]
    s_waitcnt lgkmcnt(10)
    buffer_load_dwordx4 v16, s[20:23], s60 offen offset:0 lds
    v_mfma_f32_16x16x32_bf16 v[220:223], v[84:87], v[124:127], v[220:223]
    s_waitcnt vmcnt(13)
    ds_read_b64_tr_b16 v[64:65], v8 offset:32768
    v_mfma_f32_16x16x32_bf16 v[216:219], v[84:87], v[120:123], v[216:219]
    ds_read_b64_tr_b16 v[66:67], v8 offset:33280
    v_mfma_f32_16x16x32_bf16 v[212:215], v[84:87], v[116:119], v[212:215]
    v_mfma_f32_16x16x32_bf16 v[208:211], v[84:87], v[112:115], v[208:211]
    s_waitcnt lgkmcnt(8)
    buffer_load_dwordx4 v17, s[20:23], s60 offen offset:1024 lds
    v_mfma_f32_16x16x32_bf16 v[224:227], v[88:91], v[112:115], v[224:227]
    ds_read_b64_tr_b16 v[68:69], v9 offset:32768
    v_mfma_f32_16x16x32_bf16 v[228:231], v[88:91], v[116:119], v[228:231]
    ds_read_b64_tr_b16 v[70:71], v9 offset:33280
    v_mfma_f32_16x16x32_bf16 v[232:235], v[88:91], v[120:123], v[232:235]
    v_mfma_f32_16x16x32_bf16 v[236:239], v[88:91], v[124:127], v[236:239]
    s_waitcnt lgkmcnt(6)
    buffer_load_dwordx4 v18, s[20:23], s60 offen offset:2048 lds
    v_mfma_f32_16x16x32_bf16 v[252:255], v[92:95], v[124:127], v[252:255]
    ds_read_b64_tr_b16 v[72:73], v10 offset:32768
    v_mfma_f32_16x16x32_bf16 v[248:251], v[92:95], v[120:123], v[248:251]
    ds_read_b64_tr_b16 v[74:75], v10 offset:33280
    v_mfma_f32_16x16x32_bf16 v[244:247], v[92:95], v[116:119], v[244:247]
    v_mfma_f32_16x16x32_bf16 v[240:243], v[92:95], v[112:115], v[240:243]
    s_waitcnt lgkmcnt(4)
    buffer_load_dwordx4 v19, s[20:23], s60 offen offset:3072 lds
    v_mfma_f32_16x16x32_bf16 v[128:131], v[64:67], v[96:99], v[128:131]
    ds_read_b64_tr_b16 v[76:77], v11 offset:32768
    v_mfma_f32_16x16x32_bf16 v[132:135], v[64:67], v[100:103], v[132:135]
    ds_read_b64_tr_b16 v[78:79], v11 offset:33280
    v_mfma_f32_16x16x32_bf16 v[136:139], v[64:67], v[104:107], v[136:139]
    s_add_u32 m0, s59, 16384
    s_mov_b32 s60, 393344
    v_mfma_f32_16x16x32_bf16 v[140:143], v[64:67], v[108:111], v[140:143]
    s_waitcnt lgkmcnt(4)
    buffer_load_dwordx4 v16, s[20:23], s60 offen offset:0 lds
    v_mfma_f32_16x16x32_bf16 v[156:159], v[68:71], v[108:111], v[156:159]
    s_waitcnt vmcnt(13)
    ds_read_b64_tr_b16 v[80:81], v4 offset:0
    v_mfma_f32_16x16x32_bf16 v[152:155], v[68:71], v[104:107], v[152:155]
    ds_read_b64_tr_b16 v[82:83], v4 offset:512
    v_mfma_f32_16x16x32_bf16 v[148:151], v[68:71], v[100:103], v[148:151]
    ds_read_b64_tr_b16 v[112:113], v63 offset:57344
    ds_read_b64_tr_b16 v[114:115], v63 offset:57856
    v_mfma_f32_16x16x32_bf16 v[144:147], v[68:71], v[96:99], v[144:147]
    s_waitcnt lgkmcnt(6)
    buffer_load_dwordx4 v17, s[20:23], s60 offen offset:1024 lds
    v_mfma_f32_16x16x32_bf16 v[160:163], v[72:75], v[96:99], v[160:163]
    ds_read_b64_tr_b16 v[84:85], v5 offset:0
    v_mfma_f32_16x16x32_bf16 v[164:167], v[72:75], v[100:103], v[164:167]
    ds_read_b64_tr_b16 v[86:87], v5 offset:512
    v_mfma_f32_16x16x32_bf16 v[168:171], v[72:75], v[104:107], v[168:171]
    ds_read_b64_tr_b16 v[116:117], v63 offset:58368
    ds_read_b64_tr_b16 v[118:119], v63 offset:58880
    v_mfma_f32_16x16x32_bf16 v[172:175], v[72:75], v[108:111], v[172:175]
    s_waitcnt lgkmcnt(8)
    buffer_load_dwordx4 v18, s[20:23], s60 offen offset:2048 lds
    v_mfma_f32_16x16x32_bf16 v[188:191], v[76:79], v[108:111], v[188:191]
    ds_read_b64_tr_b16 v[88:89], v6 offset:0
    v_mfma_f32_16x16x32_bf16 v[184:187], v[76:79], v[104:107], v[184:187]
    ds_read_b64_tr_b16 v[90:91], v6 offset:512
    v_mfma_f32_16x16x32_bf16 v[180:183], v[76:79], v[100:103], v[180:183]
    ds_read_b64_tr_b16 v[120:121], v63 offset:59392
    ds_read_b64_tr_b16 v[122:123], v63 offset:59904
    v_mfma_f32_16x16x32_bf16 v[176:179], v[76:79], v[96:99], v[176:179]
    s_waitcnt lgkmcnt(10)
    buffer_load_dwordx4 v19, s[20:23], s60 offen offset:3072 lds
    v_mfma_f32_16x16x32_bf16 v[192:195], v[80:83], v[96:99], v[192:195]
    ds_read_b64_tr_b16 v[92:93], v7 offset:0
    v_mfma_f32_16x16x32_bf16 v[196:199], v[80:83], v[100:103], v[196:199]
    ds_read_b64_tr_b16 v[94:95], v7 offset:512
    v_mfma_f32_16x16x32_bf16 v[200:203], v[80:83], v[104:107], v[200:203]
    s_add_u32 m0, s59, 81920
    s_mov_b32 s60, 425984
    ds_read_b64_tr_b16 v[124:125], v63 offset:60416
    ds_read_b64_tr_b16 v[126:127], v63 offset:60928
    v_mfma_f32_16x16x32_bf16 v[204:207], v[80:83], v[108:111], v[204:207]
    s_waitcnt lgkmcnt(10)
    buffer_load_dwordx4 v16, s[20:23], s60 offen offset:0 lds
    v_mfma_f32_16x16x32_bf16 v[220:223], v[84:87], v[108:111], v[220:223]
    s_waitcnt vmcnt(13)
    ds_read_b64_tr_b16 v[64:65], v4 offset:32768
    v_mfma_f32_16x16x32_bf16 v[216:219], v[84:87], v[104:107], v[216:219]
    ds_read_b64_tr_b16 v[66:67], v4 offset:33280
    v_mfma_f32_16x16x32_bf16 v[212:215], v[84:87], v[100:103], v[212:215]
    v_mfma_f32_16x16x32_bf16 v[208:211], v[84:87], v[96:99], v[208:211]
    s_waitcnt lgkmcnt(8)
    buffer_load_dwordx4 v17, s[20:23], s60 offen offset:1024 lds
    v_mfma_f32_16x16x32_bf16 v[224:227], v[88:91], v[96:99], v[224:227]
    ds_read_b64_tr_b16 v[68:69], v5 offset:32768
    v_mfma_f32_16x16x32_bf16 v[228:231], v[88:91], v[100:103], v[228:231]
    ds_read_b64_tr_b16 v[70:71], v5 offset:33280
    v_mfma_f32_16x16x32_bf16 v[232:235], v[88:91], v[104:107], v[232:235]
    v_mfma_f32_16x16x32_bf16 v[236:239], v[88:91], v[108:111], v[236:239]
    s_waitcnt lgkmcnt(6)
    buffer_load_dwordx4 v18, s[20:23], s60 offen offset:2048 lds
    v_mfma_f32_16x16x32_bf16 v[252:255], v[92:95], v[108:111], v[252:255]
    ds_read_b64_tr_b16 v[72:73], v6 offset:32768
    v_mfma_f32_16x16x32_bf16 v[248:251], v[92:95], v[104:107], v[248:251]
    ds_read_b64_tr_b16 v[74:75], v6 offset:33280
    v_mfma_f32_16x16x32_bf16 v[244:247], v[92:95], v[100:103], v[244:247]
    v_mfma_f32_16x16x32_bf16 v[240:243], v[92:95], v[96:99], v[240:243]
    s_waitcnt lgkmcnt(4)
    buffer_load_dwordx4 v19, s[20:23], s60 offen offset:3072 lds
    v_mfma_f32_16x16x32_bf16 v[128:131], v[64:67], v[112:115], v[128:131]
    ds_read_b64_tr_b16 v[76:77], v7 offset:32768
    v_mfma_f32_16x16x32_bf16 v[132:135], v[64:67], v[116:119], v[132:135]
    ds_read_b64_tr_b16 v[78:79], v7 offset:33280
    v_mfma_f32_16x16x32_bf16 v[136:139], v[64:67], v[120:123], v[136:139]
    s_add_u32 m0, s59, 0
    s_mov_b32 s60, 426112
    v_mfma_f32_16x16x32_bf16 v[140:143], v[64:67], v[124:127], v[140:143]
    s_waitcnt lgkmcnt(4)
    buffer_load_dwordx4 v16, s[20:23], s60 offen offset:0 lds
    v_mfma_f32_16x16x32_bf16 v[156:159], v[68:71], v[124:127], v[156:159]
    s_waitcnt vmcnt(13)
    ds_read_b64_tr_b16 v[80:81], v8 offset:0
    v_mfma_f32_16x16x32_bf16 v[152:155], v[68:71], v[120:123], v[152:155]
    ds_read_b64_tr_b16 v[82:83], v8 offset:512
    v_mfma_f32_16x16x32_bf16 v[148:151], v[68:71], v[116:119], v[148:151]
    ds_read_b64_tr_b16 v[96:97], v63 offset:12288
    ds_read_b64_tr_b16 v[98:99], v63 offset:12800
    v_mfma_f32_16x16x32_bf16 v[144:147], v[68:71], v[112:115], v[144:147]
    s_waitcnt lgkmcnt(6)
    buffer_load_dwordx4 v17, s[20:23], s60 offen offset:1024 lds
    v_mfma_f32_16x16x32_bf16 v[160:163], v[72:75], v[112:115], v[160:163]
    ds_read_b64_tr_b16 v[84:85], v9 offset:0
    v_mfma_f32_16x16x32_bf16 v[164:167], v[72:75], v[116:119], v[164:167]
    ds_read_b64_tr_b16 v[86:87], v9 offset:512
    v_mfma_f32_16x16x32_bf16 v[168:171], v[72:75], v[120:123], v[168:171]
    ds_read_b64_tr_b16 v[100:101], v63 offset:13312
    ds_read_b64_tr_b16 v[102:103], v63 offset:13824
    v_mfma_f32_16x16x32_bf16 v[172:175], v[72:75], v[124:127], v[172:175]
    s_waitcnt lgkmcnt(8)
    buffer_load_dwordx4 v18, s[20:23], s60 offen offset:2048 lds
    v_mfma_f32_16x16x32_bf16 v[188:191], v[76:79], v[124:127], v[188:191]
    ds_read_b64_tr_b16 v[88:89], v10 offset:0
    v_mfma_f32_16x16x32_bf16 v[184:187], v[76:79], v[120:123], v[184:187]
    ds_read_b64_tr_b16 v[90:91], v10 offset:512
    v_mfma_f32_16x16x32_bf16 v[180:183], v[76:79], v[116:119], v[180:183]
    ds_read_b64_tr_b16 v[104:105], v63 offset:14336
    ds_read_b64_tr_b16 v[106:107], v63 offset:14848
    v_mfma_f32_16x16x32_bf16 v[176:179], v[76:79], v[112:115], v[176:179]
    s_waitcnt lgkmcnt(10)
    buffer_load_dwordx4 v19, s[20:23], s60 offen offset:3072 lds
    v_mfma_f32_16x16x32_bf16 v[192:195], v[80:83], v[112:115], v[192:195]
    ds_read_b64_tr_b16 v[92:93], v11 offset:0
    v_mfma_f32_16x16x32_bf16 v[196:199], v[80:83], v[116:119], v[196:199]
    ds_read_b64_tr_b16 v[94:95], v11 offset:512
    v_mfma_f32_16x16x32_bf16 v[200:203], v[80:83], v[120:123], v[200:203]
    s_add_u32 m0, s59, 32768
    s_mov_b32 s60, 458752
    ds_read_b64_tr_b16 v[108:109], v63 offset:15360
    ds_read_b64_tr_b16 v[110:111], v63 offset:15872
    v_mfma_f32_16x16x32_bf16 v[204:207], v[80:83], v[124:127], v[204:207]
    s_waitcnt lgkmcnt(10)
    buffer_load_dwordx4 v16, s[20:23], s60 offen offset:0 lds
    v_mfma_f32_16x16x32_bf16 v[220:223], v[84:87], v[124:127], v[220:223]
    s_waitcnt vmcnt(13)
    ds_read_b64_tr_b16 v[64:65], v8 offset:16384
    v_mfma_f32_16x16x32_bf16 v[216:219], v[84:87], v[120:123], v[216:219]
    ds_read_b64_tr_b16 v[66:67], v8 offset:16896
    v_mfma_f32_16x16x32_bf16 v[212:215], v[84:87], v[116:119], v[212:215]
    v_mfma_f32_16x16x32_bf16 v[208:211], v[84:87], v[112:115], v[208:211]
    s_waitcnt lgkmcnt(8)
    buffer_load_dwordx4 v17, s[20:23], s60 offen offset:1024 lds
    v_mfma_f32_16x16x32_bf16 v[224:227], v[88:91], v[112:115], v[224:227]
    ds_read_b64_tr_b16 v[68:69], v9 offset:16384
    v_mfma_f32_16x16x32_bf16 v[228:231], v[88:91], v[116:119], v[228:231]
    ds_read_b64_tr_b16 v[70:71], v9 offset:16896
    v_mfma_f32_16x16x32_bf16 v[232:235], v[88:91], v[120:123], v[232:235]
    v_mfma_f32_16x16x32_bf16 v[236:239], v[88:91], v[124:127], v[236:239]
    s_waitcnt lgkmcnt(6)
    buffer_load_dwordx4 v18, s[20:23], s60 offen offset:2048 lds
    v_mfma_f32_16x16x32_bf16 v[252:255], v[92:95], v[124:127], v[252:255]
    ds_read_b64_tr_b16 v[72:73], v10 offset:16384
    v_mfma_f32_16x16x32_bf16 v[248:251], v[92:95], v[120:123], v[248:251]
    ds_read_b64_tr_b16 v[74:75], v10 offset:16896
    v_mfma_f32_16x16x32_bf16 v[244:247], v[92:95], v[116:119], v[244:247]
    v_mfma_f32_16x16x32_bf16 v[240:243], v[92:95], v[112:115], v[240:243]
    s_waitcnt lgkmcnt(4)
    buffer_load_dwordx4 v19, s[20:23], s60 offen offset:3072 lds
    v_mfma_f32_16x16x32_bf16 v[128:131], v[64:67], v[96:99], v[128:131]
    ds_read_b64_tr_b16 v[76:77], v11 offset:16384
    v_mfma_f32_16x16x32_bf16 v[132:135], v[64:67], v[100:103], v[132:135]
    ds_read_b64_tr_b16 v[78:79], v11 offset:16896
    v_mfma_f32_16x16x32_bf16 v[136:139], v[64:67], v[104:107], v[136:139]
    s_add_u32 m0, s59, 49152
    s_mov_b32 s60, 458880
    v_mfma_f32_16x16x32_bf16 v[140:143], v[64:67], v[108:111], v[140:143]
    s_waitcnt lgkmcnt(4)
    buffer_load_dwordx4 v16, s[20:23], s60 offen offset:0 lds
    v_mfma_f32_16x16x32_bf16 v[156:159], v[68:71], v[108:111], v[156:159]
    s_waitcnt vmcnt(13)
    ds_read_b64_tr_b16 v[80:81], v4 offset:16384
    v_mfma_f32_16x16x32_bf16 v[152:155], v[68:71], v[104:107], v[152:155]
    ds_read_b64_tr_b16 v[82:83], v4 offset:16896
    v_mfma_f32_16x16x32_bf16 v[148:151], v[68:71], v[100:103], v[148:151]
    ds_read_b64_tr_b16 v[112:113], v63 offset:28672
    ds_read_b64_tr_b16 v[114:115], v63 offset:29184
    v_mfma_f32_16x16x32_bf16 v[144:147], v[68:71], v[96:99], v[144:147]
    s_waitcnt lgkmcnt(6)
    buffer_load_dwordx4 v17, s[20:23], s60 offen offset:1024 lds
    v_mfma_f32_16x16x32_bf16 v[160:163], v[72:75], v[96:99], v[160:163]
    ds_read_b64_tr_b16 v[84:85], v5 offset:16384
    v_mfma_f32_16x16x32_bf16 v[164:167], v[72:75], v[100:103], v[164:167]
    ds_read_b64_tr_b16 v[86:87], v5 offset:16896
    v_mfma_f32_16x16x32_bf16 v[168:171], v[72:75], v[104:107], v[168:171]
    ds_read_b64_tr_b16 v[116:117], v63 offset:29696
    ds_read_b64_tr_b16 v[118:119], v63 offset:30208
    v_mfma_f32_16x16x32_bf16 v[172:175], v[72:75], v[108:111], v[172:175]
    s_waitcnt lgkmcnt(8)
    buffer_load_dwordx4 v18, s[20:23], s60 offen offset:2048 lds
    v_mfma_f32_16x16x32_bf16 v[188:191], v[76:79], v[108:111], v[188:191]
    ds_read_b64_tr_b16 v[88:89], v6 offset:16384
    v_mfma_f32_16x16x32_bf16 v[184:187], v[76:79], v[104:107], v[184:187]
    ds_read_b64_tr_b16 v[90:91], v6 offset:16896
    v_mfma_f32_16x16x32_bf16 v[180:183], v[76:79], v[100:103], v[180:183]
    ds_read_b64_tr_b16 v[120:121], v63 offset:30720
    ds_read_b64_tr_b16 v[122:123], v63 offset:31232
    v_mfma_f32_16x16x32_bf16 v[176:179], v[76:79], v[96:99], v[176:179]
    s_waitcnt lgkmcnt(10)
    buffer_load_dwordx4 v19, s[20:23], s60 offen offset:3072 lds
    v_mfma_f32_16x16x32_bf16 v[192:195], v[80:83], v[96:99], v[192:195]
    ds_read_b64_tr_b16 v[92:93], v7 offset:16384
    v_mfma_f32_16x16x32_bf16 v[196:199], v[80:83], v[100:103], v[196:199]
    ds_read_b64_tr_b16 v[94:95], v7 offset:16896
    v_mfma_f32_16x16x32_bf16 v[200:203], v[80:83], v[104:107], v[200:203]
    s_add_u32 m0, s59, 65536
    s_mov_b32 s60, 491520
    ds_read_b64_tr_b16 v[124:125], v63 offset:31744
    ds_read_b64_tr_b16 v[126:127], v63 offset:32256
    v_mfma_f32_16x16x32_bf16 v[204:207], v[80:83], v[108:111], v[204:207]
    s_waitcnt lgkmcnt(10)
    buffer_load_dwordx4 v16, s[20:23], s60 offen offset:0 lds
    v_mfma_f32_16x16x32_bf16 v[220:223], v[84:87], v[108:111], v[220:223]
    s_waitcnt vmcnt(13)
    ds_read_b64_tr_b16 v[64:65], v8 offset:32768
    v_mfma_f32_16x16x32_bf16 v[216:219], v[84:87], v[104:107], v[216:219]
    ds_read_b64_tr_b16 v[66:67], v8 offset:33280
    v_mfma_f32_16x16x32_bf16 v[212:215], v[84:87], v[100:103], v[212:215]
    v_mfma_f32_16x16x32_bf16 v[208:211], v[84:87], v[96:99], v[208:211]
    s_waitcnt lgkmcnt(8)
    buffer_load_dwordx4 v17, s[20:23], s60 offen offset:1024 lds
    v_mfma_f32_16x16x32_bf16 v[224:227], v[88:91], v[96:99], v[224:227]
    ds_read_b64_tr_b16 v[68:69], v9 offset:32768
    v_mfma_f32_16x16x32_bf16 v[228:231], v[88:91], v[100:103], v[228:231]
    ds_read_b64_tr_b16 v[70:71], v9 offset:33280
    v_mfma_f32_16x16x32_bf16 v[232:235], v[88:91], v[104:107], v[232:235]
    v_mfma_f32_16x16x32_bf16 v[236:239], v[88:91], v[108:111], v[236:239]
    s_waitcnt lgkmcnt(6)
    buffer_load_dwordx4 v18, s[20:23], s60 offen offset:2048 lds
    v_mfma_f32_16x16x32_bf16 v[252:255], v[92:95], v[108:111], v[252:255]
    ds_read_b64_tr_b16 v[72:73], v10 offset:32768
    v_mfma_f32_16x16x32_bf16 v[248:251], v[92:95], v[104:107], v[248:251]
    ds_read_b64_tr_b16 v[74:75], v10 offset:33280
    v_mfma_f32_16x16x32_bf16 v[244:247], v[92:95], v[100:103], v[244:247]
    v_mfma_f32_16x16x32_bf16 v[240:243], v[92:95], v[96:99], v[240:243]
    s_waitcnt lgkmcnt(4)
    buffer_load_dwordx4 v19, s[20:23], s60 offen offset:3072 lds
    v_mfma_f32_16x16x32_bf16 v[128:131], v[64:67], v[112:115], v[128:131]
    ds_read_b64_tr_b16 v[76:77], v11 offset:32768
    v_mfma_f32_16x16x32_bf16 v[132:135], v[64:67], v[116:119], v[132:135]
    ds_read_b64_tr_b16 v[78:79], v11 offset:33280
    v_mfma_f32_16x16x32_bf16 v[136:139], v[64:67], v[120:123], v[136:139]
    s_add_u32 m0, s59, 16384
    s_mov_b32 s60, 491648
    v_mfma_f32_16x16x32_bf16 v[140:143], v[64:67], v[124:127], v[140:143]
    s_waitcnt lgkmcnt(4)
    buffer_load_dwordx4 v16, s[20:23], s60 offen offset:0 lds
    v_mfma_f32_16x16x32_bf16 v[156:159], v[68:71], v[124:127], v[156:159]
    s_waitcnt vmcnt(13)
    ds_read_b64_tr_b16 v[80:81], v4 offset:0
    v_mfma_f32_16x16x32_bf16 v[152:155], v[68:71], v[120:123], v[152:155]
    ds_read_b64_tr_b16 v[82:83], v4 offset:512
    v_mfma_f32_16x16x32_bf16 v[148:151], v[68:71], v[116:119], v[148:151]
    ds_read_b64_tr_b16 v[96:97], v63 offset:45056
    ds_read_b64_tr_b16 v[98:99], v63 offset:45568
    v_mfma_f32_16x16x32_bf16 v[144:147], v[68:71], v[112:115], v[144:147]
    s_waitcnt lgkmcnt(6)
    buffer_load_dwordx4 v17, s[20:23], s60 offen offset:1024 lds
    v_mfma_f32_16x16x32_bf16 v[160:163], v[72:75], v[112:115], v[160:163]
    ds_read_b64_tr_b16 v[84:85], v5 offset:0
    v_mfma_f32_16x16x32_bf16 v[164:167], v[72:75], v[116:119], v[164:167]
    ds_read_b64_tr_b16 v[86:87], v5 offset:512
    v_mfma_f32_16x16x32_bf16 v[168:171], v[72:75], v[120:123], v[168:171]
    ds_read_b64_tr_b16 v[100:101], v63 offset:46080
    ds_read_b64_tr_b16 v[102:103], v63 offset:46592
    v_mfma_f32_16x16x32_bf16 v[172:175], v[72:75], v[124:127], v[172:175]
    s_waitcnt lgkmcnt(8)
    buffer_load_dwordx4 v18, s[20:23], s60 offen offset:2048 lds
    v_mfma_f32_16x16x32_bf16 v[188:191], v[76:79], v[124:127], v[188:191]
    ds_read_b64_tr_b16 v[88:89], v6 offset:0
    v_mfma_f32_16x16x32_bf16 v[184:187], v[76:79], v[120:123], v[184:187]
    ds_read_b64_tr_b16 v[90:91], v6 offset:512
    v_mfma_f32_16x16x32_bf16 v[180:183], v[76:79], v[116:119], v[180:183]
    ds_read_b64_tr_b16 v[104:105], v63 offset:47104
    ds_read_b64_tr_b16 v[106:107], v63 offset:47616
    v_mfma_f32_16x16x32_bf16 v[176:179], v[76:79], v[112:115], v[176:179]
    s_waitcnt lgkmcnt(10)
    buffer_load_dwordx4 v19, s[20:23], s60 offen offset:3072 lds
    v_mfma_f32_16x16x32_bf16 v[192:195], v[80:83], v[112:115], v[192:195]
    ds_read_b64_tr_b16 v[92:93], v7 offset:0
    v_mfma_f32_16x16x32_bf16 v[196:199], v[80:83], v[116:119], v[196:199]
    ds_read_b64_tr_b16 v[94:95], v7 offset:512
    v_mfma_f32_16x16x32_bf16 v[200:203], v[80:83], v[120:123], v[200:203]
    s_add_u32 m0, s59, 81920
    s_mov_b32 s60, 262144
    ds_read_b64_tr_b16 v[108:109], v63 offset:48128
    ds_read_b64_tr_b16 v[110:111], v63 offset:48640
    v_mfma_f32_16x16x32_bf16 v[204:207], v[80:83], v[124:127], v[204:207]
    s_waitcnt lgkmcnt(10)
    buffer_load_dwordx4 v12, s[32:35], s60 offen offset:0 lds
    v_mfma_f32_16x16x32_bf16 v[220:223], v[84:87], v[124:127], v[220:223]
    s_waitcnt vmcnt(13)
    ds_read_b64_tr_b16 v[64:65], v4 offset:32768
    v_mfma_f32_16x16x32_bf16 v[216:219], v[84:87], v[120:123], v[216:219]
    ds_read_b64_tr_b16 v[66:67], v4 offset:33280
    v_mfma_f32_16x16x32_bf16 v[212:215], v[84:87], v[116:119], v[212:215]
    v_mfma_f32_16x16x32_bf16 v[208:211], v[84:87], v[112:115], v[208:211]
    s_waitcnt lgkmcnt(8)
    buffer_load_dwordx4 v13, s[32:35], s60 offen offset:1024 lds
    v_mfma_f32_16x16x32_bf16 v[224:227], v[88:91], v[112:115], v[224:227]
    ds_read_b64_tr_b16 v[68:69], v5 offset:32768
    v_mfma_f32_16x16x32_bf16 v[228:231], v[88:91], v[116:119], v[228:231]
    ds_read_b64_tr_b16 v[70:71], v5 offset:33280
    v_mfma_f32_16x16x32_bf16 v[232:235], v[88:91], v[120:123], v[232:235]
    v_mfma_f32_16x16x32_bf16 v[236:239], v[88:91], v[124:127], v[236:239]
    s_waitcnt lgkmcnt(6)
    buffer_load_dwordx4 v14, s[32:35], s60 offen offset:2048 lds
    v_mfma_f32_16x16x32_bf16 v[252:255], v[92:95], v[124:127], v[252:255]
    ds_read_b64_tr_b16 v[72:73], v6 offset:32768
    v_mfma_f32_16x16x32_bf16 v[248:251], v[92:95], v[120:123], v[248:251]
    ds_read_b64_tr_b16 v[74:75], v6 offset:33280
    v_mfma_f32_16x16x32_bf16 v[244:247], v[92:95], v[116:119], v[244:247]
    v_mfma_f32_16x16x32_bf16 v[240:243], v[92:95], v[112:115], v[240:243]
    s_waitcnt lgkmcnt(4)
    buffer_load_dwordx4 v15, s[32:35], s60 offen offset:3072 lds
    v_mfma_f32_16x16x32_bf16 v[128:131], v[64:67], v[96:99], v[128:131]
    ds_read_b64_tr_b16 v[76:77], v7 offset:32768
    v_mfma_f32_16x16x32_bf16 v[132:135], v[64:67], v[100:103], v[132:135]
    ds_read_b64_tr_b16 v[78:79], v7 offset:33280
    v_mfma_f32_16x16x32_bf16 v[136:139], v[64:67], v[104:107], v[136:139]
    s_add_u32 m0, s59, 0
    s_mov_b32 s60, 294912
    v_mfma_f32_16x16x32_bf16 v[140:143], v[64:67], v[108:111], v[140:143]
    s_waitcnt lgkmcnt(4)
    buffer_load_dwordx4 v12, s[32:35], s60 offen offset:0 lds
    v_mfma_f32_16x16x32_bf16 v[156:159], v[68:71], v[108:111], v[156:159]
    s_waitcnt vmcnt(13)
    ds_read_b64_tr_b16 v[80:81], v8 offset:0
    v_mfma_f32_16x16x32_bf16 v[152:155], v[68:71], v[104:107], v[152:155]
    ds_read_b64_tr_b16 v[82:83], v8 offset:512
    v_mfma_f32_16x16x32_bf16 v[148:151], v[68:71], v[100:103], v[148:151]
    ds_read_b64_tr_b16 v[112:113], v63 offset:61440
    ds_read_b64_tr_b16 v[114:115], v63 offset:61952
    v_mfma_f32_16x16x32_bf16 v[144:147], v[68:71], v[96:99], v[144:147]
    s_waitcnt lgkmcnt(6)
    buffer_load_dwordx4 v13, s[32:35], s60 offen offset:1024 lds
    v_mfma_f32_16x16x32_bf16 v[160:163], v[72:75], v[96:99], v[160:163]
    ds_read_b64_tr_b16 v[84:85], v9 offset:0
    v_mfma_f32_16x16x32_bf16 v[164:167], v[72:75], v[100:103], v[164:167]
    ds_read_b64_tr_b16 v[86:87], v9 offset:512
    v_mfma_f32_16x16x32_bf16 v[168:171], v[72:75], v[104:107], v[168:171]
    ds_read_b64_tr_b16 v[116:117], v63 offset:62464
    ds_read_b64_tr_b16 v[118:119], v63 offset:62976
    v_mfma_f32_16x16x32_bf16 v[172:175], v[72:75], v[108:111], v[172:175]
    s_waitcnt lgkmcnt(8)
    buffer_load_dwordx4 v14, s[32:35], s60 offen offset:2048 lds
    v_mfma_f32_16x16x32_bf16 v[188:191], v[76:79], v[108:111], v[188:191]
    ds_read_b64_tr_b16 v[88:89], v10 offset:0
    v_mfma_f32_16x16x32_bf16 v[184:187], v[76:79], v[104:107], v[184:187]
    ds_read_b64_tr_b16 v[90:91], v10 offset:512
    v_mfma_f32_16x16x32_bf16 v[180:183], v[76:79], v[100:103], v[180:183]
    ds_read_b64_tr_b16 v[120:121], v63 offset:63488
    ds_read_b64_tr_b16 v[122:123], v63 offset:64000
    v_mfma_f32_16x16x32_bf16 v[176:179], v[76:79], v[96:99], v[176:179]
    s_waitcnt lgkmcnt(10)
    buffer_load_dwordx4 v15, s[32:35], s60 offen offset:3072 lds
    v_mfma_f32_16x16x32_bf16 v[192:195], v[80:83], v[96:99], v[192:195]
    ds_read_b64_tr_b16 v[92:93], v11 offset:0
    v_mfma_f32_16x16x32_bf16 v[196:199], v[80:83], v[100:103], v[196:199]
    ds_read_b64_tr_b16 v[94:95], v11 offset:512
    v_mfma_f32_16x16x32_bf16 v[200:203], v[80:83], v[104:107], v[200:203]
    s_add_u32 m0, s59, 32768
    s_mov_b32 s60, 327680
    ds_read_b64_tr_b16 v[124:125], v63 offset:64512
    ds_read_b64_tr_b16 v[126:127], v63 offset:65024
    v_mfma_f32_16x16x32_bf16 v[204:207], v[80:83], v[108:111], v[204:207]
    s_waitcnt lgkmcnt(10)
    buffer_load_dwordx4 v12, s[32:35], s60 offen offset:0 lds
    v_mfma_f32_16x16x32_bf16 v[220:223], v[84:87], v[108:111], v[220:223]
    s_waitcnt vmcnt(13)
    ds_read_b64_tr_b16 v[64:65], v8 offset:16384
    v_mfma_f32_16x16x32_bf16 v[216:219], v[84:87], v[104:107], v[216:219]
    ds_read_b64_tr_b16 v[66:67], v8 offset:16896
    v_mfma_f32_16x16x32_bf16 v[212:215], v[84:87], v[100:103], v[212:215]
    v_mfma_f32_16x16x32_bf16 v[208:211], v[84:87], v[96:99], v[208:211]
    s_waitcnt lgkmcnt(8)
    buffer_load_dwordx4 v13, s[32:35], s60 offen offset:1024 lds
    v_mfma_f32_16x16x32_bf16 v[224:227], v[88:91], v[96:99], v[224:227]
    ds_read_b64_tr_b16 v[68:69], v9 offset:16384
    v_mfma_f32_16x16x32_bf16 v[228:231], v[88:91], v[100:103], v[228:231]
    ds_read_b64_tr_b16 v[70:71], v9 offset:16896
    v_mfma_f32_16x16x32_bf16 v[232:235], v[88:91], v[104:107], v[232:235]
    v_mfma_f32_16x16x32_bf16 v[236:239], v[88:91], v[108:111], v[236:239]
    s_waitcnt lgkmcnt(6)
    buffer_load_dwordx4 v14, s[32:35], s60 offen offset:2048 lds
    v_mfma_f32_16x16x32_bf16 v[252:255], v[92:95], v[108:111], v[252:255]
    ds_read_b64_tr_b16 v[72:73], v10 offset:16384
    v_mfma_f32_16x16x32_bf16 v[248:251], v[92:95], v[104:107], v[248:251]
    ds_read_b64_tr_b16 v[74:75], v10 offset:16896
    v_mfma_f32_16x16x32_bf16 v[244:247], v[92:95], v[100:103], v[244:247]
    v_mfma_f32_16x16x32_bf16 v[240:243], v[92:95], v[96:99], v[240:243]
    s_waitcnt lgkmcnt(4)
    buffer_load_dwordx4 v15, s[32:35], s60 offen offset:3072 lds
    v_mfma_f32_16x16x32_bf16 v[128:131], v[64:67], v[112:115], v[128:131]
    ds_read_b64_tr_b16 v[76:77], v11 offset:16384
    v_mfma_f32_16x16x32_bf16 v[132:135], v[64:67], v[116:119], v[132:135]
    ds_read_b64_tr_b16 v[78:79], v11 offset:16896
    s_lshl_b32 s57, s76, 3
    s_add_u32 s57, s57, s77
    s_lshl_b32 s57, s57, 7
    s_mov_b32 s62, 0
    s_lshl_b32 s3, s77, 16
    s_lshl_b32 s63, s54, 11
    s_add_u32 s3, s3, s63
    v_mfma_f32_16x16x32_bf16 v[136:139], v[64:67], v[120:123], v[136:139]
    s_add_u32 m0, s59, 49152
    s_mov_b32 s60, 360448
    v_mfma_f32_16x16x32_bf16 v[140:143], v[64:67], v[124:127], v[140:143]
    s_waitcnt lgkmcnt(4)
    buffer_load_dwordx4 v12, s[32:35], s60 offen offset:0 lds
    v_mfma_f32_16x16x32_bf16 v[156:159], v[68:71], v[124:127], v[156:159]
    s_waitcnt vmcnt(13)
    ds_read_b64_tr_b16 v[80:81], v4 offset:16384
    v_mfma_f32_16x16x32_bf16 v[152:155], v[68:71], v[120:123], v[152:155]
    ds_read_b64_tr_b16 v[82:83], v4 offset:16896
    v_mfma_f32_16x16x32_bf16 v[148:151], v[68:71], v[116:119], v[148:151]
    v_mfma_f32_16x16x32_bf16 v[144:147], v[68:71], v[112:115], v[144:147]
    s_waitcnt lgkmcnt(4)
    buffer_load_dwordx4 v13, s[32:35], s60 offen offset:1024 lds
    v_mfma_f32_16x16x32_bf16 v[160:163], v[72:75], v[112:115], v[160:163]
    ds_read_b64_tr_b16 v[84:85], v5 offset:16384
    v_mfma_f32_16x16x32_bf16 v[164:167], v[72:75], v[116:119], v[164:167]
    ds_read_b64_tr_b16 v[86:87], v5 offset:16896
    v_mfma_f32_16x16x32_bf16 v[168:171], v[72:75], v[120:123], v[168:171]
    v_mfma_f32_16x16x32_bf16 v[172:175], v[72:75], v[124:127], v[172:175]
    s_waitcnt lgkmcnt(4)
    buffer_load_dwordx4 v14, s[32:35], s60 offen offset:2048 lds
    v_mfma_f32_16x16x32_bf16 v[188:191], v[76:79], v[124:127], v[188:191]
    ds_read_b64_tr_b16 v[88:89], v6 offset:16384
    v_mfma_f32_16x16x32_bf16 v[184:187], v[76:79], v[120:123], v[184:187]
    ds_read_b64_tr_b16 v[90:91], v6 offset:16896
    v_mfma_f32_16x16x32_bf16 v[180:183], v[76:79], v[116:119], v[180:183]
    v_mfma_f32_16x16x32_bf16 v[176:179], v[76:79], v[112:115], v[176:179]
    s_waitcnt lgkmcnt(4)
    buffer_load_dwordx4 v15, s[32:35], s60 offen offset:3072 lds
    v_mfma_f32_16x16x32_bf16 v[192:195], v[80:83], v[112:115], v[192:195]
    ds_read_b64_tr_b16 v[92:93], v7 offset:16384
    v_mfma_f32_16x16x32_bf16 v[196:199], v[80:83], v[116:119], v[196:199]
    ds_read_b64_tr_b16 v[94:95], v7 offset:16896
    v_mfma_f32_16x16x32_bf16 v[200:203], v[80:83], v[120:123], v[200:203]
    s_add_u32 m0, s59, 65536
    s_mov_b32 s60, 393216
    v_mfma_f32_16x16x32_bf16 v[204:207], v[80:83], v[124:127], v[204:207]
    s_waitcnt lgkmcnt(4)
    buffer_load_dwordx4 v12, s[32:35], s60 offen offset:0 lds
    v_mfma_f32_16x16x32_bf16 v[220:223], v[84:87], v[124:127], v[220:223]
    s_waitcnt vmcnt(13)
    ds_read_b64_tr_b16 v[64:65], v8 offset:32768
    v_mfma_f32_16x16x32_bf16 v[216:219], v[84:87], v[120:123], v[216:219]
    ds_read_b64_tr_b16 v[66:67], v8 offset:33280
    v_mfma_f32_16x16x32_bf16 v[212:215], v[84:87], v[116:119], v[212:215]
    v_mfma_f32_16x16x32_bf16 v[208:211], v[84:87], v[112:115], v[208:211]
    s_waitcnt lgkmcnt(4)
    buffer_load_dwordx4 v13, s[32:35], s60 offen offset:1024 lds
    v_mfma_f32_16x16x32_bf16 v[224:227], v[88:91], v[112:115], v[224:227]
    ds_read_b64_tr_b16 v[68:69], v9 offset:32768
    v_mfma_f32_16x16x32_bf16 v[228:231], v[88:91], v[116:119], v[228:231]
    ds_read_b64_tr_b16 v[70:71], v9 offset:33280
    v_mfma_f32_16x16x32_bf16 v[232:235], v[88:91], v[120:123], v[232:235]
    v_mfma_f32_16x16x32_bf16 v[236:239], v[88:91], v[124:127], v[236:239]
    s_waitcnt lgkmcnt(4)
    buffer_load_dwordx4 v14, s[32:35], s60 offen offset:2048 lds
    v_mfma_f32_16x16x32_bf16 v[252:255], v[92:95], v[124:127], v[252:255]
    ds_read_b64_tr_b16 v[72:73], v10 offset:32768
    v_mfma_f32_16x16x32_bf16 v[248:251], v[92:95], v[120:123], v[248:251]
    ds_read_b64_tr_b16 v[74:75], v10 offset:33280
    v_mfma_f32_16x16x32_bf16 v[244:247], v[92:95], v[116:119], v[244:247]
    v_mfma_f32_16x16x32_bf16 v[240:243], v[92:95], v[112:115], v[240:243]
    s_waitcnt lgkmcnt(4)
    buffer_load_dwordx4 v15, s[32:35], s60 offen offset:3072 lds
    v_mfma_f32_16x16x32_bf16 a[128:131], v[64:67], a[16:19], a[128:131]
    ds_read_b64_tr_b16 v[76:77], v11 offset:32768
    v_mfma_f32_16x16x32_bf16 a[132:135], v[64:67], a[20:23], a[132:135]
    ds_read_b64_tr_b16 v[78:79], v11 offset:33280
    v_mfma_f32_16x16x32_bf16 a[136:139], v[64:67], a[24:27], a[136:139]
    s_add_u32 m0, s59, 16384
    s_mov_b32 s60, 425984
    v_mfma_f32_16x16x32_bf16 a[140:143], v[64:67], a[28:31], a[140:143]
    s_waitcnt lgkmcnt(4)
    buffer_load_dwordx4 v12, s[32:35], s60 offen offset:0 lds
    v_mfma_f32_16x16x32_bf16 a[156:159], v[68:71], a[28:31], a[156:159]
    s_waitcnt vmcnt(13)
    ds_read_b64_tr_b16 v[80:81], v4 offset:0
    v_mfma_f32_16x16x32_bf16 a[152:155], v[68:71], a[24:27], a[152:155]
    ds_read_b64_tr_b16 v[82:83], v4 offset:512
    v_mfma_f32_16x16x32_bf16 a[148:151], v[68:71], a[20:23], a[148:151]
    v_mfma_f32_16x16x32_bf16 a[144:147], v[68:71], a[16:19], a[144:147]
    s_waitcnt lgkmcnt(4)
    buffer_load_dwordx4 v13, s[32:35], s60 offen offset:1024 lds
    v_mfma_f32_16x16x32_bf16 a[224:227], v[72:75], a[16:19], a[224:227]
    s_add_u32 s56, s58, 0
    s_add_u32 s61, s58, 4096
    s_add_u32 s65, s58, 65536
    s_add_u32 s66, s58, 69632
    ds_read_b64_tr_b16 v[84:85], v5 offset:0
    v_cvt_pk_bf16_f32 v128, v128, v129
    v_mfma_f32_16x16x32_bf16 a[228:231], v[72:75], a[20:23], a[228:231]
    ds_read_b64_tr_b16 v[86:87], v5 offset:512
    v_cvt_pk_bf16_f32 v129, v130, v131
    v_mfma_f32_16x16x32_bf16 a[232:235], v[72:75], a[24:27], a[232:235]
    v_cvt_pk_bf16_f32 v130, v144, v145
    v_cvt_pk_bf16_f32 v131, v146, v147
    v_mfma_f32_16x16x32_bf16 a[236:239], v[72:75], a[28:31], a[236:239]
    s_waitcnt lgkmcnt(4)
    buffer_load_dwordx4 v14, s[32:35], s60 offen offset:2048 lds
    v_cvt_pk_bf16_f32 v132, v132, v133
    v_mfma_f32_16x16x32_bf16 a[252:255], v[76:79], a[28:31], a[252:255]
    ds_read_b64_tr_b16 v[88:89], v6 offset:0
    v_cvt_pk_bf16_f32 v133, v134, v135
    v_mfma_f32_16x16x32_bf16 a[248:251], v[76:79], a[24:27], a[248:251]
    ds_read_b64_tr_b16 v[90:91], v6 offset:512
    v_cvt_pk_bf16_f32 v134, v148, v149
    v_mfma_f32_16x16x32_bf16 a[244:247], v[76:79], a[20:23], a[244:247]
    buffer_store_dwordx4 v[128:131], v2, s[48:51], s56 offen offset:0 sc1
    v_cvt_pk_bf16_f32 v135, v150, v151
    v_mfma_f32_16x16x32_bf16 a[240:243], v[76:79], a[16:19], a[240:243]
    s_waitcnt lgkmcnt(4)
    buffer_load_dwordx4 v15, s[32:35], s60 offen offset:3072 lds
    v_cvt_pk_bf16_f32 v136, v136, v137
    v_mfma_f32_16x16x32_bf16 a[128:131], v[80:83], a[48:51], a[128:131]
    ds_read_b64_tr_b16 v[92:93], v7 offset:0
    v_cvt_pk_bf16_f32 v137, v138, v139
    v_mfma_f32_16x16x32_bf16 a[132:135], v[80:83], a[52:55], a[132:135]
    ds_read_b64_tr_b16 v[94:95], v7 offset:512
    v_cvt_pk_bf16_f32 v138, v152, v153
    v_mfma_f32_16x16x32_bf16 a[136:139], v[80:83], a[56:59], a[136:139]
    buffer_load_dword v49, v51, s[4:7], s57 offen offset:0 sc1
    v_cvt_pk_bf16_f32 v139, v154, v155
    v_mfma_f32_16x16x32_bf16 a[140:143], v[80:83], a[60:63], a[140:143]
    s_waitcnt lgkmcnt(4)
    v_cvt_pk_bf16_f32 v140, v140, v141
    v_cvt_pk_bf16_f32 v141, v142, v143
    v_mfma_f32_16x16x32_bf16 a[156:159], v[84:87], a[60:63], a[156:159]
    s_waitcnt vmcnt(14)
    ds_read_b64_tr_b16 v[64:65], v4 offset:32768
    v_cvt_pk_bf16_f32 v142, v156, v157
    v_mfma_f32_16x16x32_bf16 a[152:155], v[84:87], a[56:59], a[152:155]
    ds_read_b64_tr_b16 v[66:67], v4 offset:33280
    v_cvt_pk_bf16_f32 v143, v158, v159
    v_mfma_f32_16x16x32_bf16 a[148:151], v[84:87], a[52:55], a[148:151]
    buffer_store_dwordx4 v[132:135], v2, s[48:51], s56 offen offset:2048 sc1
    v_cvt_pk_bf16_f32 v160, v160, v161
    v_mfma_f32_16x16x32_bf16 a[144:147], v[84:87], a[48:51], a[144:147]
    s_waitcnt lgkmcnt(4)
    v_cvt_pk_bf16_f32 v161, v162, v163
    v_cvt_pk_bf16_f32 v162, v176, v177
    v_mfma_f32_16x16x32_bf16 a[224:227], v[88:91], a[48:51], a[224:227]
    ds_read_b64_tr_b16 v[68:69], v5 offset:32768
    v_cvt_pk_bf16_f32 v163, v178, v179
    v_mfma_f32_16x16x32_bf16 a[228:231], v[88:91], a[52:55], a[228:231]
    ds_read_b64_tr_b16 v[70:71], v5 offset:33280
    v_cvt_pk_bf16_f32 v164, v164, v165
    v_mfma_f32_16x16x32_bf16 a[232:235], v[88:91], a[56:59], a[232:235]
    v_cvt_pk_bf16_f32 v165, v166, v167
    v_cvt_pk_bf16_f32 v166, v180, v181
    v_mfma_f32_16x16x32_bf16 a[236:239], v[88:91], a[60:63], a[236:239]
    s_waitcnt lgkmcnt(4)
    v_cvt_pk_bf16_f32 v167, v182, v183
    v_cvt_pk_bf16_f32 v168, v168, v169
    v_mfma_f32_16x16x32_bf16 a[252:255], v[92:95], a[60:63], a[252:255]
    ds_read_b64_tr_b16 v[72:73], v6 offset:32768
    v_cvt_pk_bf16_f32 v169, v170, v171
    v_mfma_f32_16x16x32_bf16 a[248:251], v[92:95], a[56:59], a[248:251]
    ds_read_b64_tr_b16 v[74:75], v6 offset:33280
    v_cvt_pk_bf16_f32 v170, v184, v185
    v_mfma_f32_16x16x32_bf16 a[244:247], v[92:95], a[52:55], a[244:247]
    buffer_store_dwordx4 v[136:139], v2, s[48:51], s61 offen offset:0 sc1
    v_cvt_pk_bf16_f32 v171, v186, v187
    v_mfma_f32_16x16x32_bf16 a[240:243], v[92:95], a[48:51], a[240:243]
    s_waitcnt lgkmcnt(4)
    v_cvt_pk_bf16_f32 v172, v172, v173
    v_cvt_pk_bf16_f32 v173, v174, v175
    v_mfma_f32_16x16x32_bf16 a[128:131], v[64:67], a[80:83], a[128:131]
    ds_read_b64_tr_b16 v[76:77], v7 offset:32768
    v_cvt_pk_bf16_f32 v174, v188, v189
    v_mfma_f32_16x16x32_bf16 a[132:135], v[64:67], a[84:87], a[132:135]
    ds_read_b64_tr_b16 v[78:79], v7 offset:33280
    v_cvt_pk_bf16_f32 v175, v190, v191
    v_mfma_f32_16x16x32_bf16 a[136:139], v[64:67], a[88:91], a[136:139]
    v_cvt_pk_bf16_f32 v192, v192, v193
    v_cvt_pk_bf16_f32 v193, v194, v195
    v_mfma_f32_16x16x32_bf16 a[140:143], v[64:67], a[92:95], a[140:143]
    s_waitcnt lgkmcnt(4)
    v_cvt_pk_bf16_f32 v194, v208, v209
    v_cvt_pk_bf16_f32 v195, v210, v211
    v_mfma_f32_16x16x32_bf16 a[156:159], v[68:71], a[92:95], a[156:159]
    s_waitcnt vmcnt(12)
    ds_read_b64_tr_b16 v[80:81], v8 offset:0
    v_cvt_pk_bf16_f32 v196, v196, v197
    v_mfma_f32_16x16x32_bf16 a[152:155], v[68:71], a[88:91], a[152:155]
    ds_read_b64_tr_b16 v[82:83], v8 offset:512
    v_cvt_pk_bf16_f32 v197, v198, v199
    v_mfma_f32_16x16x32_bf16 a[148:151], v[68:71], a[84:87], a[148:151]
    buffer_store_dwordx4 v[140:143], v2, s[48:51], s61 offen offset:2048 sc1
    v_cvt_pk_bf16_f32 v198, v212, v213
    v_mfma_f32_16x16x32_bf16 a[144:147], v[68:71], a[80:83], a[144:147]
    s_waitcnt lgkmcnt(4)
    v_cvt_pk_bf16_f32 v199, v214, v215
    v_cvt_pk_bf16_f32 v200, v200, v201
    v_mfma_f32_16x16x32_bf16 a[224:227], v[72:75], a[80:83], a[224:227]
    ds_read_b64_tr_b16 v[84:85], v9 offset:0
    v_cvt_pk_bf16_f32 v201, v202, v203
    v_mfma_f32_16x16x32_bf16 a[228:231], v[72:75], a[84:87], a[228:231]
    ds_read_b64_tr_b16 v[86:87], v9 offset:512
    v_cvt_pk_bf16_f32 v202, v216, v217
    v_mfma_f32_16x16x32_bf16 a[232:235], v[72:75], a[88:91], a[232:235]
    v_cvt_pk_bf16_f32 v203, v218, v219
    v_cvt_pk_bf16_f32 v204, v204, v205
    v_mfma_f32_16x16x32_bf16 a[236:239], v[72:75], a[92:95], a[236:239]
    s_waitcnt lgkmcnt(4)
    v_cvt_pk_bf16_f32 v205, v206, v207
    v_cvt_pk_bf16_f32 v206, v220, v221
    v_mfma_f32_16x16x32_bf16 a[252:255], v[76:79], a[92:95], a[252:255]
    ds_read_b64_tr_b16 v[88:89], v10 offset:0
    v_cvt_pk_bf16_f32 v207, v222, v223
    v_mfma_f32_16x16x32_bf16 a[248:251], v[76:79], a[88:91], a[248:251]
    ds_read_b64_tr_b16 v[90:91], v10 offset:512
    v_cvt_pk_bf16_f32 v224, v224, v225
    v_mfma_f32_16x16x32_bf16 a[244:247], v[76:79], a[84:87], a[244:247]
    buffer_store_dwordx4 v[160:163], v2, s[48:51], s56 offen offset:1024 sc1
    v_cvt_pk_bf16_f32 v225, v226, v227
    v_mfma_f32_16x16x32_bf16 a[240:243], v[76:79], a[80:83], a[240:243]
    s_waitcnt lgkmcnt(4)
    v_cvt_pk_bf16_f32 v226, v240, v241
    v_cvt_pk_bf16_f32 v227, v242, v243
    v_mfma_f32_16x16x32_bf16 a[128:131], v[80:83], a[112:115], a[128:131]
    ds_read_b64_tr_b16 v[92:93], v11 offset:0
    v_cvt_pk_bf16_f32 v228, v228, v229
    v_mfma_f32_16x16x32_bf16 a[132:135], v[80:83], a[116:119], a[132:135]
    ds_read_b64_tr_b16 v[94:95], v11 offset:512
    v_cvt_pk_bf16_f32 v229, v230, v231
    v_mfma_f32_16x16x32_bf16 a[136:139], v[80:83], a[120:123], a[136:139]
    v_cvt_pk_bf16_f32 v230, v244, v245
    v_cvt_pk_bf16_f32 v231, v246, v247
    v_mfma_f32_16x16x32_bf16 a[140:143], v[80:83], a[124:127], a[140:143]
    s_waitcnt lgkmcnt(4)
    v_cvt_pk_bf16_f32 v232, v232, v233
    v_cvt_pk_bf16_f32 v233, v234, v235
    v_mfma_f32_16x16x32_bf16 a[156:159], v[84:87], a[124:127], a[156:159]
    s_waitcnt vmcnt(10)
    ds_read_b64_tr_b16 v[64:65], v8 offset:16384
    v_cvt_pk_bf16_f32 v234, v248, v249
    v_mfma_f32_16x16x32_bf16 a[152:155], v[84:87], a[120:123], a[152:155]
    ds_read_b64_tr_b16 v[66:67], v8 offset:16896
    v_cvt_pk_bf16_f32 v235, v250, v251
    v_mfma_f32_16x16x32_bf16 a[148:151], v[84:87], a[116:119], a[148:151]
    buffer_store_dwordx4 v[164:167], v2, s[48:51], s56 offen offset:3072 sc1
    v_cvt_pk_bf16_f32 v236, v236, v237
    v_mfma_f32_16x16x32_bf16 a[144:147], v[84:87], a[112:115], a[144:147]
    s_waitcnt lgkmcnt(4)
    v_cvt_pk_bf16_f32 v237, v238, v239
    v_cvt_pk_bf16_f32 v238, v252, v253
    v_mfma_f32_16x16x32_bf16 a[224:227], v[88:91], a[112:115], a[224:227]
    ds_read_b64_tr_b16 v[68:69], v9 offset:16384
    v_cvt_pk_bf16_f32 v239, v254, v255
    v_mfma_f32_16x16x32_bf16 a[228:231], v[88:91], a[116:119], a[228:231]
    ds_read_b64_tr_b16 v[70:71], v9 offset:16896
    v_mfma_f32_16x16x32_bf16 a[232:235], v[88:91], a[120:123], a[232:235]
    v_mfma_f32_16x16x32_bf16 a[236:239], v[88:91], a[124:127], a[236:239]
    s_waitcnt lgkmcnt(4)
    v_mfma_f32_16x16x32_bf16 a[252:255], v[92:95], a[124:127], a[252:255]
    ds_read_b64_tr_b16 v[72:73], v10 offset:16384
    v_mfma_f32_16x16x32_bf16 a[248:251], v[92:95], a[120:123], a[248:251]
    ds_read_b64_tr_b16 v[74:75], v10 offset:16896
    v_mfma_f32_16x16x32_bf16 a[244:247], v[92:95], a[116:119], a[244:247]
    buffer_store_dwordx4 v[168:171], v2, s[48:51], s61 offen offset:1024 sc1
    v_mfma_f32_16x16x32_bf16 a[240:243], v[92:95], a[112:115], a[240:243]
    s_waitcnt lgkmcnt(4)
    v_mfma_f32_16x16x32_bf16 a[128:131], v[64:67], a[160:163], a[128:131]
    ds_read_b64_tr_b16 v[76:77], v11 offset:16384
    v_mfma_f32_16x16x32_bf16 a[132:135], v[64:67], a[164:167], a[132:135]
    ds_read_b64_tr_b16 v[78:79], v11 offset:16896
    v_mfma_f32_16x16x32_bf16 a[136:139], v[64:67], a[168:171], a[136:139]
    v_mfma_f32_16x16x32_bf16 a[140:143], v[64:67], a[172:175], a[140:143]
    s_waitcnt lgkmcnt(4)
    v_mfma_f32_16x16x32_bf16 a[156:159], v[68:71], a[172:175], a[156:159]
    s_waitcnt vmcnt(7)
    ds_read_b64_tr_b16 v[80:81], v4 offset:16384
    v_mfma_f32_16x16x32_bf16 a[152:155], v[68:71], a[168:171], a[152:155]
    ds_read_b64_tr_b16 v[82:83], v4 offset:16896
    v_mfma_f32_16x16x32_bf16 a[148:151], v[68:71], a[164:167], a[148:151]
    buffer_store_dwordx4 v[172:175], v2, s[48:51], s61 offen offset:3072 sc1
    v_mfma_f32_16x16x32_bf16 a[144:147], v[68:71], a[160:163], a[144:147]
    s_waitcnt lgkmcnt(4)
    v_mfma_f32_16x16x32_bf16 a[224:227], v[72:75], a[160:163], a[224:227]
    ds_read_b64_tr_b16 v[84:85], v5 offset:16384
    v_mfma_f32_16x16x32_bf16 a[228:231], v[72:75], a[164:167], a[228:231]
    ds_read_b64_tr_b16 v[86:87], v5 offset:16896
    v_mfma_f32_16x16x32_bf16 a[232:235], v[72:75], a[168:171], a[232:235]
    v_mfma_f32_16x16x32_bf16 a[236:239], v[72:75], a[172:175], a[236:239]
    s_waitcnt lgkmcnt(4)
    v_mfma_f32_16x16x32_bf16 a[252:255], v[76:79], a[172:175], a[252:255]
    ds_read_b64_tr_b16 v[88:89], v6 offset:16384
    v_mfma_f32_16x16x32_bf16 a[248:251], v[76:79], a[168:171], a[248:251]
    ds_read_b64_tr_b16 v[90:91], v6 offset:16896
    v_mfma_f32_16x16x32_bf16 a[244:247], v[76:79], a[164:167], a[244:247]
    buffer_store_dwordx4 v[192:195], v2, s[48:51], s65 offen offset:0 sc1
    v_mfma_f32_16x16x32_bf16 a[240:243], v[76:79], a[160:163], a[240:243]
    s_waitcnt lgkmcnt(4)
    v_mfma_f32_16x16x32_bf16 a[128:131], v[80:83], a[176:179], a[128:131]
    ds_read_b64_tr_b16 v[92:93], v7 offset:16384
    v_mfma_f32_16x16x32_bf16 a[132:135], v[80:83], a[180:183], a[132:135]
    ds_read_b64_tr_b16 v[94:95], v7 offset:16896
    v_mfma_f32_16x16x32_bf16 a[136:139], v[80:83], a[184:187], a[136:139]
    v_mfma_f32_16x16x32_bf16 a[140:143], v[80:83], a[188:191], a[140:143]
    s_waitcnt lgkmcnt(4)
    v_mfma_f32_16x16x32_bf16 a[156:159], v[84:87], a[188:191], a[156:159]
    v_mfma_f32_16x16x32_bf16 a[152:155], v[84:87], a[184:187], a[152:155]
    v_mfma_f32_16x16x32_bf16 a[148:151], v[84:87], a[180:183], a[148:151]
    buffer_store_dwordx4 v[196:199], v2, s[48:51], s65 offen offset:2048 sc1
    v_mfma_f32_16x16x32_bf16 a[144:147], v[84:87], a[176:179], a[144:147]
    s_waitcnt lgkmcnt(2)
    v_mfma_f32_16x16x32_bf16 a[224:227], v[88:91], a[176:179], a[224:227]
    v_mfma_f32_16x16x32_bf16 a[228:231], v[88:91], a[180:183], a[228:231]
    v_mfma_f32_16x16x32_bf16 a[232:235], v[88:91], a[184:187], a[232:235]
    v_mfma_f32_16x16x32_bf16 a[236:239], v[88:91], a[188:191], a[236:239]
    s_waitcnt lgkmcnt(0)
    v_mfma_f32_16x16x32_bf16 a[252:255], v[92:95], a[188:191], a[252:255]
    v_mfma_f32_16x16x32_bf16 a[248:251], v[92:95], a[184:187], a[248:251]
    v_mfma_f32_16x16x32_bf16 a[244:247], v[92:95], a[180:183], a[244:247]
    buffer_store_dwordx4 v[200:203], v2, s[48:51], s66 offen offset:0 sc1
    v_mfma_f32_16x16x32_bf16 a[240:243], v[92:95], a[176:179], a[240:243]
    s_nop 5
    ds_write_b128 v50, a[128:131] offset:0
    ds_write_b128 v50, a[144:147] offset:1024
    ds_write_b128 v50, a[224:227] offset:2048
    ds_write_b128 v50, a[240:243] offset:3072
    ds_write_b128 v50, a[132:135] offset:16384
    ds_write_b128 v50, a[148:151] offset:17408
    ds_write_b128 v50, a[228:231] offset:18432
    ds_write_b128 v50, a[244:247] offset:19456
    buffer_store_dwordx4 v[204:207], v2, s[48:51], s66 offen offset:2048 sc1
    ds_write_b128 v50, a[136:139] offset:32768
    ds_write_b128 v50, a[152:155] offset:33792
    ds_write_b128 v50, a[232:235] offset:34816
    ds_write_b128 v50, a[248:251] offset:35840
    s_waitcnt lgkmcnt(11)
    ds_write_b128 v50, a[140:143] offset:49152
    s_waitcnt lgkmcnt(11)
    ds_write_b128 v50, a[156:159] offset:50176
    s_waitcnt lgkmcnt(11)
    ds_write_b128 v50, a[236:239] offset:51200
    s_waitcnt lgkmcnt(11)
    ds_write_b128 v50, a[252:255] offset:52224
    buffer_store_dwordx4 v[224:227], v2, s[48:51], s65 offen offset:1024 sc1
    v_mov_b64 v[80:81], 0
    v_mov_b64 v[82:83], 0
    v_mov_b64 v[84:85], 0
    v_mov_b64 v[86:87], 0
    v_mov_b64 v[88:89], 0
    v_mov_b64 v[90:91], 0
    v_mov_b64 v[92:93], 0
    v_mov_b64 v[94:95], 0
    s_waitcnt lgkmcnt(0)
    s_barrier
    ds_read_b128 v[144:147], v55 offset:0
    ds_read_b128 v[148:151], v55 offset:1024
    ds_read_b128 v[152:155], v55 offset:2048
    ds_read_b128 v[156:159], v55 offset:3072
    ds_read_b128 v[176:179], v55 offset:4096
    ds_read_b128 v[180:183], v55 offset:5120
    ds_read_b128 v[184:187], v55 offset:6144
    ds_read_b128 v[188:191], v55 offset:7168
    ds_read_b128 v[208:211], v55 offset:8192
    ds_read_b128 v[212:215], v55 offset:9216
    ds_read_b128 v[216:219], v55 offset:10240
    ds_read_b128 v[220:223], v55 offset:11264
    ds_read_b128 v[240:243], v55 offset:12288
    ds_read_b128 v[244:247], v55 offset:13312
    s_waitcnt lgkmcnt(13)
    ds_read_b128 v[248:251], v55 offset:14336
    s_waitcnt lgkmcnt(13)
    ds_read_b128 v[252:255], v55 offset:15360
    buffer_store_dwordx4 v[228:231], v2, s[48:51], s65 offen offset:3072 sc1
    buffer_store_dwordx4 v[232:235], v2, s[48:51], s66 offen offset:1024 sc1
    buffer_store_dwordx4 v[236:239], v2, s[48:51], s66 offen offset:3072 sc1
    s_waitcnt lgkmcnt(0)
    v_pk_add_f32 v[144:145], v[144:145], v[176:177]
    v_pk_add_f32 v[208:209], v[208:209], v[240:241]
    v_pk_add_f32 v[146:147], v[146:147], v[178:179]
    v_pk_add_f32 v[210:211], v[210:211], v[242:243]
    v_pk_add_f32 v[148:149], v[148:149], v[180:181]
    v_pk_add_f32 v[212:213], v[212:213], v[244:245]
    v_pk_add_f32 v[150:151], v[150:151], v[182:183]
    v_pk_add_f32 v[214:215], v[214:215], v[246:247]
    v_pk_add_f32 v[152:153], v[152:153], v[184:185]
    v_pk_add_f32 v[216:217], v[216:217], v[248:249]
    v_pk_add_f32 v[154:155], v[154:155], v[186:187]
    v_pk_add_f32 v[218:219], v[218:219], v[250:251]
    v_pk_add_f32 v[156:157], v[156:157], v[188:189]
    v_pk_add_f32 v[220:221], v[220:221], v[252:253]
    v_pk_add_f32 v[158:159], v[158:159], v[190:191]
    v_pk_add_f32 v[222:223], v[222:223], v[254:255]
    v_pk_add_f32 v[96:97], v[144:145], v[208:209]
    v_pk_add_f32 v[98:99], v[146:147], v[210:211]
    v_pk_add_f32 v[100:101], v[148:149], v[212:213]
    v_pk_add_f32 v[102:103], v[150:151], v[214:215]
    v_pk_add_f32 v[104:105], v[152:153], v[216:217]
    v_pk_add_f32 v[106:107], v[154:155], v[218:219]
    v_pk_add_f32 v[108:109], v[156:157], v[220:221]
    v_pk_add_f32 v[110:111], v[158:159], v[222:223]
    v_mul_f32 v64, 0xbfb8aa3b, v96
    v_mul_f32 v65, 0xbfb8aa3b, v97
    v_mul_f32 v66, 0xbfb8aa3b, v98
    v_mul_f32 v67, 0xbfb8aa3b, v99
    v_mul_f32 v68, 0xbfb8aa3b, v100
    v_mul_f32 v69, 0xbfb8aa3b, v101
    v_mul_f32 v70, 0xbfb8aa3b, v102
    v_mul_f32 v71, 0xbfb8aa3b, v103
    v_mul_f32 v72, 0xbfb8aa3b, v104
    v_mul_f32 v73, 0xbfb8aa3b, v105
    v_mul_f32 v74, 0xbfb8aa3b, v106
    v_mul_f32 v75, 0xbfb8aa3b, v107
    v_mul_f32 v76, 0xbfb8aa3b, v108
    v_mul_f32 v77, 0xbfb8aa3b, v109
    v_mul_f32 v78, 0xbfb8aa3b, v110
    v_mul_f32 v79, 0xbfb8aa3b, v111
    v_exp_f32 v64, v64
    v_exp_f32 v65, v65
    v_exp_f32 v66, v66
    v_exp_f32 v67, v67
    v_exp_f32 v68, v68
    v_exp_f32 v69, v69
    v_exp_f32 v70, v70
    v_exp_f32 v71, v71
    v_exp_f32 v72, v72
    v_exp_f32 v73, v73
    v_exp_f32 v74, v74
    v_exp_f32 v75, v75
    v_exp_f32 v76, v76
    v_exp_f32 v77, v77
    v_exp_f32 v78, v78
    v_exp_f32 v79, v79
    v_add_f32 v64, 1.0, v64
    v_add_f32 v65, 1.0, v65
    v_add_f32 v66, 1.0, v66
    v_add_f32 v67, 1.0, v67
    v_add_f32 v68, 1.0, v68
    v_add_f32 v69, 1.0, v69
    v_add_f32 v70, 1.0, v70
    v_add_f32 v71, 1.0, v71
    v_add_f32 v72, 1.0, v72
    v_add_f32 v73, 1.0, v73
    v_add_f32 v74, 1.0, v74
    v_add_f32 v75, 1.0, v75
    v_add_f32 v76, 1.0, v76
    v_add_f32 v77, 1.0, v77
    v_add_f32 v78, 1.0, v78
    v_add_f32 v79, 1.0, v79
    v_rcp_f32 v64, v64
    v_rcp_f32 v65, v65
    v_rcp_f32 v66, v66
    v_rcp_f32 v67, v67
    v_rcp_f32 v68, v68
    v_rcp_f32 v69, v69
    v_rcp_f32 v70, v70
    v_rcp_f32 v71, v71
    v_rcp_f32 v72, v72
    v_rcp_f32 v73, v73
    v_rcp_f32 v74, v74
    v_rcp_f32 v75, v75
    v_rcp_f32 v76, v76
    v_rcp_f32 v77, v77
    v_rcp_f32 v78, v78
    v_rcp_f32 v79, v79
    v_mul_f32 v96, v96, v64
    v_mul_f32 v97, v97, v65
    v_mul_f32 v98, v98, v66
    v_mul_f32 v99, v99, v67
    v_mul_f32 v100, v100, v68
    v_mul_f32 v101, v101, v69
    v_mul_f32 v102, v102, v70
    v_mul_f32 v103, v103, v71
    v_mul_f32 v104, v104, v72
    v_mul_f32 v105, v105, v73
    v_mul_f32 v106, v106, v74
    v_mul_f32 v107, v107, v75
    v_mul_f32 v108, v108, v76
    v_mul_f32 v109, v109, v77
    v_mul_f32 v110, v110, v78
    v_mul_f32 v111, v111, v79
    v_lshlrev_b32 v64, 16, v40
    v_and_b32 v65, 0xffff0000, v40
    v_lshlrev_b32 v66, 16, v41
    v_and_b32 v67, 0xffff0000, v41
    v_lshlrev_b32 v68, 16, v42
    v_and_b32 v69, 0xffff0000, v42
    v_lshlrev_b32 v70, 16, v43
    v_and_b32 v71, 0xffff0000, v43
    v_lshlrev_b32 v72, 16, v44
    v_and_b32 v73, 0xffff0000, v44
    v_lshlrev_b32 v74, 16, v45
    v_and_b32 v75, 0xffff0000, v45
    v_lshlrev_b32 v76, 16, v46
    v_and_b32 v77, 0xffff0000, v46
    v_lshlrev_b32 v78, 16, v47
    v_and_b32 v79, 0xffff0000, v47
    s_waitcnt vmcnt(0)
    v_mov_b32 v3, 1
    s_mov_b64 exec, 1
    buffer_store_dword v3, off, s[4:7], s79 offset:0 sc1
    s_mov_b64 exec, -1
    v_mov_b32 v3, 1
    s_mov_b64 exec, 1
    buffer_store_dword v3, off, s[4:7], s79 offset:128 sc1
    s_mov_b64 exec, -1
    v_cmp_eq_u32 vcc, 1, v49
    s_nop 1
    s_and_b32 s62, vcc_lo, 255
    s_add_u32 s55, s3, 0
    s_bitcmp1_b32 s62, 0
    s_cselect_b32 s55, s55, 524288
    buffer_load_dwordx4 v[128:131], v2, s[84:87], s55 offen offset:0 sc1
    buffer_load_dwordx4 v[132:135], v2, s[84:87], s55 offen offset:1024 sc1
    s_add_u32 s55, s3, 8192
    s_bitcmp1_b32 s62, 1
    s_cselect_b32 s55, s55, 524288
    buffer_load_dwordx4 v[136:139], v2, s[84:87], s55 offen offset:0 sc1
    buffer_load_dwordx4 v[140:143], v2, s[84:87], s55 offen offset:1024 sc1
    s_add_u32 s55, s3, 16384
    s_bitcmp1_b32 s62, 2
    s_cselect_b32 s55, s55, 524288
    buffer_load_dwordx4 v[160:163], v2, s[84:87], s55 offen offset:0 sc1
    buffer_load_dwordx4 v[164:167], v2, s[84:87], s55 offen offset:1024 sc1
    s_add_u32 s55, s3, 24576
    s_bitcmp1_b32 s62, 3
    s_cselect_b32 s55, s55, 524288
    buffer_load_dwordx4 v[168:171], v2, s[84:87], s55 offen offset:0 sc1
    buffer_load_dwordx4 v[172:175], v2, s[84:87], s55 offen offset:1024 sc1
    s_add_u32 s55, s3, 32768
    s_bitcmp1_b32 s62, 4
    s_cselect_b32 s55, s55, 524288
    buffer_load_dwordx4 v[192:195], v2, s[84:87], s55 offen offset:0 sc1
    buffer_load_dwordx4 v[196:199], v2, s[84:87], s55 offen offset:1024 sc1
    s_add_u32 s55, s3, 40960
    s_bitcmp1_b32 s62, 5
    s_cselect_b32 s55, s55, 524288
    buffer_load_dwordx4 v[200:203], v2, s[84:87], s55 offen offset:0 sc1
    buffer_load_dwordx4 v[204:207], v2, s[84:87], s55 offen offset:1024 sc1
    s_add_u32 s55, s3, 49152
    s_bitcmp1_b32 s62, 6
    s_cselect_b32 s55, s55, 524288
    buffer_load_dwordx4 v[224:227], v2, s[84:87], s55 offen offset:0 sc1
    buffer_load_dwordx4 v[228:231], v2, s[84:87], s55 offen offset:1024 sc1
    s_add_u32 s55, s3, 57344
    s_bitcmp1_b32 s62, 7
    s_cselect_b32 s55, s55, 524288
    buffer_load_dwordx4 v[232:235], v2, s[84:87], s55 offen offset:0 sc1
    buffer_load_dwordx4 v[236:239], v2, s[84:87], s55 offen offset:1024 sc1
    buffer_load_dword v49, v51, s[4:7], s57 offen offset:0 sc1
    s_mov_b32 s67, s62
    s_mov_b32 s61, 0
L_fin_loop:
    s_waitcnt vmcnt(0)
    v_cmp_eq_u32 vcc, 1, v49
    s_nop 1
    s_andn2_b32 s63, vcc_lo, s62
    s_and_b32 s63, s63, 255
    s_cbranch_scc0 L_in0_end
    s_or_b32 s62, s62, s63
    s_bitcmp1_b32 s63, 0
    s_cbranch_scc0 L_in0_0
    s_add_u32 s55, s3, 0
    buffer_load_dwordx4 v[128:131], v2, s[84:87], s55 offen offset:0 sc1
    buffer_load_dwordx4 v[132:135], v2, s[84:87], s55 offen offset:1024 sc1
L_in0_0:
    s_bitcmp1_b32 s63, 1
    s_cbranch_scc0 L_in0_1
    s_add_u32 s55, s3, 8192
    buffer_load_dwordx4 v[136:139], v2, s[84:87], s55 offen offset:0 sc1
    buffer_load_dwordx4 v[140:143], v2, s[84:87], s55 offen offset:1024 sc1
L_in0_1:
    s_bitcmp1_b32 s63, 2
    s_cbranch_scc0 L_in0_2
    s_add_u32 s55, s3, 16384
    buffer_load_dwordx4 v[160:163], v2, s[84:87], s55 offen offset:0 sc1
    buffer_load_dwordx4 v[164:167], v2, s[84:87], s55 offen offset:1024 sc1
L_in0_2:
    s_bitcmp1_b32 s63, 3
    s_cbranch_scc0 L_in0_3
    s_add_u32 s55, s3, 24576
    buffer_load_dwordx4 v[168:171], v2, s[84:87], s55 offen offset:0 sc1
    buffer_load_dwordx4 v[172:175], v2, s[84:87], s55 offen offset:1024 sc1
L_in0_3:
    s_bitcmp1_b32 s63, 4
    s_cbranch_scc0 L_in0_4
    s_add_u32 s55, s3, 32768
    buffer_load_dwordx4 v[192:195], v2, s[84:87], s55 offen offset:0 sc1
    buffer_load_dwordx4 v[196:199], v2, s[84:87], s55 offen offset:1024 sc1
L_in0_4:
    s_bitcmp1_b32 s63, 5
    s_cbranch_scc0 L_in0_5
    s_add_u32 s55, s3, 40960
    buffer_load_dwordx4 v[200:203], v2, s[84:87], s55 offen offset:0 sc1
    buffer_load_dwordx4 v[204:207], v2, s[84:87], s55 offen offset:1024 sc1
L_in0_5:
    s_bitcmp1_b32 s63, 6
    s_cbranch_scc0 L_in0_6
    s_add_u32 s55, s3, 49152
    buffer_load_dwordx4 v[224:227], v2, s[84:87], s55 offen offset:0 sc1
    buffer_load_dwordx4 v[228:231], v2, s[84:87], s55 offen offset:1024 sc1
L_in0_6:
    s_bitcmp1_b32 s63, 7
    s_cbranch_scc0 L_in0_7
    s_add_u32 s55, s3, 57344
    buffer_load_dwordx4 v[232:235], v2, s[84:87], s55 offen offset:0 sc1
    buffer_load_dwordx4 v[236:239], v2, s[84:87], s55 offen offset:1024 sc1
L_in0_7:
L_in0_end:
    buffer_load_dword v49, v51, s[4:7], s57 offen offset:0 sc1
    s_bitcmp1_b32 s67, 0
    s_cbranch_scc0 L_acc0_0
    v_lshlrev_b32 v112, 16, v128
    v_and_b32 v113, 0xffff0000, v128
    v_lshlrev_b32 v114, 16, v129
    v_and_b32 v115, 0xffff0000, v129
    v_lshlrev_b32 v116, 16, v130
    v_and_b32 v117, 0xffff0000, v130
    v_lshlrev_b32 v118, 16, v131
    v_and_b32 v119, 0xffff0000, v131
    v_lshlrev_b32 v120, 16, v132
    v_and_b32 v121, 0xffff0000, v132
    v_lshlrev_b32 v122, 16, v133
    v_and_b32 v123, 0xffff0000, v133
    v_lshlrev_b32 v124, 16, v134
    v_and_b32 v125, 0xffff0000, v134
    v_lshlrev_b32 v126, 16, v135
    v_and_b32 v127, 0xffff0000, v135
    v_pk_add_f32 v[80:81], v[80:81], v[112:113]
    v_pk_add_f32 v[82:83], v[82:83], v[114:115]
    v_pk_add_f32 v[84:85], v[84:85], v[116:117]
    v_pk_add_f32 v[86:87], v[86:87], v[118:119]
    v_pk_add_f32 v[88:89], v[88:89], v[120:121]
    v_pk_add_f32 v[90:91], v[90:91], v[122:123]
    v_pk_add_f32 v[92:93], v[92:93], v[124:125]
    v_pk_add_f32 v[94:95], v[94:95], v[126:127]
L_acc0_0:
    s_bitcmp1_b32 s67, 1
    s_cbranch_scc0 L_acc0_1
    v_lshlrev_b32 v112, 16, v136
    v_and_b32 v113, 0xffff0000, v136
    v_lshlrev_b32 v114, 16, v137
    v_and_b32 v115, 0xffff0000, v137
    v_lshlrev_b32 v116, 16, v138
    v_and_b32 v117, 0xffff0000, v138
    v_lshlrev_b32 v118, 16, v139
    v_and_b32 v119, 0xffff0000, v139
    v_lshlrev_b32 v120, 16, v140
    v_and_b32 v121, 0xffff0000, v140
    v_lshlrev_b32 v122, 16, v141
    v_and_b32 v123, 0xffff0000, v141
    v_lshlrev_b32 v124, 16, v142
    v_and_b32 v125, 0xffff0000, v142
    v_lshlrev_b32 v126, 16, v143
    v_and_b32 v127, 0xffff0000, v143
    v_pk_add_f32 v[80:81], v[80:81], v[112:113]
    v_pk_add_f32 v[82:83], v[82:83], v[114:115]
    v_pk_add_f32 v[84:85], v[84:85], v[116:117]
    v_pk_add_f32 v[86:87], v[86:87], v[118:119]
    v_pk_add_f32 v[88:89], v[88:89], v[120:121]
    v_pk_add_f32 v[90:91], v[90:91], v[122:123]
    v_pk_add_f32 v[92:93], v[92:93], v[124:125]
    v_pk_add_f32 v[94:95], v[94:95], v[126:127]
L_acc0_1:
    s_bitcmp1_b32 s67, 2
    s_cbranch_scc0 L_acc0_2
    v_lshlrev_b32 v112, 16, v160
    v_and_b32 v113, 0xffff0000, v160
    v_lshlrev_b32 v114, 16, v161
    v_and_b32 v115, 0xffff0000, v161
    v_lshlrev_b32 v116, 16, v162
    v_and_b32 v117, 0xffff0000, v162
    v_lshlrev_b32 v118, 16, v163
    v_and_b32 v119, 0xffff0000, v163
    v_lshlrev_b32 v120, 16, v164
    v_and_b32 v121, 0xffff0000, v164
    v_lshlrev_b32 v122, 16, v165
    v_and_b32 v123, 0xffff0000, v165
    v_lshlrev_b32 v124, 16, v166
    v_and_b32 v125, 0xffff0000, v166
    v_lshlrev_b32 v126, 16, v167
    v_and_b32 v127, 0xffff0000, v167
    v_pk_add_f32 v[80:81], v[80:81], v[112:113]
    v_pk_add_f32 v[82:83], v[82:83], v[114:115]
    v_pk_add_f32 v[84:85], v[84:85], v[116:117]
    v_pk_add_f32 v[86:87], v[86:87], v[118:119]
    v_pk_add_f32 v[88:89], v[88:89], v[120:121]
    v_pk_add_f32 v[90:91], v[90:91], v[122:123]
    v_pk_add_f32 v[92:93], v[92:93], v[124:125]
    v_pk_add_f32 v[94:95], v[94:95], v[126:127]
L_acc0_2:
    s_bitcmp1_b32 s67, 3
    s_cbranch_scc0 L_acc0_3
    v_lshlrev_b32 v112, 16, v168
    v_and_b32 v113, 0xffff0000, v168
    v_lshlrev_b32 v114, 16, v169
    v_and_b32 v115, 0xffff0000, v169
    v_lshlrev_b32 v116, 16, v170
    v_and_b32 v117, 0xffff0000, v170
    v_lshlrev_b32 v118, 16, v171
    v_and_b32 v119, 0xffff0000, v171
    v_lshlrev_b32 v120, 16, v172
    v_and_b32 v121, 0xffff0000, v172
    v_lshlrev_b32 v122, 16, v173
    v_and_b32 v123, 0xffff0000, v173
    v_lshlrev_b32 v124, 16, v174
    v_and_b32 v125, 0xffff0000, v174
    v_lshlrev_b32 v126, 16, v175
    v_and_b32 v127, 0xffff0000, v175
    v_pk_add_f32 v[80:81], v[80:81], v[112:113]
    v_pk_add_f32 v[82:83], v[82:83], v[114:115]
    v_pk_add_f32 v[84:85], v[84:85], v[116:117]
    v_pk_add_f32 v[86:87], v[86:87], v[118:119]
    v_pk_add_f32 v[88:89], v[88:89], v[120:121]
    v_pk_add_f32 v[90:91], v[90:91], v[122:123]
    v_pk_add_f32 v[92:93], v[92:93], v[124:125]
    v_pk_add_f32 v[94:95], v[94:95], v[126:127]
L_acc0_3:
    s_bitcmp1_b32 s67, 4
    s_cbranch_scc0 L_acc0_4
    v_lshlrev_b32 v112, 16, v192
    v_and_b32 v113, 0xffff0000, v192
    v_lshlrev_b32 v114, 16, v193
    v_and_b32 v115, 0xffff0000, v193
    v_lshlrev_b32 v116, 16, v194
    v_and_b32 v117, 0xffff0000, v194
    v_lshlrev_b32 v118, 16, v195
    v_and_b32 v119, 0xffff0000, v195
    v_lshlrev_b32 v120, 16, v196
    v_and_b32 v121, 0xffff0000, v196
    v_lshlrev_b32 v122, 16, v197
    v_and_b32 v123, 0xffff0000, v197
    v_lshlrev_b32 v124, 16, v198
    v_and_b32 v125, 0xffff0000, v198
    v_lshlrev_b32 v126, 16, v199
    v_and_b32 v127, 0xffff0000, v199
    v_pk_add_f32 v[80:81], v[80:81], v[112:113]
    v_pk_add_f32 v[82:83], v[82:83], v[114:115]
    v_pk_add_f32 v[84:85], v[84:85], v[116:117]
    v_pk_add_f32 v[86:87], v[86:87], v[118:119]
    v_pk_add_f32 v[88:89], v[88:89], v[120:121]
    v_pk_add_f32 v[90:91], v[90:91], v[122:123]
    v_pk_add_f32 v[92:93], v[92:93], v[124:125]
    v_pk_add_f32 v[94:95], v[94:95], v[126:127]
L_acc0_4:
    s_bitcmp1_b32 s67, 5
    s_cbranch_scc0 L_acc0_5
    v_lshlrev_b32 v112, 16, v200
    v_and_b32 v113, 0xffff0000, v200
    v_lshlrev_b32 v114, 16, v201
    v_and_b32 v115, 0xffff0000, v201
    v_lshlrev_b32 v116, 16, v202
    v_and_b32 v117, 0xffff0000, v202
    v_lshlrev_b32 v118, 16, v203
    v_and_b32 v119, 0xffff0000, v203
    v_lshlrev_b32 v120, 16, v204
    v_and_b32 v121, 0xffff0000, v204
    v_lshlrev_b32 v122, 16, v205
    v_and_b32 v123, 0xffff0000, v205
    v_lshlrev_b32 v124, 16, v206
    v_and_b32 v125, 0xffff0000, v206
    v_lshlrev_b32 v126, 16, v207
    v_and_b32 v127, 0xffff0000, v207
    v_pk_add_f32 v[80:81], v[80:81], v[112:113]
    v_pk_add_f32 v[82:83], v[82:83], v[114:115]
    v_pk_add_f32 v[84:85], v[84:85], v[116:117]
    v_pk_add_f32 v[86:87], v[86:87], v[118:119]
    v_pk_add_f32 v[88:89], v[88:89], v[120:121]
    v_pk_add_f32 v[90:91], v[90:91], v[122:123]
    v_pk_add_f32 v[92:93], v[92:93], v[124:125]
    v_pk_add_f32 v[94:95], v[94:95], v[126:127]
L_acc0_5:
    s_bitcmp1_b32 s67, 6
    s_cbranch_scc0 L_acc0_6
    v_lshlrev_b32 v112, 16, v224
    v_and_b32 v113, 0xffff0000, v224
    v_lshlrev_b32 v114, 16, v225
    v_and_b32 v115, 0xffff0000, v225
    v_lshlrev_b32 v116, 16, v226
    v_and_b32 v117, 0xffff0000, v226
    v_lshlrev_b32 v118, 16, v227
    v_and_b32 v119, 0xffff0000, v227
    v_lshlrev_b32 v120, 16, v228
    v_and_b32 v121, 0xffff0000, v228
    v_lshlrev_b32 v122, 16, v229
    v_and_b32 v123, 0xffff0000, v229
    v_lshlrev_b32 v124, 16, v230
    v_and_b32 v125, 0xffff0000, v230
    v_lshlrev_b32 v126, 16, v231
    v_and_b32 v127, 0xffff0000, v231
    v_pk_add_f32 v[80:81], v[80:81], v[112:113]
    v_pk_add_f32 v[82:83], v[82:83], v[114:115]
    v_pk_add_f32 v[84:85], v[84:85], v[116:117]
    v_pk_add_f32 v[86:87], v[86:87], v[118:119]
    v_pk_add_f32 v[88:89], v[88:89], v[120:121]
    v_pk_add_f32 v[90:91], v[90:91], v[122:123]
    v_pk_add_f32 v[92:93], v[92:93], v[124:125]
    v_pk_add_f32 v[94:95], v[94:95], v[126:127]
L_acc0_6:
    s_bitcmp1_b32 s67, 7
    s_cbranch_scc0 L_acc0_7
    v_lshlrev_b32 v112, 16, v232
    v_and_b32 v113, 0xffff0000, v232
    v_lshlrev_b32 v114, 16, v233
    v_and_b32 v115, 0xffff0000, v233
    v_lshlrev_b32 v116, 16, v234
    v_and_b32 v117, 0xffff0000, v234
    v_lshlrev_b32 v118, 16, v235
    v_and_b32 v119, 0xffff0000, v235
    v_lshlrev_b32 v120, 16, v236
    v_and_b32 v121, 0xffff0000, v236
    v_lshlrev_b32 v122, 16, v237
    v_and_b32 v123, 0xffff0000, v237
    v_lshlrev_b32 v124, 16, v238
    v_and_b32 v125, 0xffff0000, v238
    v_lshlrev_b32 v126, 16, v239
    v_and_b32 v127, 0xffff0000, v239
    v_pk_add_f32 v[80:81], v[80:81], v[112:113]
    v_pk_add_f32 v[82:83], v[82:83], v[114:115]
    v_pk_add_f32 v[84:85], v[84:85], v[116:117]
    v_pk_add_f32 v[86:87], v[86:87], v[118:119]
    v_pk_add_f32 v[88:89], v[88:89], v[120:121]
    v_pk_add_f32 v[90:91], v[90:91], v[122:123]
    v_pk_add_f32 v[92:93], v[92:93], v[124:125]
    v_pk_add_f32 v[94:95], v[94:95], v[126:127]
L_acc0_7:
    s_mov_b32 s67, s63
    s_add_u32 s61, s61, 1
    s_cmp_ge_u32 s61, 50000
    s_cbranch_scc1 L_fin_done
    s_cmp_lg_u32 s67, 0
    s_cbranch_scc1 L_fin_loop
    s_cmp_lg_u32 s62, 255
    s_cbranch_scc1 L_fin_loop
L_fin_done:
    v_pk_fma_f32 v[64:65], v[80:81], v[96:97], v[64:65]
    v_pk_fma_f32 v[66:67], v[82:83], v[98:99], v[66:67]
    v_pk_fma_f32 v[68:69], v[84:85], v[100:101], v[68:69]
    v_pk_fma_f32 v[70:71], v[86:87], v[102:103], v[70:71]
    v_pk_fma_f32 v[72:73], v[88:89], v[104:105], v[72:73]
    v_pk_fma_f32 v[74:75], v[90:91], v[106:107], v[74:75]
    v_pk_fma_f32 v[76:77], v[92:93], v[108:109], v[76:77]
    v_pk_fma_f32 v[78:79], v[94:95], v[110:111], v[78:79]
    v_cvt_pk_bf16_f32 v40, v64, v65
    v_cvt_pk_bf16_f32 v41, v66, v67
    v_cvt_pk_bf16_f32 v42, v68, v69
    v_cvt_pk_bf16_f32 v43, v70, v71
    v_cvt_pk_bf16_f32 v44, v72, v73
    v_cvt_pk_bf16_f32 v45, v74, v75
    v_cvt_pk_bf16_f32 v46, v76, v77
    v_cvt_pk_bf16_f32 v47, v78, v79
    buffer_store_dwordx2 v[40:41], v48, s[36:39], 0 offen offset:0
    buffer_store_dwordx2 v[42:43], v48, s[36:39], 0 offen offset:32
    buffer_store_dwordx2 v[44:45], v48, s[36:39], 0 offen offset:64
    buffer_store_dwordx2 v[46:47], v48, s[36:39], 0 offen offset:96
L_end:
    s_endpgm
L_sigH_side:
    s_lshl_b32 s56, s53, 3
    s_add_u32 s56, s56, s52
    s_mov_b64 exec, 2
    buffer_store_byte v38, off, s[40:43], s56 sc1
    s_mov_b64 exec, -1
    s_branch L_sigH_ret
L_fallback:
    s_waitcnt vmcnt(0) lgkmcnt(0)
    s_mov_b32 s64, 1
    s_lshl_b32 s55, s54, 6
    v_add_u32 v0, s55, v1
    s_barrier
    s_branch L_restart
L_maxpass:
    s_waitcnt vmcnt(0) lgkmcnt(0)
    s_mov_b32 s64, 2
    s_mov_b32 s46, 0
    s_mov_b32 s62, 0
    v_mov_b32 v40, 0xff800000
    v_mov_b32 v41, 0xff800000
    v_mov_b32 v42, 0xff800000
    v_mov_b32 v43, 0xff800000
L_fb_loop:
    s_barrier
    s_add_u32 m0, s59, 65536
    s_nop 0
    buffer_load_dwordx4 v32, s[8:11], s62 offen offset:0 lds
    buffer_load_dwordx4 v33, s[8:11], s62 offen offset:1024 lds
    buffer_load_dwordx4 v34, s[8:11], s62 offen offset:2048 lds
    buffer_load_dwordx4 v35, s[8:11], s62 offen offset:3072 lds
    s_waitcnt vmcnt(0)
    s_barrier
    ds_read_b128 a[128:131], v20 offset:0
    ds_read_b128 a[132:135], v21 offset:0
    ds_read_b128 a[136:139], v22 offset:0
    ds_read_b128 a[140:143], v23 offset:0
    s_waitcnt lgkmcnt(0)
    v_mfma_f32_16x16x32_bf16 v[64:67], a[128:131], a[0:3], 0
    v_mfma_f32_16x16x32_bf16 v[68:71], a[128:131], a[4:7], 0
    v_mfma_f32_16x16x32_bf16 v[72:75], a[128:131], a[8:11], 0
    v_mfma_f32_16x16x32_bf16 v[76:79], a[128:131], a[12:15], 0
    v_mfma_f32_16x16x32_bf16 v[64:67], a[132:135], a[32:35], v[64:67]
    v_mfma_f32_16x16x32_bf16 v[68:71], a[132:135], a[36:39], v[68:71]
    v_mfma_f32_16x16x32_bf16 v[72:75], a[132:135], a[40:43], v[72:75]
    v_mfma_f32_16x16x32_bf16 v[76:79], a[132:135], a[44:47], v[76:79]
    v_mfma_f32_16x16x32_bf16 v[64:67], a[136:139], a[64:67], v[64:67]
    v_mfma_f32_16x16x32_bf16 v[68:71], a[136:139], a[68:71], v[68:71]
    v_mfma_f32_16x16x32_bf16 v[72:75], a[136:139], a[72:75], v[72:75]
    v_mfma_f32_16x16x32_bf16 v[76:79], a[136:139], a[76:79], v[76:79]
    v_mfma_f32_16x16x32_bf16 v[64:67], a[140:143], a[96:99], v[64:67]
    v_mfma_f32_16x16x32_bf16 v[68:71], a[140:143], a[100:103], v[68:71]
    v_mfma_f32_16x16x32_bf16 v[72:75], a[140:143], a[104:107], v[72:75]
    v_mfma_f32_16x16x32_bf16 v[76:79], a[140:143], a[108:111], v[76:79]
    s_nop 7
    v_max3_f32 v40, v40, v64, v65
    v_max3_f32 v40, v40, v66, v67
    v_max3_f32 v41, v41, v68, v69
    v_max3_f32 v41, v41, v70, v71
    v_max3_f32 v42, v42, v72, v73
    v_max3_f32 v42, v42, v74, v75
    v_max3_f32 v43, v43, v76, v77
    v_max3_f32 v43, v43, v78, v79
    s_nop 2
    ds_read_b128 a[128:131], v20 offset:4096
    ds_read_b128 a[132:135], v21 offset:4096
    ds_read_b128 a[136:139], v22 offset:4096
    ds_read_b128 a[140:143], v23 offset:4096
    s_waitcnt lgkmcnt(0)
    v_mfma_f32_16x16x32_bf16 v[64:67], a[128:131], a[0:3], 0
    v_mfma_f32_16x16x32_bf16 v[68:71], a[128:131], a[4:7], 0
    v_mfma_f32_16x16x32_bf16 v[72:75], a[128:131], a[8:11], 0
    v_mfma_f32_16x16x32_bf16 v[76:79], a[128:131], a[12:15], 0
    v_mfma_f32_16x16x32_bf16 v[64:67], a[132:135], a[32:35], v[64:67]
    v_mfma_f32_16x16x32_bf16 v[68:71], a[132:135], a[36:39], v[68:71]
    v_mfma_f32_16x16x32_bf16 v[72:75], a[132:135], a[40:43], v[72:75]
    v_mfma_f32_16x16x32_bf16 v[76:79], a[132:135], a[44:47], v[76:79]
    v_mfma_f32_16x16x32_bf16 v[64:67], a[136:139], a[64:67], v[64:67]
    v_mfma_f32_16x16x32_bf16 v[68:71], a[136:139], a[68:71], v[68:71]
    v_mfma_f32_16x16x32_bf16 v[72:75], a[136:139], a[72:75], v[72:75]
    v_mfma_f32_16x16x32_bf16 v[76:79], a[136:139], a[76:79], v[76:79]
    v_mfma_f32_16x16x32_bf16 v[64:67], a[140:143], a[96:99], v[64:67]
    v_mfma_f32_16x16x32_bf16 v[68:71], a[140:143], a[100:103], v[68:71]
    v_mfma_f32_16x16x32_bf16 v[72:75], a[140:143], a[104:107], v[72:75]
    v_mfma_f32_16x16x32_bf16 v[76:79], a[140:143], a[108:111], v[76:79]
    s_nop 7
    v_max3_f32 v40, v40, v64, v65
    v_max3_f32 v40, v40, v66, v67
    v_max3_f32 v41, v41, v68, v69
    v_max3_f32 v41, v41, v70, v71
    v_max3_f32 v42, v42, v72, v73
    v_max3_f32 v42, v42, v74, v75
    v_max3_f32 v43, v43, v76, v77
    v_max3_f32 v43, v43, v78, v79
    s_nop 2
    ds_read_b128 a[128:131], v20 offset:8192
    ds_read_b128 a[132:135], v21 offset:8192
    ds_read_b128 a[136:139], v22 offset:8192
    ds_read_b128 a[140:143], v23 offset:8192
    s_waitcnt lgkmcnt(0)
    v_mfma_f32_16x16x32_bf16 v[64:67], a[128:131], a[0:3], 0
    v_mfma_f32_16x16x32_bf16 v[68:71], a[128:131], a[4:7], 0
    v_mfma_f32_16x16x32_bf16 v[72:75], a[128:131], a[8:11], 0
    v_mfma_f32_16x16x32_bf16 v[76:79], a[128:131], a[12:15], 0
    v_mfma_f32_16x16x32_bf16 v[64:67], a[132:135], a[32:35], v[64:67]
    v_mfma_f32_16x16x32_bf16 v[68:71], a[132:135], a[36:39], v[68:71]
    v_mfma_f32_16x16x32_bf16 v[72:75], a[132:135], a[40:43], v[72:75]
    v_mfma_f32_16x16x32_bf16 v[76:79], a[132:135], a[44:47], v[76:79]
    v_mfma_f32_16x16x32_bf16 v[64:67], a[136:139], a[64:67], v[64:67]
    v_mfma_f32_16x16x32_bf16 v[68:71], a[136:139], a[68:71], v[68:71]
    v_mfma_f32_16x16x32_bf16 v[72:75], a[136:139], a[72:75], v[72:75]
    v_mfma_f32_16x16x32_bf16 v[76:79], a[136:139], a[76:79], v[76:79]
    v_mfma_f32_16x16x32_bf16 v[64:67], a[140:143], a[96:99], v[64:67]
    v_mfma_f32_16x16x32_bf16 v[68:71], a[140:143], a[100:103], v[68:71]
    v_mfma_f32_16x16x32_bf16 v[72:75], a[140:143], a[104:107], v[72:75]
    v_mfma_f32_16x16x32_bf16 v[76:79], a[140:143], a[108:111], v[76:79]
    s_nop 7
    v_max3_f32 v40, v40, v64, v65
    v_max3_f32 v40, v40, v66, v67
    v_max3_f32 v41, v41, v68, v69
    v_max3_f32 v41, v41, v70, v71
    v_max3_f32 v42, v42, v72, v73
    v_max3_f32 v42, v42, v74, v75
    v_max3_f32 v43, v43, v76, v77
    v_max3_f32 v43, v43, v78, v79
    s_nop 2
    ds_read_b128 a[128:131], v20 offset:12288
    ds_read_b128 a[132:135], v21 offset:12288
    ds_read_b128 a[136:139], v22 offset:12288
    ds_read_b128 a[140:143], v23 offset:12288
    s_waitcnt lgkmcnt(0)
    v_mfma_f32_16x16x32_bf16 v[64:67], a[128:131], a[0:3], 0
    v_mfma_f32_16x16x32_bf16 v[68:71], a[128:131], a[4:7], 0
    v_mfma_f32_16x16x32_bf16 v[72:75], a[128:131], a[8:11], 0
    v_mfma_f32_16x16x32_bf16 v[76:79], a[128:131], a[12:15], 0
    v_mfma_f32_16x16x32_bf16 v[64:67], a[132:135], a[32:35], v[64:67]
    v_mfma_f32_16x16x32_bf16 v[68:71], a[132:135], a[36:39], v[68:71]
    v_mfma_f32_16x16x32_bf16 v[72:75], a[132:135], a[40:43], v[72:75]
    v_mfma_f32_16x16x32_bf16 v[76:79], a[132:135], a[44:47], v[76:79]
    v_mfma_f32_16x16x32_bf16 v[64:67], a[136:139], a[64:67], v[64:67]
    v_mfma_f32_16x16x32_bf16 v[68:71], a[136:139], a[68:71], v[68:71]
    v_mfma_f32_16x16x32_bf16 v[72:75], a[136:139], a[72:75], v[72:75]
    v_mfma_f32_16x16x32_bf16 v[76:79], a[136:139], a[76:79], v[76:79]
    v_mfma_f32_16x16x32_bf16 v[64:67], a[140:143], a[96:99], v[64:67]
    v_mfma_f32_16x16x32_bf16 v[68:71], a[140:143], a[100:103], v[68:71]
    v_mfma_f32_16x16x32_bf16 v[72:75], a[140:143], a[104:107], v[72:75]
    v_mfma_f32_16x16x32_bf16 v[76:79], a[140:143], a[108:111], v[76:79]
    s_nop 7
    v_max3_f32 v40, v40, v64, v65
    v_max3_f32 v40, v40, v66, v67
    v_max3_f32 v41, v41, v68, v69
    v_max3_f32 v41, v41, v70, v71
    v_max3_f32 v42, v42, v72, v73
    v_max3_f32 v42, v42, v74, v75
    v_max3_f32 v43, v43, v76, v77
    v_max3_f32 v43, v43, v78, v79
    s_nop 2
    s_add_u32 s62, s62, 16384
    s_cmp_lt_u32 s62, 524288
    s_cbranch_scc1 L_fb_loop
    v_mov_b32 v44, v40
    v_mov_b32 v45, v41
    v_mov_b32 v46, v42
    v_mov_b32 v47, v43
    v_permlane32_swap_b32 v40, v44
    v_permlane32_swap_b32 v41, v45
    v_permlane32_swap_b32 v42, v46
    v_permlane32_swap_b32 v43, v47
    v_max_f32 v40, v40, v44
    v_max_f32 v41, v41, v45
    v_max_f32 v42, v42, v46
    v_max_f32 v43, v43, v47
    v_mov_b32 v44, v40
    v_mov_b32 v45, v41
    v_mov_b32 v46, v42
    v_mov_b32 v47, v43
    v_permlane16_swap_b32 v40, v44
    v_permlane16_swap_b32 v41, v45
    v_permlane16_swap_b32 v42, v46
    v_permlane16_swap_b32 v43, v47
    v_max_f32 v40, v40, v44
    v_max_f32 v41, v41, v45
    v_max_f32 v42, v42, v46
    v_max_f32 v43, v43, v47
    v_sub_f32 v48, 0, v40
    v_sub_f32 v49, 0, v40
    v_sub_f32 v50, 0, v40
    v_sub_f32 v51, 0, v40
    v_sub_f32 v52, 0, v41
    v_sub_f32 v53, 0, v41
    v_sub_f32 v54, 0, v41
    v_sub_f32 v55, 0, v41
    v_sub_f32 v56, 0, v42
    v_sub_f32 v57, 0, v42
    v_sub_f32 v58, 0, v42
    v_sub_f32 v59, 0, v42
    v_sub_f32 v60, 0, v43
    v_sub_f32 v61, 0, v43
    v_sub_f32 v62, 0, v43
    v_sub_f32 v63, 0, v43
    s_barrier
    s_add_u32 m0, s59, 65536
    s_mov_b32 s60, 0
    buffer_load_dwordx4 v32, s[8:11], s60 offen offset:0 lds
    buffer_load_dwordx4 v33, s[8:11], s60 offen offset:1024 lds
    buffer_load_dwordx4 v34, s[8:11], s60 offen offset:2048 lds
    buffer_load_dwordx4 v35, s[8:11], s60 offen offset:3072 lds
    s_add_u32 m0, s59, 81920
    s_mov_b32 s60, 8192
    buffer_load_dwordx4 v32, s[8:11], s60 offen offset:0 lds
    buffer_load_dwordx4 v33, s[8:11], s60 offen offset:1024 lds
    buffer_load_dwordx4 v34, s[8:11], s60 offen offset:2048 lds
    buffer_load_dwordx4 v35, s[8:11], s60 offen offset:3072 lds
    s_add_u32 m0, s59, 0
    s_mov_b32 s60, 0
    buffer_load_dwordx4 v36, s[12:15], s60 offen offset:0 lds
    buffer_load_dwordx4 v37, s[12:15], s60 offen offset:1024 lds
    buffer_load_dwordx4 v36, s[12:15], s60 offen offset:2048 lds
    buffer_load_dwordx4 v37, s[12:15], s60 offen offset:3072 lds
    s_waitcnt vmcnt(0)
    s_branch L_att_start
L_code_end:
    s_endpgm
.section .rodata,"a"
.p2align 6
.amdhsa_kernel recurrent_scan__gqa_block_cached__geglu_ffn__prompt_kernel
  .amdhsa_next_free_vgpr 512
  .amdhsa_next_free_sgpr 102
  .amdhsa_accum_offset 256
  .amdhsa_group_segment_fixed_size 0
  .amdhsa_kernarg_size 96
  .amdhsa_user_sgpr_count 2
  .amdhsa_user_sgpr_kernarg_segment_ptr 1
  .amdhsa_system_sgpr_workgroup_id_x 1
.end_amdhsa_kernel
```
